```python
import torch

def _softmax(x, axis=-1):
    return torch.softmax(x, dim=axis)
def _gelu(x):
    return torch.nn.functional.gelu(x, approximate="tanh")
def _silu(x):
    return torch.nn.functional.silu(x)
def _sigmoid(x):
    return torch.sigmoid(x)
def _layernorm(x, axis=-1, eps=1e-5):
    m = x.mean(dim=axis, keepdim=True)
    v = x.var(dim=axis, keepdim=True, unbiased=False)
    return (x - m) / torch.sqrt(v + eps)
def _scatter_add(tgt, idx, src, axis=0):
    return tgt.clone().index_add_(axis, idx, src)
def _segment_sum(src, seg, n):
    out = torch.zeros((n,) + src.shape[1:], dtype=src.dtype)
    return out.index_add_(0, seg, src)
def _pad(x, pw):
    flat = tuple(v for pair in reversed(pw) for v in pair)
    return torch.nn.functional.pad(x, flat)

kernel_name = 'recurrent_scan__sliding_local_dilated__swiglu_ffn__prompt'

def setup_inputs():

    _w = (lambda a: (lambda t: t.to(torch.bfloat16) if t.is_floating_point() else t)(torch.as_tensor(a)))
    def _A_setup():
        B, S, D = 1, 2048, 576
        return {
            "x": _w((lambda *s: torch.randn(*s, dtype=torch.bfloat16) * 0.05)(B, S, D)),
            "wqkv": _w((lambda *s: torch.randn(*s, dtype=torch.bfloat16) * 0.05)(D, 3 * D)),
            "wo": _w((lambda *s: torch.randn(*s, dtype=torch.bfloat16) * 0.05)(D, D)),
        }
    _A_in = _A_setup()

    def _B_setup():
        B, S, D, F = 1, 2048, 576, 4608
        return {
            "x": _w((lambda *s: torch.randn(*s, dtype=torch.bfloat16) * 0.05)(B, S, D)),
            "w_gate": _w((lambda *s: torch.randn(*s, dtype=torch.bfloat16) * 0.05)(D, F)),
            "w_up": _w((lambda *s: torch.randn(*s, dtype=torch.bfloat16) * 0.05)(D, F)),
            "w_down": _w((lambda *s: torch.randn(*s, dtype=torch.bfloat16) * 0.05)(F, D)),
        }
    _B_in = _B_setup()

    return {
        "A_x": _A_in["x"],
        "A_wqkv": _A_in["wqkv"],
        "A_wo": _A_in["wo"],
        "B_x": _B_in["x"],
        "B_w_gate": _B_in["w_gate"],
        "B_w_up": _B_in["w_up"],
        "B_w_down": _B_in["w_down"],
    }

def reference(A_x, A_wqkv, A_wo, B_x, B_w_gate, B_w_up, B_w_down):
    def _A_ref(x, wqkv, wo):
        B, S, D = x.shape
        H = 32; Dh = D // H
        W, dil = 8, 2
        qkv = (lambda x, *d: x.permute(*d))((x @ wqkv).reshape(B, S, 3, H, Dh), 2, 0, 3, 1, 4)
        q, k, v = qkv[0], qkv[1], qkv[2]
        scale = Dh ** -0.5
        pos = torch.arange(S)
        off = torch.arange(W) * dil
        idx = pos[:, None] - off[None, :]
        mask = idx >= 0
        idx_c = torch.where(mask, idx, 0).reshape(-1)
        kg = k[:, :, idx_c, :].reshape(B, H, S, W, Dh)
        vg = v[:, :, idx_c, :].reshape(B, H, S, W, Dh)
        logits = torch.einsum("bhsd,bhswd->bhsw", q, kg) * scale
        logits = torch.where(mask[None, None, :, :], logits, -1e9)
        attn = _softmax(logits, axis=-1)
        o = torch.einsum("bhsw,bhswd->bhsd", attn, vg)
        return (lambda x, *d: x.permute(*d))(o, 0, 2, 1, 3).reshape(B, S, D) @ wo

    def _B_ref(x, w_gate, w_up, w_down):
        g = _silu(x @ w_gate)
        u = x @ w_up
        return (g * u) @ w_down

    x = A_x
    xn = _layernorm(x, axis=-1)
    s = _A_ref(xn, A_wqkv, A_wo)
    g = _silu(_B_ref(xn, B_w_gate, B_w_up, B_w_down))
    return x + s * g
```

```asm
; @launch grid=(256,1,1) block=(512,1,1) lds=162304
.amdgcn_target "amdgcn-amd-amdhsa--gfx950"
.text
.globl recurrent_scan__sliding_local_dilated__swiglu_ffn__prompt_kernel
.p2align 8
.type recurrent_scan__sliding_local_dilated__swiglu_ffn__prompt_kernel,@function
recurrent_scan__sliding_local_dilated__swiglu_ffn__prompt_kernel:
    s_getpc_b64 s[100:101]
K_PC:
    s_cmp_ge_u32 s2, 256
    s_cbranch_scc1 K_END
    s_load_dwordx4 s[4:7], s[0:1], 0
    s_load_dwordx4 s[8:11], s[0:1], 32
    s_load_dwordx2 s[12:13], s[0:1], 72
    s_load_dwordx2 s[14:15], s[0:1], 16
    s_load_dwordx2 s[16:17], s[0:1], 48
    s_load_dwordx2 s[18:19], s[0:1], 64
    v_lshrrev_b32 v145, 6, v0
    v_and_b32 v144, 63, v0
    v_readfirstlane_b32 s3, v145
    v_mov_b32 v1, v0
    v_mov_b32 v2, v144
    v_lshlrev_b32 v3, 4, v2
    v_cmp_gt_u32 vcc, 8, v2
    v_mov_b32 v5, 0x7fff0000
    s_nop 0
    v_cndmask_b32 v4, v5, v3, vcc
    v_cndmask_b32 v6, 0, 1.0, vcc
    s_lshl_b32 s26, s2, 3
    s_add_u32 s26, s26, s3
    s_mul_i32 s26, s26, 1152
    s_waitcnt lgkmcnt(0)
    s_mov_b32 s48, s4
    s_mov_b32 s49, s5
    s_mov_b32 s50, 0x240000
    s_mov_b32 s51, 0x00020000
    buffer_load_dwordx4 v[16:19], v3, s[48:51], s26 offen
    buffer_load_dwordx4 v[20:23], v4, s[48:51], s26 offen offset:1024
    s_add_u32 s52, s12, 0x3100000
    s_addc_u32 s53, s13, 0
    s_mov_b32 s54, 0x1000
    s_mov_b32 s55, 0x00020000
    s_memrealtime s[76:77]
    s_cmp_eq_u32 s3, 6
    s_cbranch_scc0 K_NOPF
    s_lshr_b32 s26, s2, 3
    s_and_b32 s26, s26, 7
    s_mul_i32 s26, s26, 8192
    v_lshlrev_b32 v88, 7, v2
    v_add_u32 v88, s26, v88
    v_min_u32 v88, K_END-K_PC-4, v88
    global_load_dword v89, v88, s[100:101]
K_NOPF:
    s_and_b32 s20, s2, 7
    s_lshr_b32 s26, s2, 3
    s_and_b32 s21, s26, 3
    s_lshr_b32 s22, s26, 2
    s_lshl_b32 s23, s20, 2
    s_add_u32 s23, s23, s21
    s_lshl_b32 s24, s3, 10
    s_lshl_b32 s28, s22, 3
    s_add_u32 s28, s28, s3
    s_mul_i32 s29, s28, 36864
    s_mul_i32 s65, s20, 1152
    s_lshl_b32 s26, s21, 8
    s_add_u32 s65, s65, s26
    s_mov_b32 s32, s8
    s_mov_b32 s33, s9
    s_mov_b32 s34, 0x510000
    s_mov_b32 s35, 0x00020000
    s_mov_b32 s36, s10
    s_mov_b32 s37, s11
    s_mov_b32 s38, 0x510000
    s_mov_b32 s39, 0x00020000
    s_lshl_b32 s26, s22, 2
    s_add_u32 s26, s26, s3
    s_sub_u32 s26, s26, 4
    s_mul_i32 s26, s26, 18
    v_add_u32 v72, s26, v2
    v_mul_u32_u24 v72, 0x2400, v72
    s_cmp_ge_u32 s3, 4
    s_cselect_b32 s26, 18, 0
    v_cmp_gt_u32 vcc, s26, v2
    s_nop 1
    v_cndmask_b32 v72, v5, v72, vcc
    buffer_load_dword v76, v72, s[32:35], s65 offen
    buffer_load_dword v77, v72, s[36:39], s65 offen
    s_lshl_b32 s28, s28, 1
    v_lshlrev_b32 v238, 4, v144
    v_lshrrev_b32 v145, 3, v144
    v_bfe_u32 v146, v144, 2, 1
    v_bfe_u32 v149, v144, 4, 1
    v_xor_b32 v146, v146, v149
    v_and_b32 v147, 3, v144
    s_lshl_b32 s26, s3, 3
    v_add_u32 v148, s26, v145
    v_lshlrev_b32 v149, 4, v147
    v_bfe_u32 v150, v144, 2, 3
    v_add_u32 v150, s26, v150
    v_mul_u32_u24 v232, 0x2400, v150
    s_bfe_u32 s26, s3, 0x10001
    v_xor_b32 v150, s26, v147
    v_lshl_add_u32 v232, v150, 4, v232
    v_lshrrev_b32 v150, 5, v144
    v_lshl_add_u32 v232, v150, 6, v232
    s_mov_b32 s44, s12
    s_mov_b32 s45, s13
    s_mov_b32 s46, 0x240000
    s_mov_b32 s47, 0x00020000
    s_add_u32 s56, s12, 0x3101000
    s_addc_u32 s57, s13, 0
    s_mov_b32 s58, 0x8800
    s_mov_b32 s59, 0x00020000
    s_waitcnt vmcnt(2)
    v_lshlrev_b32 v24, 16, v16
    v_and_b32 v25, 0xffff0000, v16
    v_lshlrev_b32 v26, 16, v17
    v_and_b32 v27, 0xffff0000, v17
    v_lshlrev_b32 v28, 16, v18
    v_and_b32 v29, 0xffff0000, v18
    v_lshlrev_b32 v30, 16, v19
    v_and_b32 v31, 0xffff0000, v19
    v_lshlrev_b32 v32, 16, v20
    v_and_b32 v33, 0xffff0000, v20
    v_lshlrev_b32 v34, 16, v21
    v_and_b32 v35, 0xffff0000, v21
    v_lshlrev_b32 v36, 16, v22
    v_and_b32 v37, 0xffff0000, v22
    v_lshlrev_b32 v38, 16, v23
    v_and_b32 v39, 0xffff0000, v23
    v_add_f32 v40, v24, v25
    v_add_f32 v41, v26, v27
    v_add_f32 v40, v40, v28
    v_add_f32 v41, v41, v29
    v_add_f32 v40, v40, v30
    v_add_f32 v41, v41, v31
    v_add_f32 v40, v40, v32
    v_add_f32 v41, v41, v33
    v_add_f32 v40, v40, v34
    v_add_f32 v41, v41, v35
    v_add_f32 v40, v40, v36
    v_add_f32 v41, v41, v37
    v_add_f32 v40, v40, v38
    v_add_f32 v41, v41, v39
    v_add_f32 v40, v40, v41
    s_nop 1
    v_add_f32_dpp v40, v40, v40 row_ror:8 row_mask:0xf bank_mask:0xf
    s_nop 1
    v_add_f32_dpp v40, v40, v40 row_ror:4 row_mask:0xf bank_mask:0xf
    s_nop 1
    v_add_f32_dpp v40, v40, v40 row_ror:2 row_mask:0xf bank_mask:0xf
    s_nop 1
    v_add_f32_dpp v40, v40, v40 row_ror:1 row_mask:0xf bank_mask:0xf
    v_mov_b32 v41, v40
    s_nop 1
    v_permlane16_swap_b32 v40, v41
    v_add_f32 v40, v40, v41
    v_mov_b32 v41, v40
    s_nop 1
    v_permlane32_swap_b32 v40, v41
    v_add_f32 v40, v40, v41
    v_mul_f32 v40, 0x3ae38e39, v40
    v_sub_f32 v44, v24, v40
    v_sub_f32 v45, v25, v40
    v_sub_f32 v46, v26, v40
    v_sub_f32 v47, v27, v40
    v_sub_f32 v48, v28, v40
    v_sub_f32 v49, v29, v40
    v_sub_f32 v50, v30, v40
    v_sub_f32 v51, v31, v40
    v_sub_f32 v52, v32, v40
    v_sub_f32 v53, v33, v40
    v_sub_f32 v54, v34, v40
    v_sub_f32 v55, v35, v40
    v_sub_f32 v56, v36, v40
    v_sub_f32 v57, v37, v40
    v_sub_f32 v58, v38, v40
    v_sub_f32 v59, v39, v40
    v_mul_f32 v42, v44, v44
    v_mul_f32 v43, v52, v52
    v_fmac_f32 v42, v45, v45
    v_fmac_f32 v43, v53, v53
    v_fmac_f32 v42, v46, v46
    v_fmac_f32 v43, v54, v54
    v_fmac_f32 v42, v47, v47
    v_fmac_f32 v43, v55, v55
    v_fmac_f32 v42, v48, v48
    v_fmac_f32 v43, v56, v56
    v_fmac_f32 v42, v49, v49
    v_fmac_f32 v43, v57, v57
    v_fmac_f32 v42, v50, v50
    v_fmac_f32 v43, v58, v58
    v_fmac_f32 v42, v51, v51
    v_fmac_f32 v43, v59, v59
    v_fmac_f32 v42, v43, v6
    s_nop 1
    v_add_f32_dpp v42, v42, v42 row_ror:8 row_mask:0xf bank_mask:0xf
    s_nop 1
    v_add_f32_dpp v42, v42, v42 row_ror:4 row_mask:0xf bank_mask:0xf
    s_nop 1
    v_add_f32_dpp v42, v42, v42 row_ror:2 row_mask:0xf bank_mask:0xf
    s_nop 1
    v_add_f32_dpp v42, v42, v42 row_ror:1 row_mask:0xf bank_mask:0xf
    v_mov_b32 v41, v42
    s_nop 1
    v_permlane16_swap_b32 v42, v41
    v_add_f32 v42, v42, v41
    v_mov_b32 v41, v42
    s_nop 1
    v_permlane32_swap_b32 v42, v41
    v_add_f32 v42, v42, v41
    v_mul_f32 v42, 0x3ae38e39, v42
    v_cvt_pk_bf16_f32 v40, v40, v40
    v_lshlrev_b32 v40, 16, v40
    v_cvt_pk_bf16_f32 v42, v42, v42
    v_lshlrev_b32 v42, 16, v42
    v_add_f32 v42, 0x3727c5ac, v42
    v_cvt_pk_bf16_f32 v42, v42, v42
    v_lshlrev_b32 v42, 16, v42
    v_sqrt_f32 v42, v42
    s_nop 0
    v_cvt_pk_bf16_f32 v42, v42, v42
    v_lshlrev_b32 v42, 16, v42
    v_rcp_f32 v42, v42
    v_sub_f32 v24, v24, v40
    v_sub_f32 v25, v25, v40
    v_cvt_pk_bf16_f32 v25, v24, v25
    v_lshlrev_b32 v24, 16, v25
    v_and_b32 v25, 0xffff0000, v25
    v_mul_f32 v24, v24, v42
    v_mul_f32 v25, v25, v42
    v_cvt_pk_bf16_f32 v16, v24, v25
    v_sub_f32 v26, v26, v40
    v_sub_f32 v27, v27, v40
    v_cvt_pk_bf16_f32 v27, v26, v27
    v_lshlrev_b32 v26, 16, v27
    v_and_b32 v27, 0xffff0000, v27
    v_mul_f32 v26, v26, v42
    v_mul_f32 v27, v27, v42
    v_cvt_pk_bf16_f32 v17, v26, v27
    v_sub_f32 v28, v28, v40
    v_sub_f32 v29, v29, v40
    v_cvt_pk_bf16_f32 v29, v28, v29
    v_lshlrev_b32 v28, 16, v29
    v_and_b32 v29, 0xffff0000, v29
    v_mul_f32 v28, v28, v42
    v_mul_f32 v29, v29, v42
    v_cvt_pk_bf16_f32 v18, v28, v29
    v_sub_f32 v30, v30, v40
    v_sub_f32 v31, v31, v40
    v_cvt_pk_bf16_f32 v31, v30, v31
    v_lshlrev_b32 v30, 16, v31
    v_and_b32 v31, 0xffff0000, v31
    v_mul_f32 v30, v30, v42
    v_mul_f32 v31, v31, v42
    v_cvt_pk_bf16_f32 v19, v30, v31
    v_sub_f32 v32, v32, v40
    v_sub_f32 v33, v33, v40
    v_cvt_pk_bf16_f32 v33, v32, v33
    v_lshlrev_b32 v32, 16, v33
    v_and_b32 v33, 0xffff0000, v33
    v_mul_f32 v32, v32, v42
    v_mul_f32 v33, v33, v42
    v_cvt_pk_bf16_f32 v20, v32, v33
    v_sub_f32 v34, v34, v40
    v_sub_f32 v35, v35, v40
    v_cvt_pk_bf16_f32 v35, v34, v35
    v_lshlrev_b32 v34, 16, v35
    v_and_b32 v35, 0xffff0000, v35
    v_mul_f32 v34, v34, v42
    v_mul_f32 v35, v35, v42
    v_cvt_pk_bf16_f32 v21, v34, v35
    v_sub_f32 v36, v36, v40
    v_sub_f32 v37, v37, v40
    v_cvt_pk_bf16_f32 v37, v36, v37
    v_lshlrev_b32 v36, 16, v37
    v_and_b32 v37, 0xffff0000, v37
    v_mul_f32 v36, v36, v42
    v_mul_f32 v37, v37, v42
    v_cvt_pk_bf16_f32 v22, v36, v37
    v_sub_f32 v38, v38, v40
    v_sub_f32 v39, v39, v40
    v_cvt_pk_bf16_f32 v39, v38, v39
    v_lshlrev_b32 v38, 16, v39
    v_and_b32 v39, 0xffff0000, v39
    v_mul_f32 v38, v38, v42
    v_mul_f32 v39, v39, v42
    v_cvt_pk_bf16_f32 v23, v38, v39
    v_lshlrev_b32 v44, 7, v2
    s_lshl_b32 s26, s3, 4
    s_add_u32 s26, s26, 147456
    v_add_u32 v44, s26, v44
    ds_write_b128 v44, v[16:19]
    s_mov_b64 exec, 0xff
    ds_write_b128 v44, v[20:23] offset:8192
    s_mov_b64 exec, -1
    v_lshlrev_b32 v44, 4, v1
    v_add_u32 v44, 147456, v44
    v_lshrrev_b32 v45, 3, v1
    v_lshlrev_b32 v45, 9, v45
    v_and_b32 v46, 7, v1
    v_lshl_add_u32 v45, v46, 4, v45
    s_lshr_b32 s26, s2, 2
    s_mul_i32 s26, s26, 36864
    s_and_b32 s25, s2, 3
    s_lshl_b32 s27, s25, 7
    s_add_u32 s26, s26, s27
    s_add_u32 s27, s26, 16384
    s_add_u32 s25, s26, 32768
    v_cmp_gt_u32 vcc, 64, v1
    s_nop 1
    v_cndmask_b32 v46, v5, v45, vcc
    v_min_u32 v47, 63, v1
    v_lshlrev_b32 v47, 4, v47
    v_add_u32 v47, 155648, v47
    s_waitcnt lgkmcnt(0)
    s_barrier
    s_cmp_ge_u32 s3, 4
    s_cbranch_scc1 K_NOPUB
    ds_read_b128 v[16:19], v44
    ds_read_b128 v[20:23], v44 offset:4096
    ds_read_b128 v[24:27], v47
    s_waitcnt lgkmcnt(2)
    buffer_store_dwordx4 v[16:19], v45, s[44:47], s26 offen sc1
    s_waitcnt lgkmcnt(1)
    buffer_store_dwordx4 v[20:23], v45, s[44:47], s27 offen sc1
    s_waitcnt lgkmcnt(0)
    buffer_store_dwordx4 v[24:27], v46, s[44:47], s25 offen sc1
    s_waitcnt vmcnt(0)
K_NOPUB:
    s_barrier
    s_cmp_eq_u32 s3, 0
    s_cbranch_scc0 SIG1_308
    s_memrealtime s[90:91]
    v_mov_b32 v54, 0
    s_lshl_b32 s25, s2, 3
    s_waitcnt lgkmcnt(0)
    v_mov_b32 v52, s90
    v_xor_b32 v53, 0x5bd1e995, v52
    s_mov_b64 exec, 1
    buffer_store_dwordx2 v[52:53], v54, s[52:55], s25 offen offset:0 sc1
    s_mov_b64 exec, -1
SIG1_308:
    s_add_u32 s25, s65, 0x0
    s_add_u32 m0, s24, 0
    s_nop 0
    buffer_load_dwordx4 v232, s[32:35], s25 offen lds
    s_add_u32 s25, s65, 0x0
    s_add_u32 m0, s24, 8192
    s_nop 0
    buffer_load_dwordx4 v232, s[36:39], s25 offen lds
    s_add_u32 s25, s65, 0x90000
    s_add_u32 m0, s24, 16384
    s_nop 0
    buffer_load_dwordx4 v232, s[32:35], s25 offen lds
    s_add_u32 s25, s65, 0x90000
    s_add_u32 m0, s24, 24576
    s_nop 0
    buffer_load_dwordx4 v232, s[36:39], s25 offen lds
    s_cmp_eq_u32 s3, 3
    s_cbranch_scc1 K_PUBD
    s_add_u32 s25, s65, 0x120000
    s_add_u32 m0, s24, 32768
    s_nop 0
    buffer_load_dwordx4 v232, s[32:35], s25 offen lds
    s_add_u32 s25, s65, 0x120000
    s_add_u32 m0, s24, 40960
    s_nop 0
    buffer_load_dwordx4 v232, s[36:39], s25 offen lds
    s_add_u32 s25, s65, 0x1b0000
    s_add_u32 m0, s24, 49152
    s_nop 0
    buffer_load_dwordx4 v232, s[32:35], s25 offen lds
    s_add_u32 s25, s65, 0x1b0000
    s_add_u32 m0, s24, 57344
    s_nop 0
    buffer_load_dwordx4 v232, s[36:39], s25 offen lds
    s_add_u32 s25, s65, 0x240000
    s_add_u32 m0, s24, 65536
    s_nop 0
    buffer_load_dwordx4 v232, s[32:35], s25 offen lds
    s_add_u32 s25, s65, 0x240000
    s_add_u32 m0, s24, 73728
    s_nop 0
    buffer_load_dwordx4 v232, s[36:39], s25 offen lds
K_PUBD:
    s_lshl_b32 s26, s3, 8
    s_add_u32 s26, s26, s2
    s_mul_i32 s74, s26, 7282
    s_lshr_b32 s74, s74, 16
    s_mul_i32 s75, s74, 9
    s_sub_u32 s75, s26, s75
    s_cmp_lt_u32 s74, 144
    s_cselect_b32 s26, 4, 8
    s_cselect_b32 s96, 8, 4
    s_cselect_b32 s97, 8, 14
    s_cmp_lt_u32 s74, 160
    s_cselect_b32 s26, s26, 72
    s_cselect_b32 s27, 2, 18
    s_cselect_b32 s96, s96, 36
    s_cselect_b32 s97, s97, 108
    s_mulk_i32 s96, 1152
    s_mulk_i32 s97, 1152
    v_lshrrev_b32 v7, 5, v2
    v_mul_u32_u24 v7, s26, v7
    v_bfe_u32 v8, v2, 4, 1
    v_mad_u32_u24 v7, v8, s27, v7
    v_bfe_u32 v8, v2, 3, 1
    v_add_u32 v7, v7, v8
    v_mul_u32_u24 v7, 0x480, v7
    v_bfe_u32 v8, v2, 1, 2
    v_lshrrev_b32 v9, 4, v2
    v_xor_b32 v8, v8, v9
    v_lshl_add_u32 v7, v8, 5, v7
    v_and_b32 v8, 1, v2
    v_lshl_add_u32 v255, v8, 4, v7
    s_cmp_lt_u32 s74, 144
    s_cselect_b32 s92, s16, s14
    s_cselect_b32 s93, s17, s15
    s_mov_b32 s94, 0xa2000
    s_cselect_b32 s94, 0x510000, s94
    s_mov_b32 s95, 0x00020000
    s_lshl_b32 s79, s74, 5
    s_sub_u32 s26, s74, 144
    s_mul_i32 s26, s26, 36
    s_cmp_lt_u32 s74, 144
    s_cselect_b32 s79, s79, s26
    s_sub_u32 s26, s74, 160
    s_mul_i32 s26, s26, 288
    s_add_u32 s26, s26, 16
    s_cmp_lt_u32 s74, 160
    s_cselect_b32 s79, s79, s26
    s_mul_i32 s79, s79, 1152
    s_lshl_b32 s26, s75, 7
    s_add_u32 s79, s79, s26
    s_mul_i32 s26, s74, 3641
    s_lshr_b32 s26, s26, 16
    s_mul_i32 s27, s26, 18
    s_sub_u32 s27, s74, s27
    s_lshr_b32 s64, s26, 1
    s_mul_i32 s64, s64, 36
    s_and_b32 s26, s26, 1
    s_lshr_b32 s25, s27, 2
    s_lshl_b32 s25, s25, 1
    s_and_b32 s78, s27, 1
    s_add_u32 s25, s25, s78
    s_lshl_b32 s78, s26, 3
    s_add_u32 s25, s25, s78
    s_bitcmp1_b32 s27, 1
    s_cselect_b32 s78, 16, 0
    s_add_u32 s25, s25, s78
    s_lshl_b32 s78, s26, 1
    s_add_u32 s78, s78, s27
    s_add_u32 s78, s78, 16
    s_cmp_lt_u32 s27, 16
    s_cselect_b32 s25, s25, s78
    s_add_u32 s25, s25, s64
    s_cmp_lt_u32 s74, 144
    s_cselect_b32 s25, s25, s74
    s_mul_i32 s78, s25, 4608
    s_cmp_lt_u32 s74, 162
    s_cselect_b32 s78, s78, 0x40000000
    s_mov_b32 s64, 0xbfb8aa3b
    s_mul_i32 s66, s23, 36
    v_mul_u32_u24 v150, 0x480, v146
    v_mul_u32_u24 v233, 0xd80, v148
    v_add3_u32 v233, v233, v150, v149
    v_cmp_gt_u32 s[68:69], 3, v147
    s_mul_i32 s26, s20, 1152
    s_lshl_b32 s27, s21, 5
    s_add_u32 s26, s26, s27
    s_add_u32 s26, s26, 1024
    v_and_b32 v150, 1, v144
    v_mul_u32_u24 v151, 0x2400, v148
    v_lshl_add_u32 v151, v150, 4, v151
    v_add_u32 v151, s26, v151
    v_mul_u32_u24 v152, 0xd80, v148
    v_min_u32 v153, 20, v149
    s_add_u32 s26, s66, 2304
    v_add3_u32 v152, v152, v153, s26
    v_cmp_eq_u32 vcc, 0, v146
    s_nop 1
    v_cndmask_b32 v151, v152, v151, vcc
    v_mov_b32 v152, 0x36000
    v_mov_b32 v153, 0x90000
    v_cndmask_b32 v236, v152, v153, vcc
    v_lshl_add_u32 v150, v146, 2, v147
    v_mov_b32 v153, s6
    v_mov_b32 v154, s7
    v_mov_b32 v155, s10
    v_mov_b32 v156, s11
    v_cmp_gt_u32 vcc, 4, v150
    s_nop 1
    v_cndmask_b32 v153, v153, v155, vcc
    v_cndmask_b32 v154, v154, v156, vcc
    v_mov_b32 v155, s8
    v_mov_b32 v156, s9
    v_cmp_gt_u32 vcc, 2, v150
    s_nop 1
    v_cndmask_b32 v153, v153, v155, vcc
    v_cndmask_b32 v154, v154, v156, vcc
    v_add_co_u32 v234, vcc, v153, v151
    s_nop 1
    v_addc_co_u32 v235, vcc, 0, v154, vcc
    v_cmp_gt_u32 s[30:31], 7, v150
    v_lshrrev_b32 v152, 5, v144
    v_bfe_u32 v153, v144, 2, 2
    v_lshl_add_u32 v153, v152, 3, v153
    v_lshlrev_b32 v153, 7, v153
    v_bfe_u32 v154, v144, 3, 1
    v_lshl_add_u32 v153, v154, 6, v153
    v_bfe_u32 v155, v144, 4, 1
    v_lshl_add_u32 v155, v155, 2, v147
    v_lshl_add_u32 v228, v155, 3, v153
    v_xor_b32 v229, 64, v228
    v_mov_b32 v230, v228
    v_xor_b32 v156, 64, v153
    v_add_u32 v157, 8232, v156
    v_cmp_eq_u32 vcc, 5, v155
    s_nop 1
    v_cndmask_b32 v230, v230, v157, vcc
    v_add_u32 v157, 8192, v156
    v_cmp_eq_u32 vcc, 6, v155
    s_nop 1
    v_cndmask_b32 v230, v230, v157, vcc
    v_add_u32 v157, 8208, v156
    v_cmp_eq_u32 vcc, 7, v155
    s_nop 1
    v_cndmask_b32 v230, v230, v157, vcc
    v_mov_b32 v231, v229
    v_xor_b32 v156, 64, v153
    v_add_u32 v157, 8232, v156
    v_cmp_eq_u32 vcc, 5, v155
    s_nop 1
    v_cndmask_b32 v231, v231, v157, vcc
    v_add_u32 v157, 8200, v156
    v_cmp_eq_u32 vcc, 6, v155
    s_nop 1
    v_cndmask_b32 v231, v231, v157, vcc
    v_add_u32 v157, 8216, v156
    v_cmp_eq_u32 vcc, 7, v155
    s_nop 1
    v_cndmask_b32 v231, v231, v157, vcc
    v_mov_b32 v249, v228
    v_bfe_u32 v154, v144, 4, 1
    v_lshlrev_b32 v228, 11, v154
    v_lshl_add_u32 v228, v154, 4, v228
    v_lshl_add_u32 v228, v152, 10, v228
    v_bfe_u32 v156, v144, 2, 2
    v_lshl_add_u32 v228, v156, 6, v228
    v_bfe_u32 v156, v144, 1, 1
    v_lshl_add_u32 v228, v156, 5, v228
    v_and_b32 v156, 1, v144
    v_lshl_add_u32 v228, v156, 3, v228
    v_xor_b32 v229, 16, v228
    v_add_u32 v154, s28, v154
    s_mov_b32 s26, 165888
    v_mul_lo_u32 v239, v154, s26
    v_and_b32 v154, 15, v144
    v_lshl_add_u32 v239, v154, 4, v239
    v_lshl_add_u32 v239, v152, 8, v239
    v_lshl_add_u32 v248, v152, 4, v154
    v_lshlrev_b32 v248, 4, v248
    v_add_u32 v248, 139264, v248
    s_lshr_b32 s26, s3, 2
    s_or_b32 s26, s26, s3
    s_and_b32 s26, s26, 1
    v_bfe_u32 v154, v144, 4, 1
    v_cmp_eq_u32 s[72:73], s26, v154
    v_and_b32 v240, 15, v144
    v_lshlrev_b32 v240, 4, v240
    v_lshl_add_u32 v240, v154, 10, v240
    v_lshl_add_u32 v240, v152, 9, v240
    v_bfe_u32 v10, v2, 2, 3
    v_bfe_u32 v11, v10, 1, 2
    v_lshlrev_b32 v10, 7, v10
    v_lshl_add_u32 v10, v11, 5, v10
    v_and_b32 v11, 3, v2
    v_lshl_add_u32 v10, v11, 3, v10
    v_lshrrev_b32 v11, 5, v2
    v_lshl_add_u32 v10, v11, 11, v10
    s_lshl_b32 s26, s3, 12
    s_add_u32 s26, s26, 114688
    v_add_u32 v254, s26, v10
    v_bfe_u32 v64, v2, 3, 1
    v_and_b32 v65, 7, v2
    s_lshl_b32 s26, s75, 3
    v_add_u32 v66, s26, v64
    v_mul_u32_u24 v67, 57, v66
    v_lshrrev_b32 v67, 9, v67
    v_mul_u32_u24 v68, 9, v67
    v_sub_u32 v68, v66, v68
    v_and_b32 v69, 1, v68
    v_lshl_add_u32 v69, v69, 3, v65
    v_lshl_add_u32 v69, v9, 4, v69
    v_lshlrev_b32 v69, 4, v69
    v_lshrrev_b32 v70, 1, v68
    v_lshl_add_u32 v69, v70, 10, v69
    v_lshl_add_u32 v70, v9, 3, v65
    v_lshlrev_b32 v70, 4, v70
    v_add_u32 v70, 0x1000, v70
    v_cmp_gt_u32 vcc, 8, v68
    s_nop 1
    v_cndmask_b32 v69, v70, v69, vcc
    v_mul_u32_u24 v67, 0xb6400, v67
    v_add_u32 v250, v67, v69
    v_add_u32 v66, s26, v64
    v_add_u32 v66, 2, v66
    v_mul_u32_u24 v67, 57, v66
    v_lshrrev_b32 v67, 9, v67
    v_mul_u32_u24 v68, 9, v67
    v_sub_u32 v68, v66, v68
    v_and_b32 v69, 1, v68
    v_lshl_add_u32 v69, v69, 3, v65
    v_lshl_add_u32 v69, v9, 4, v69
    v_lshlrev_b32 v69, 4, v69
    v_lshrrev_b32 v70, 1, v68
    v_lshl_add_u32 v69, v70, 10, v69
    v_lshl_add_u32 v70, v9, 3, v65
    v_lshlrev_b32 v70, 4, v70
    v_add_u32 v70, 0x1000, v70
    v_cmp_gt_u32 vcc, 8, v68
    s_nop 1
    v_cndmask_b32 v69, v70, v69, vcc
    v_mul_u32_u24 v67, 0xb6400, v67
    v_add_u32 v251, v67, v69
    v_add_u32 v66, s26, v64
    v_add_u32 v66, 4, v66
    v_mul_u32_u24 v67, 57, v66
    v_lshrrev_b32 v67, 9, v67
    v_mul_u32_u24 v68, 9, v67
    v_sub_u32 v68, v66, v68
    v_and_b32 v69, 1, v68
    v_lshl_add_u32 v69, v69, 3, v65
    v_lshl_add_u32 v69, v9, 4, v69
    v_lshlrev_b32 v69, 4, v69
    v_lshrrev_b32 v70, 1, v68
    v_lshl_add_u32 v69, v70, 10, v69
    v_lshl_add_u32 v70, v9, 3, v65
    v_lshlrev_b32 v70, 4, v70
    v_add_u32 v70, 0x1000, v70
    v_cmp_gt_u32 vcc, 8, v68
    s_nop 1
    v_cndmask_b32 v69, v70, v69, vcc
    v_mul_u32_u24 v67, 0xb6400, v67
    v_add_u32 v252, v67, v69
    v_add_u32 v66, s26, v64
    v_add_u32 v66, 6, v66
    v_mul_u32_u24 v67, 57, v66
    v_lshrrev_b32 v67, 9, v67
    v_mul_u32_u24 v68, 9, v67
    v_sub_u32 v68, v66, v68
    v_and_b32 v69, 1, v68
    v_lshl_add_u32 v69, v69, 3, v65
    v_lshl_add_u32 v69, v9, 4, v69
    v_lshlrev_b32 v69, 4, v69
    v_lshrrev_b32 v70, 1, v68
    v_lshl_add_u32 v69, v70, 10, v69
    v_lshl_add_u32 v70, v9, 3, v65
    v_lshlrev_b32 v70, 4, v70
    v_add_u32 v70, 0x1000, v70
    v_cmp_gt_u32 vcc, 8, v68
    s_nop 1
    v_cndmask_b32 v69, v70, v69, vcc
    v_mul_u32_u24 v67, 0xb6400, v67
    v_add_u32 v253, v67, v69
    s_mov_b32 s40, s6
    s_mov_b32 s41, s7
    s_mov_b32 s42, 0x1e6000
    s_mov_b32 s43, 0x00020000
    s_add_u32 s48, s12, 0x400000
    s_addc_u32 s49, s13, 0
    s_mov_b32 s50, 0x1440000
    s_mov_b32 s51, 0x00020000
    s_add_u32 s60, s12, 0x2000000
    s_addc_u32 s61, s13, 0
    s_mov_b32 s62, 0x5b2000
    s_mov_b32 s63, 0x00020000
    s_waitcnt lgkmcnt(0)
    s_cmp_eq_u32 s3, 3
    s_cbranch_scc0 POLL1_632_R
    v_mbcnt_lo_u32_b32 v48, -1, 0
    v_mbcnt_hi_u32_b32 v48, -1, v48
    s_lshl_b32 s27, s22, 4
    s_sub_u32 s27, s27, 2
    v_add_u32 v49, s27, v48
    v_max_i32 v49, 0, v49
    v_lshlrev_b32 v49, 4, v49
    v_cmp_gt_u32 vcc, 18, v48
    s_nop 0
    s_mov_b64 exec, vcc
    s_mov_b32 s26, 0
POLL1_632_F:
    buffer_load_dwordx4 v[52:55], v49, s[52:55], 0 offen offset:0 sc1
    s_add_u32 s26, s26, 1
    s_waitcnt vmcnt(0)
    s_add_u32 s27, s76, 4294966296
    v_xor_b32 v50, v52, v53
    v_xor_b32 v51, v54, v55
    v_xor_b32 v50, 0x5bd1e995, v50
    v_xor_b32 v51, 0x5bd1e995, v51
    v_or_b32 v50, v50, v51
    v_subrev_u32 v53, s27, v52
    v_subrev_u32 v55, s27, v54
    v_max_u32 v51, v53, v55
    v_lshrrev_b32 v51, 22, v51
    v_or_b32 v50, v50, v51
    v_cmp_ne_u32 vcc, 0, v50
    s_nop 4
    s_cbranch_vccz POLL1_632_D
    s_mov_b64 exec, vcc
    s_sleep 3
    s_cmp_lt_u32 s26, 0x8000
    s_cbranch_scc1 POLL1_632_F
POLL1_632_D:
    s_mov_b64 exec, -1
POLL1_632_R:
    s_barrier
    s_cmp_eq_u32 s3, 3
    s_cbranch_scc0 K_LATEW2
    s_add_u32 s25, s65, 0x120000
    s_add_u32 m0, s24, 32768
    s_nop 0
    buffer_load_dwordx4 v232, s[32:35], s25 offen lds
    s_add_u32 s25, s65, 0x120000
    s_add_u32 m0, s24, 40960
    s_nop 0
    buffer_load_dwordx4 v232, s[36:39], s25 offen lds
    s_add_u32 s25, s65, 0x1b0000
    s_add_u32 m0, s24, 49152
    s_nop 0
    buffer_load_dwordx4 v232, s[32:35], s25 offen lds
    s_add_u32 s25, s65, 0x1b0000
    s_add_u32 m0, s24, 57344
    s_nop 0
    buffer_load_dwordx4 v232, s[36:39], s25 offen lds
    s_add_u32 s25, s65, 0x240000
    s_add_u32 m0, s24, 65536
    s_nop 0
    buffer_load_dwordx4 v232, s[32:35], s25 offen lds
    s_add_u32 s25, s65, 0x240000
    s_add_u32 m0, s24, 73728
    s_nop 0
    buffer_load_dwordx4 v232, s[36:39], s25 offen lds
K_LATEW2:
    buffer_load_dwordx4 v[0:3], v240, s[44:47], s29 offen offset:0
    buffer_load_dwordx4 v[4:7], v240, s[44:47], s29 offen offset:256
    buffer_load_dwordx4 v[8:11], v240, s[44:47], s29 offen offset:2048
    buffer_load_dwordx4 v[12:15], v240, s[44:47], s29 offen offset:2304
    s_add_u32 s29, s29, 4096
    buffer_load_dwordx4 v[16:19], v240, s[44:47], s29 offen offset:0
    buffer_load_dwordx4 v[20:23], v240, s[44:47], s29 offen offset:256
    buffer_load_dwordx4 v[24:27], v240, s[44:47], s29 offen offset:2048
    buffer_load_dwordx4 v[28:31], v240, s[44:47], s29 offen offset:2304
    s_add_u32 s29, s29, 4096
    buffer_load_dwordx4 v[32:35], v240, s[44:47], s29 offen offset:0
    buffer_load_dwordx4 v[36:39], v240, s[44:47], s29 offen offset:256
    buffer_load_dwordx4 v[40:43], v240, s[44:47], s29 offen offset:2048
    buffer_load_dwordx4 v[44:47], v240, s[44:47], s29 offen offset:2304
    s_add_u32 s29, s29, 4096
    s_cmp_ge_u32 s3, 4
    s_cbranch_scc1 K_G2
    s_waitcnt vmcnt(20)
    s_barrier
    ds_read_b64_tr_b16 v[208:209], v228 offset:0
    ds_read_b64_tr_b16 v[210:211], v228 offset:256
    ds_read_b64_tr_b16 v[212:213], v228 offset:512
    ds_read_b64_tr_b16 v[214:215], v228 offset:768
    ds_read_b64_tr_b16 v[216:217], v228 offset:8192
    ds_read_b64_tr_b16 v[218:219], v228 offset:8448
    s_waitcnt vmcnt(8)
    ds_read_b64_tr_b16 v[220:221], v228 offset:8704
    ds_read_b64_tr_b16 v[222:223], v228 offset:8960
    s_waitcnt lgkmcnt(6)
    v_mfma_f32_16x16x32_bf16 v[144:147], v[208:211], v[0:3], 0
    v_mfma_f32_16x16x32_bf16 v[152:155], v[208:211], v[4:7], 0
    buffer_load_dwordx4 v[48:51], v240, s[44:47], s29 offen offset:0
    ds_read_b64_tr_b16 v[208:209], v229 offset:0
    ds_read_b64_tr_b16 v[210:211], v229 offset:256
    s_waitcnt lgkmcnt(6)
    v_mfma_f32_16x16x32_bf16 v[160:163], v[212:215], v[0:3], 0
    v_mfma_f32_16x16x32_bf16 v[168:171], v[212:215], v[4:7], 0
    ds_read_b64_tr_b16 v[212:213], v229 offset:512
    ds_read_b64_tr_b16 v[214:215], v229 offset:768
    s_waitcnt lgkmcnt(6)
    v_mfma_f32_16x16x32_bf16 v[176:179], v[216:219], v[0:3], 0
    v_mfma_f32_16x16x32_bf16 v[184:187], v[216:219], v[4:7], 0
    buffer_load_dwordx4 v[52:55], v240, s[44:47], s29 offen offset:256
    ds_read_b64_tr_b16 v[216:217], v229 offset:8192
    ds_read_b64_tr_b16 v[218:219], v229 offset:8448
    s_waitcnt lgkmcnt(6)
    v_mfma_f32_16x16x32_bf16 v[192:195], v[220:223], v[0:3], 0
    v_mfma_f32_16x16x32_bf16 v[200:203], v[220:223], v[4:7], 0
    buffer_load_dwordx4 v[56:59], v240, s[44:47], s29 offen offset:2048
    ds_read_b64_tr_b16 v[220:221], v229 offset:8704
    ds_read_b64_tr_b16 v[222:223], v229 offset:8960
    s_waitcnt lgkmcnt(6)
    v_mfma_f32_16x16x32_bf16 v[148:151], v[208:211], v[0:3], 0
    v_mfma_f32_16x16x32_bf16 v[156:159], v[208:211], v[4:7], 0
    ds_read_b64_tr_b16 v[208:209], v228 offset:4096
    ds_read_b64_tr_b16 v[210:211], v228 offset:4352
    s_waitcnt lgkmcnt(6)
    v_mfma_f32_16x16x32_bf16 v[164:167], v[212:215], v[0:3], 0
    v_mfma_f32_16x16x32_bf16 v[172:175], v[212:215], v[4:7], 0
    buffer_load_dwordx4 v[60:63], v240, s[44:47], s29 offen offset:2304
    s_add_u32 s29, s29, 4096
    ds_read_b64_tr_b16 v[212:213], v228 offset:4608
    ds_read_b64_tr_b16 v[214:215], v228 offset:4864
    s_waitcnt lgkmcnt(6)
    v_mfma_f32_16x16x32_bf16 v[180:183], v[216:219], v[0:3], 0
    v_mfma_f32_16x16x32_bf16 v[188:191], v[216:219], v[4:7], 0
    ds_read_b64_tr_b16 v[216:217], v228 offset:12288
    ds_read_b64_tr_b16 v[218:219], v228 offset:12544
    s_waitcnt lgkmcnt(6)
    v_mfma_f32_16x16x32_bf16 v[196:199], v[220:223], v[0:3], 0
    v_mfma_f32_16x16x32_bf16 v[204:207], v[220:223], v[4:7], 0
    s_barrier
    ds_read_b64_tr_b16 v[220:221], v228 offset:12800
    ds_read_b64_tr_b16 v[222:223], v228 offset:13056
    s_waitcnt lgkmcnt(6)
    v_mfma_f32_16x16x32_bf16 v[144:147], v[208:211], v[8:11], v[144:147]
    v_mfma_f32_16x16x32_bf16 v[152:155], v[208:211], v[12:15], v[152:155]
    buffer_load_dwordx4 v[64:67], v240, s[44:47], s29 offen offset:0
    ds_read_b64_tr_b16 v[208:209], v229 offset:4096
    ds_read_b64_tr_b16 v[210:211], v229 offset:4352
    s_waitcnt lgkmcnt(6)
    v_mfma_f32_16x16x32_bf16 v[160:163], v[212:215], v[8:11], v[160:163]
    v_mfma_f32_16x16x32_bf16 v[168:171], v[212:215], v[12:15], v[168:171]
    ds_read_b64_tr_b16 v[212:213], v229 offset:4608
    ds_read_b64_tr_b16 v[214:215], v229 offset:4864
    s_waitcnt lgkmcnt(6)
    v_mfma_f32_16x16x32_bf16 v[176:179], v[216:219], v[8:11], v[176:179]
    v_mfma_f32_16x16x32_bf16 v[184:187], v[216:219], v[12:15], v[184:187]
    ds_read_b64_tr_b16 v[216:217], v229 offset:12288
    ds_read_b64_tr_b16 v[218:219], v229 offset:12544
    s_waitcnt lgkmcnt(6)
    v_mfma_f32_16x16x32_bf16 v[192:195], v[220:223], v[8:11], v[192:195]
    v_mfma_f32_16x16x32_bf16 v[200:203], v[220:223], v[12:15], v[200:203]
    ds_read_b64_tr_b16 v[220:221], v229 offset:12800
    ds_read_b64_tr_b16 v[222:223], v229 offset:13056
    s_waitcnt lgkmcnt(6)
    v_mfma_f32_16x16x32_bf16 v[148:151], v[208:211], v[8:11], v[148:151]
    v_mfma_f32_16x16x32_bf16 v[156:159], v[208:211], v[12:15], v[156:159]
    buffer_load_dwordx4 v[68:71], v240, s[44:47], s29 offen offset:256
    ds_read_b64_tr_b16 v[208:209], v228 offset:16384
    ds_read_b64_tr_b16 v[210:211], v228 offset:16640
    s_waitcnt lgkmcnt(6)
    v_mfma_f32_16x16x32_bf16 v[164:167], v[212:215], v[8:11], v[164:167]
    v_mfma_f32_16x16x32_bf16 v[172:175], v[212:215], v[12:15], v[172:175]
    ds_read_b64_tr_b16 v[212:213], v228 offset:16896
    ds_read_b64_tr_b16 v[214:215], v228 offset:17152
    s_waitcnt lgkmcnt(6)
    v_mfma_f32_16x16x32_bf16 v[180:183], v[216:219], v[8:11], v[180:183]
    v_mfma_f32_16x16x32_bf16 v[188:191], v[216:219], v[12:15], v[188:191]
    ds_read_b64_tr_b16 v[216:217], v228 offset:24576
    ds_read_b64_tr_b16 v[218:219], v228 offset:24832
    s_waitcnt lgkmcnt(6)
    v_mfma_f32_16x16x32_bf16 v[196:199], v[220:223], v[8:11], v[196:199]
    v_mfma_f32_16x16x32_bf16 v[204:207], v[220:223], v[12:15], v[204:207]
    s_waitcnt vmcnt(10)
    ds_read_b64_tr_b16 v[220:221], v228 offset:25088
    ds_read_b64_tr_b16 v[222:223], v228 offset:25344
    s_waitcnt lgkmcnt(6)
    v_mfma_f32_16x16x32_bf16 v[144:147], v[208:211], v[16:19], v[144:147]
    v_mfma_f32_16x16x32_bf16 v[152:155], v[208:211], v[20:23], v[152:155]
    buffer_load_dwordx4 v[72:75], v240, s[44:47], s29 offen offset:2048
    ds_read_b64_tr_b16 v[208:209], v229 offset:16384
    ds_read_b64_tr_b16 v[210:211], v229 offset:16640
    s_waitcnt lgkmcnt(6)
    v_mfma_f32_16x16x32_bf16 v[160:163], v[212:215], v[16:19], v[160:163]
    v_mfma_f32_16x16x32_bf16 v[168:171], v[212:215], v[20:23], v[168:171]
    ds_read_b64_tr_b16 v[212:213], v229 offset:16896
    ds_read_b64_tr_b16 v[214:215], v229 offset:17152
    s_waitcnt lgkmcnt(6)
    v_mfma_f32_16x16x32_bf16 v[176:179], v[216:219], v[16:19], v[176:179]
    v_mfma_f32_16x16x32_bf16 v[184:187], v[216:219], v[20:23], v[184:187]
    ds_read_b64_tr_b16 v[216:217], v229 offset:24576
    ds_read_b64_tr_b16 v[218:219], v229 offset:24832
    s_waitcnt lgkmcnt(6)
    v_mfma_f32_16x16x32_bf16 v[192:195], v[220:223], v[16:19], v[192:195]
    v_mfma_f32_16x16x32_bf16 v[200:203], v[220:223], v[20:23], v[200:203]
    ds_read_b64_tr_b16 v[220:221], v229 offset:25088
    ds_read_b64_tr_b16 v[222:223], v229 offset:25344
    s_waitcnt lgkmcnt(6)
    v_mfma_f32_16x16x32_bf16 v[148:151], v[208:211], v[16:19], v[148:151]
    v_mfma_f32_16x16x32_bf16 v[156:159], v[208:211], v[20:23], v[156:159]
    buffer_load_dwordx4 v[76:79], v240, s[44:47], s29 offen offset:2304
    s_add_u32 s29, s29, 4096
    ds_read_b64_tr_b16 v[208:209], v228 offset:20480
    ds_read_b64_tr_b16 v[210:211], v228 offset:20736
    s_waitcnt lgkmcnt(6)
    v_mfma_f32_16x16x32_bf16 v[164:167], v[212:215], v[16:19], v[164:167]
    v_mfma_f32_16x16x32_bf16 v[172:175], v[212:215], v[20:23], v[172:175]
    ds_read_b64_tr_b16 v[212:213], v228 offset:20992
    ds_read_b64_tr_b16 v[214:215], v228 offset:21248
    s_waitcnt lgkmcnt(6)
    v_mfma_f32_16x16x32_bf16 v[180:183], v[216:219], v[16:19], v[180:183]
    v_mfma_f32_16x16x32_bf16 v[188:191], v[216:219], v[20:23], v[188:191]
    ds_read_b64_tr_b16 v[216:217], v228 offset:28672
    ds_read_b64_tr_b16 v[218:219], v228 offset:28928
    s_waitcnt lgkmcnt(6)
    v_mfma_f32_16x16x32_bf16 v[196:199], v[220:223], v[16:19], v[196:199]
    v_mfma_f32_16x16x32_bf16 v[204:207], v[220:223], v[20:23], v[204:207]
    s_barrier
    ds_read_b64_tr_b16 v[220:221], v228 offset:29184
    ds_read_b64_tr_b16 v[222:223], v228 offset:29440
    s_waitcnt lgkmcnt(6)
    v_mfma_f32_16x16x32_bf16 v[144:147], v[208:211], v[24:27], v[144:147]
    v_mfma_f32_16x16x32_bf16 v[152:155], v[208:211], v[28:31], v[152:155]
    buffer_load_dwordx4 v[80:83], v240, s[44:47], s29 offen offset:0
    ds_read_b64_tr_b16 v[208:209], v229 offset:20480
    ds_read_b64_tr_b16 v[210:211], v229 offset:20736
    s_waitcnt lgkmcnt(6)
    v_mfma_f32_16x16x32_bf16 v[160:163], v[212:215], v[24:27], v[160:163]
    v_mfma_f32_16x16x32_bf16 v[168:171], v[212:215], v[28:31], v[168:171]
    ds_read_b64_tr_b16 v[212:213], v229 offset:20992
    ds_read_b64_tr_b16 v[214:215], v229 offset:21248
    s_waitcnt lgkmcnt(6)
    v_mfma_f32_16x16x32_bf16 v[176:179], v[216:219], v[24:27], v[176:179]
    v_mfma_f32_16x16x32_bf16 v[184:187], v[216:219], v[28:31], v[184:187]
    ds_read_b64_tr_b16 v[216:217], v229 offset:28672
    ds_read_b64_tr_b16 v[218:219], v229 offset:28928
    s_waitcnt lgkmcnt(6)
    v_mfma_f32_16x16x32_bf16 v[192:195], v[220:223], v[24:27], v[192:195]
    v_mfma_f32_16x16x32_bf16 v[200:203], v[220:223], v[28:31], v[200:203]
    buffer_load_dwordx4 v[84:87], v240, s[44:47], s29 offen offset:256
    ds_read_b64_tr_b16 v[220:221], v229 offset:29184
    ds_read_b64_tr_b16 v[222:223], v229 offset:29440
    s_waitcnt lgkmcnt(6)
    v_mfma_f32_16x16x32_bf16 v[148:151], v[208:211], v[24:27], v[148:151]
    v_mfma_f32_16x16x32_bf16 v[156:159], v[208:211], v[28:31], v[156:159]
    ds_read_b64_tr_b16 v[208:209], v228 offset:32768
    ds_read_b64_tr_b16 v[210:211], v228 offset:33024
    s_waitcnt lgkmcnt(6)
    v_mfma_f32_16x16x32_bf16 v[164:167], v[212:215], v[24:27], v[164:167]
    v_mfma_f32_16x16x32_bf16 v[172:175], v[212:215], v[28:31], v[172:175]
    buffer_load_dwordx4 v[88:91], v240, s[44:47], s29 offen offset:2048
    ds_read_b64_tr_b16 v[212:213], v228 offset:33280
    ds_read_b64_tr_b16 v[214:215], v228 offset:33536
    s_waitcnt lgkmcnt(6)
    v_mfma_f32_16x16x32_bf16 v[180:183], v[216:219], v[24:27], v[180:183]
    v_mfma_f32_16x16x32_bf16 v[188:191], v[216:219], v[28:31], v[188:191]
    ds_read_b64_tr_b16 v[216:217], v228 offset:40960
    ds_read_b64_tr_b16 v[218:219], v228 offset:41216
    s_waitcnt lgkmcnt(6)
    v_mfma_f32_16x16x32_bf16 v[196:199], v[220:223], v[24:27], v[196:199]
    v_mfma_f32_16x16x32_bf16 v[204:207], v[220:223], v[28:31], v[204:207]
    s_waitcnt vmcnt(11)
    ds_read_b64_tr_b16 v[220:221], v228 offset:41472
    ds_read_b64_tr_b16 v[222:223], v228 offset:41728
    s_waitcnt lgkmcnt(6)
    v_mfma_f32_16x16x32_bf16 v[144:147], v[208:211], v[32:35], v[144:147]
    v_mfma_f32_16x16x32_bf16 v[152:155], v[208:211], v[36:39], v[152:155]
    buffer_load_dwordx4 v[92:95], v240, s[44:47], s29 offen offset:2304
    s_add_u32 s29, s29, 4096
    ds_read_b64_tr_b16 v[208:209], v229 offset:32768
    ds_read_b64_tr_b16 v[210:211], v229 offset:33024
    s_waitcnt lgkmcnt(6)
    v_mfma_f32_16x16x32_bf16 v[160:163], v[212:215], v[32:35], v[160:163]
    v_mfma_f32_16x16x32_bf16 v[168:171], v[212:215], v[36:39], v[168:171]
    ds_read_b64_tr_b16 v[212:213], v229 offset:33280
    ds_read_b64_tr_b16 v[214:215], v229 offset:33536
    s_waitcnt lgkmcnt(6)
    v_mfma_f32_16x16x32_bf16 v[176:179], v[216:219], v[32:35], v[176:179]
    v_mfma_f32_16x16x32_bf16 v[184:187], v[216:219], v[36:39], v[184:187]
    s_add_u32 s25, s65, 0x2d0000
    s_add_u32 m0, s24, 81920
    s_nop 0
    buffer_load_dwordx4 v232, s[32:35], s25 offen lds
    ds_read_b64_tr_b16 v[216:217], v229 offset:40960
    ds_read_b64_tr_b16 v[218:219], v229 offset:41216
    s_waitcnt lgkmcnt(6)
    v_mfma_f32_16x16x32_bf16 v[192:195], v[220:223], v[32:35], v[192:195]
    v_mfma_f32_16x16x32_bf16 v[200:203], v[220:223], v[36:39], v[200:203]
    ds_read_b64_tr_b16 v[220:221], v229 offset:41472
    ds_read_b64_tr_b16 v[222:223], v229 offset:41728
    s_waitcnt lgkmcnt(6)
    v_mfma_f32_16x16x32_bf16 v[148:151], v[208:211], v[32:35], v[148:151]
    v_mfma_f32_16x16x32_bf16 v[156:159], v[208:211], v[36:39], v[156:159]
    ds_read_b64_tr_b16 v[208:209], v228 offset:36864
    ds_read_b64_tr_b16 v[210:211], v228 offset:37120
    s_waitcnt lgkmcnt(6)
    v_mfma_f32_16x16x32_bf16 v[164:167], v[212:215], v[32:35], v[164:167]
    v_mfma_f32_16x16x32_bf16 v[172:175], v[212:215], v[36:39], v[172:175]
    s_add_u32 s25, s65, 0x2d0000
    s_add_u32 m0, s24, 90112
    s_nop 0
    buffer_load_dwordx4 v232, s[36:39], s25 offen lds
    ds_read_b64_tr_b16 v[212:213], v228 offset:37376
    ds_read_b64_tr_b16 v[214:215], v228 offset:37632
    s_waitcnt lgkmcnt(6)
    v_mfma_f32_16x16x32_bf16 v[180:183], v[216:219], v[32:35], v[180:183]
    v_mfma_f32_16x16x32_bf16 v[188:191], v[216:219], v[36:39], v[188:191]
    ds_read_b64_tr_b16 v[216:217], v228 offset:45056
    ds_read_b64_tr_b16 v[218:219], v228 offset:45312
    s_waitcnt lgkmcnt(6)
    v_mfma_f32_16x16x32_bf16 v[196:199], v[220:223], v[32:35], v[196:199]
    v_mfma_f32_16x16x32_bf16 v[204:207], v[220:223], v[36:39], v[204:207]
    s_barrier
    ds_read_b64_tr_b16 v[220:221], v228 offset:45568
    ds_read_b64_tr_b16 v[222:223], v228 offset:45824
    s_waitcnt lgkmcnt(6)
    v_mfma_f32_16x16x32_bf16 v[144:147], v[208:211], v[40:43], v[144:147]
    v_mfma_f32_16x16x32_bf16 v[152:155], v[208:211], v[44:47], v[152:155]
    buffer_load_dwordx4 v[96:99], v240, s[44:47], s29 offen offset:0
    ds_read_b64_tr_b16 v[208:209], v229 offset:36864
    ds_read_b64_tr_b16 v[210:211], v229 offset:37120
    s_waitcnt lgkmcnt(6)
    v_mfma_f32_16x16x32_bf16 v[160:163], v[212:215], v[40:43], v[160:163]
    v_mfma_f32_16x16x32_bf16 v[168:171], v[212:215], v[44:47], v[168:171]
    ds_read_b64_tr_b16 v[212:213], v229 offset:37376
    ds_read_b64_tr_b16 v[214:215], v229 offset:37632
    s_waitcnt lgkmcnt(6)
    v_mfma_f32_16x16x32_bf16 v[176:179], v[216:219], v[40:43], v[176:179]
    v_mfma_f32_16x16x32_bf16 v[184:187], v[216:219], v[44:47], v[184:187]
    buffer_load_dwordx4 v[100:103], v240, s[44:47], s29 offen offset:256
    ds_read_b64_tr_b16 v[216:217], v229 offset:45056
    ds_read_b64_tr_b16 v[218:219], v229 offset:45312
    s_waitcnt lgkmcnt(6)
    v_mfma_f32_16x16x32_bf16 v[192:195], v[220:223], v[40:43], v[192:195]
    v_mfma_f32_16x16x32_bf16 v[200:203], v[220:223], v[44:47], v[200:203]
    ds_read_b64_tr_b16 v[220:221], v229 offset:45568
    ds_read_b64_tr_b16 v[222:223], v229 offset:45824
    s_waitcnt lgkmcnt(6)
    v_mfma_f32_16x16x32_bf16 v[148:151], v[208:211], v[40:43], v[148:151]
    v_mfma_f32_16x16x32_bf16 v[156:159], v[208:211], v[44:47], v[156:159]
    buffer_load_dwordx4 v[104:107], v240, s[44:47], s29 offen offset:2048
    ds_read_b64_tr_b16 v[208:209], v228 offset:49152
    ds_read_b64_tr_b16 v[210:211], v228 offset:49408
    s_waitcnt lgkmcnt(6)
    v_mfma_f32_16x16x32_bf16 v[164:167], v[212:215], v[40:43], v[164:167]
    v_mfma_f32_16x16x32_bf16 v[172:175], v[212:215], v[44:47], v[172:175]
    ds_read_b64_tr_b16 v[212:213], v228 offset:49664
    ds_read_b64_tr_b16 v[214:215], v228 offset:49920
    s_waitcnt lgkmcnt(6)
    v_mfma_f32_16x16x32_bf16 v[180:183], v[216:219], v[40:43], v[180:183]
    v_mfma_f32_16x16x32_bf16 v[188:191], v[216:219], v[44:47], v[188:191]
    buffer_load_dwordx4 v[108:111], v240, s[44:47], s29 offen offset:2304
    s_add_u32 s29, s29, 4096
    ds_read_b64_tr_b16 v[216:217], v228 offset:57344
    ds_read_b64_tr_b16 v[218:219], v228 offset:57600
    s_waitcnt lgkmcnt(6)
    v_mfma_f32_16x16x32_bf16 v[196:199], v[220:223], v[40:43], v[196:199]
    v_mfma_f32_16x16x32_bf16 v[204:207], v[220:223], v[44:47], v[204:207]
    s_add_u32 s25, s65, 0x360000
    s_add_u32 m0, s24, 98304
    s_nop 0
    buffer_load_dwordx4 v232, s[32:35], s25 offen lds
    s_waitcnt vmcnt(15)
    ds_read_b64_tr_b16 v[220:221], v228 offset:57856
    ds_read_b64_tr_b16 v[222:223], v228 offset:58112
    s_waitcnt lgkmcnt(6)
    v_mfma_f32_16x16x32_bf16 v[144:147], v[208:211], v[48:51], v[144:147]
    v_mfma_f32_16x16x32_bf16 v[152:155], v[208:211], v[52:55], v[152:155]
    ds_read_b64_tr_b16 v[208:209], v229 offset:49152
    ds_read_b64_tr_b16 v[210:211], v229 offset:49408
    s_waitcnt lgkmcnt(6)
    v_mfma_f32_16x16x32_bf16 v[160:163], v[212:215], v[48:51], v[160:163]
    v_mfma_f32_16x16x32_bf16 v[168:171], v[212:215], v[52:55], v[168:171]
    s_add_u32 s25, s65, 0x360000
    s_add_u32 m0, s24, 106496
    s_nop 0
    buffer_load_dwordx4 v232, s[36:39], s25 offen lds
    ds_read_b64_tr_b16 v[212:213], v229 offset:49664
    ds_read_b64_tr_b16 v[214:215], v229 offset:49920
    s_waitcnt lgkmcnt(6)
    v_mfma_f32_16x16x32_bf16 v[176:179], v[216:219], v[48:51], v[176:179]
    v_mfma_f32_16x16x32_bf16 v[184:187], v[216:219], v[52:55], v[184:187]
    ds_read_b64_tr_b16 v[216:217], v229 offset:57344
    ds_read_b64_tr_b16 v[218:219], v229 offset:57600
    s_waitcnt lgkmcnt(6)
    v_mfma_f32_16x16x32_bf16 v[192:195], v[220:223], v[48:51], v[192:195]
    v_mfma_f32_16x16x32_bf16 v[200:203], v[220:223], v[52:55], v[200:203]
    s_add_u32 s25, s65, 0x3f0000
    s_add_u32 m0, s24, 0
    s_nop 0
    buffer_load_dwordx4 v232, s[32:35], s25 offen lds
    ds_read_b64_tr_b16 v[220:221], v229 offset:57856
    ds_read_b64_tr_b16 v[222:223], v229 offset:58112
    s_waitcnt lgkmcnt(6)
    v_mfma_f32_16x16x32_bf16 v[148:151], v[208:211], v[48:51], v[148:151]
    v_mfma_f32_16x16x32_bf16 v[156:159], v[208:211], v[52:55], v[156:159]
    ds_read_b64_tr_b16 v[208:209], v228 offset:53248
    ds_read_b64_tr_b16 v[210:211], v228 offset:53504
    s_waitcnt lgkmcnt(6)
    v_mfma_f32_16x16x32_bf16 v[164:167], v[212:215], v[48:51], v[164:167]
    v_mfma_f32_16x16x32_bf16 v[172:175], v[212:215], v[52:55], v[172:175]
    s_add_u32 s25, s65, 0x3f0000
    s_add_u32 m0, s24, 8192
    s_nop 0
    buffer_load_dwordx4 v232, s[36:39], s25 offen lds
    ds_read_b64_tr_b16 v[212:213], v228 offset:53760
    ds_read_b64_tr_b16 v[214:215], v228 offset:54016
    s_waitcnt lgkmcnt(6)
    v_mfma_f32_16x16x32_bf16 v[180:183], v[216:219], v[48:51], v[180:183]
    v_mfma_f32_16x16x32_bf16 v[188:191], v[216:219], v[52:55], v[188:191]
    ds_read_b64_tr_b16 v[216:217], v228 offset:61440
    ds_read_b64_tr_b16 v[218:219], v228 offset:61696
    s_waitcnt lgkmcnt(6)
    v_mfma_f32_16x16x32_bf16 v[196:199], v[220:223], v[48:51], v[196:199]
    v_mfma_f32_16x16x32_bf16 v[204:207], v[220:223], v[52:55], v[204:207]
    s_barrier
    ds_read_b64_tr_b16 v[220:221], v228 offset:61952
    ds_read_b64_tr_b16 v[222:223], v228 offset:62208
    s_waitcnt lgkmcnt(6)
    v_mfma_f32_16x16x32_bf16 v[144:147], v[208:211], v[56:59], v[144:147]
    v_mfma_f32_16x16x32_bf16 v[152:155], v[208:211], v[60:63], v[152:155]
    buffer_load_dwordx4 v[112:115], v240, s[44:47], s29 offen offset:0
    ds_read_b64_tr_b16 v[208:209], v229 offset:53248
    ds_read_b64_tr_b16 v[210:211], v229 offset:53504
    s_waitcnt lgkmcnt(6)
    v_mfma_f32_16x16x32_bf16 v[160:163], v[212:215], v[56:59], v[160:163]
    v_mfma_f32_16x16x32_bf16 v[168:171], v[212:215], v[60:63], v[168:171]
    ds_read_b64_tr_b16 v[212:213], v229 offset:53760
    ds_read_b64_tr_b16 v[214:215], v229 offset:54016
    s_waitcnt lgkmcnt(6)
    v_mfma_f32_16x16x32_bf16 v[176:179], v[216:219], v[56:59], v[176:179]
    v_mfma_f32_16x16x32_bf16 v[184:187], v[216:219], v[60:63], v[184:187]
    ds_read_b64_tr_b16 v[216:217], v229 offset:61440
    ds_read_b64_tr_b16 v[218:219], v229 offset:61696
    s_waitcnt lgkmcnt(6)
    v_mfma_f32_16x16x32_bf16 v[192:195], v[220:223], v[56:59], v[192:195]
    v_mfma_f32_16x16x32_bf16 v[200:203], v[220:223], v[60:63], v[200:203]
    buffer_load_dwordx4 v[116:119], v240, s[44:47], s29 offen offset:256
    ds_read_b64_tr_b16 v[220:221], v229 offset:61952
    ds_read_b64_tr_b16 v[222:223], v229 offset:62208
    s_waitcnt lgkmcnt(6)
    v_mfma_f32_16x16x32_bf16 v[148:151], v[208:211], v[56:59], v[148:151]
    v_mfma_f32_16x16x32_bf16 v[156:159], v[208:211], v[60:63], v[156:159]
    v_xor_b32 v228, 0x10000, v228
    v_xor_b32 v229, 0x10000, v229
    v_xor_b32 v230, 0x10000, v230
    v_xor_b32 v231, 0x10000, v231
    v_xor_b32 v249, 0x10000, v249
    ds_read_b64_tr_b16 v[208:209], v228 offset:0
    ds_read_b64_tr_b16 v[210:211], v228 offset:256
    s_waitcnt lgkmcnt(6)
    v_mfma_f32_16x16x32_bf16 v[164:167], v[212:215], v[56:59], v[164:167]
    v_mfma_f32_16x16x32_bf16 v[172:175], v[212:215], v[60:63], v[172:175]
    buffer_load_dwordx4 v[120:123], v240, s[44:47], s29 offen offset:2048
    ds_read_b64_tr_b16 v[212:213], v228 offset:512
    ds_read_b64_tr_b16 v[214:215], v228 offset:768
    s_waitcnt lgkmcnt(6)
    v_mfma_f32_16x16x32_bf16 v[180:183], v[216:219], v[56:59], v[180:183]
    v_mfma_f32_16x16x32_bf16 v[188:191], v[216:219], v[60:63], v[188:191]
    ds_read_b64_tr_b16 v[216:217], v228 offset:8192
    ds_read_b64_tr_b16 v[218:219], v228 offset:8448
    s_waitcnt lgkmcnt(6)
    v_mfma_f32_16x16x32_bf16 v[196:199], v[220:223], v[56:59], v[196:199]
    v_mfma_f32_16x16x32_bf16 v[204:207], v[220:223], v[60:63], v[204:207]
    s_waitcnt vmcnt(17)
    ds_read_b64_tr_b16 v[220:221], v228 offset:8704
    ds_read_b64_tr_b16 v[222:223], v228 offset:8960
    s_waitcnt lgkmcnt(6)
    v_mfma_f32_16x16x32_bf16 v[144:147], v[208:211], v[64:67], v[144:147]
    v_mfma_f32_16x16x32_bf16 v[152:155], v[208:211], v[68:71], v[152:155]
    buffer_load_dwordx4 v[124:127], v240, s[44:47], s29 offen offset:2304
    s_add_u32 s29, s29, 4096
    ds_read_b64_tr_b16 v[208:209], v229 offset:0
    ds_read_b64_tr_b16 v[210:211], v229 offset:256
    s_waitcnt lgkmcnt(6)
    v_mfma_f32_16x16x32_bf16 v[160:163], v[212:215], v[64:67], v[160:163]
    v_mfma_f32_16x16x32_bf16 v[168:171], v[212:215], v[68:71], v[168:171]
    ds_read_b64_tr_b16 v[212:213], v229 offset:512
    ds_read_b64_tr_b16 v[214:215], v229 offset:768
    s_waitcnt lgkmcnt(6)
    v_mfma_f32_16x16x32_bf16 v[176:179], v[216:219], v[64:67], v[176:179]
    v_mfma_f32_16x16x32_bf16 v[184:187], v[216:219], v[68:71], v[184:187]
    s_add_u32 s25, s65, 0x480000
    s_add_u32 m0, s24, 16384
    s_nop 0
    buffer_load_dwordx4 v232, s[32:35], s25 offen lds
    ds_read_b64_tr_b16 v[216:217], v229 offset:8192
    ds_read_b64_tr_b16 v[218:219], v229 offset:8448
    s_waitcnt lgkmcnt(6)
    v_mfma_f32_16x16x32_bf16 v[192:195], v[220:223], v[64:67], v[192:195]
    v_mfma_f32_16x16x32_bf16 v[200:203], v[220:223], v[68:71], v[200:203]
    ds_read_b64_tr_b16 v[220:221], v229 offset:8704
    ds_read_b64_tr_b16 v[222:223], v229 offset:8960
    s_waitcnt lgkmcnt(6)
    v_mfma_f32_16x16x32_bf16 v[148:151], v[208:211], v[64:67], v[148:151]
    v_mfma_f32_16x16x32_bf16 v[156:159], v[208:211], v[68:71], v[156:159]
    ds_read_b64_tr_b16 v[208:209], v228 offset:4096
    ds_read_b64_tr_b16 v[210:211], v228 offset:4352
    s_waitcnt lgkmcnt(6)
    v_mfma_f32_16x16x32_bf16 v[164:167], v[212:215], v[64:67], v[164:167]
    v_mfma_f32_16x16x32_bf16 v[172:175], v[212:215], v[68:71], v[172:175]
    s_add_u32 s25, s65, 0x480000
    s_add_u32 m0, s24, 24576
    s_nop 0
    buffer_load_dwordx4 v232, s[36:39], s25 offen lds
    ds_read_b64_tr_b16 v[212:213], v228 offset:4608
    ds_read_b64_tr_b16 v[214:215], v228 offset:4864
    s_waitcnt lgkmcnt(6)
    v_mfma_f32_16x16x32_bf16 v[180:183], v[216:219], v[64:67], v[180:183]
    v_mfma_f32_16x16x32_bf16 v[188:191], v[216:219], v[68:71], v[188:191]
    ds_read_b64_tr_b16 v[216:217], v228 offset:12288
    ds_read_b64_tr_b16 v[218:219], v228 offset:12544
    s_waitcnt lgkmcnt(6)
    v_mfma_f32_16x16x32_bf16 v[196:199], v[220:223], v[64:67], v[196:199]
    v_mfma_f32_16x16x32_bf16 v[204:207], v[220:223], v[68:71], v[204:207]
    s_waitcnt vmcnt(14)
    s_barrier
    ds_read_b64_tr_b16 v[220:221], v228 offset:12800
    ds_read_b64_tr_b16 v[222:223], v228 offset:13056
    s_waitcnt lgkmcnt(6)
    v_mfma_f32_16x16x32_bf16 v[144:147], v[208:211], v[72:75], v[144:147]
    v_mfma_f32_16x16x32_bf16 v[152:155], v[208:211], v[76:79], v[152:155]
    buffer_load_dwordx4 v[128:131], v240, s[44:47], s29 offen offset:0
    ds_read_b64_tr_b16 v[208:209], v229 offset:4096
    ds_read_b64_tr_b16 v[210:211], v229 offset:4352
    s_waitcnt lgkmcnt(6)
    v_mfma_f32_16x16x32_bf16 v[160:163], v[212:215], v[72:75], v[160:163]
    v_mfma_f32_16x16x32_bf16 v[168:171], v[212:215], v[76:79], v[168:171]
    ds_read_b64_tr_b16 v[212:213], v229 offset:4608
    ds_read_b64_tr_b16 v[214:215], v229 offset:4864
    s_waitcnt lgkmcnt(6)
    v_mfma_f32_16x16x32_bf16 v[176:179], v[216:219], v[72:75], v[176:179]
    v_mfma_f32_16x16x32_bf16 v[184:187], v[216:219], v[76:79], v[184:187]
    ds_read_b64_tr_b16 v[216:217], v229 offset:12288
    ds_read_b64_tr_b16 v[218:219], v229 offset:12544
    s_waitcnt lgkmcnt(6)
    v_mfma_f32_16x16x32_bf16 v[192:195], v[220:223], v[72:75], v[192:195]
    v_mfma_f32_16x16x32_bf16 v[200:203], v[220:223], v[76:79], v[200:203]
    ds_read_b64_tr_b16 v[220:221], v229 offset:12800
    ds_read_b64_tr_b16 v[222:223], v229 offset:13056
    s_waitcnt lgkmcnt(6)
    v_mfma_f32_16x16x32_bf16 v[148:151], v[208:211], v[72:75], v[148:151]
    v_mfma_f32_16x16x32_bf16 v[156:159], v[208:211], v[76:79], v[156:159]
    buffer_load_dwordx4 v[132:135], v240, s[44:47], s29 offen offset:256
    ds_read_b64_tr_b16 v[208:209], v228 offset:16384
    ds_read_b64_tr_b16 v[210:211], v228 offset:16640
    s_waitcnt lgkmcnt(6)
    v_mfma_f32_16x16x32_bf16 v[164:167], v[212:215], v[72:75], v[164:167]
    v_mfma_f32_16x16x32_bf16 v[172:175], v[212:215], v[76:79], v[172:175]
    ds_read_b64_tr_b16 v[212:213], v228 offset:16896
    ds_read_b64_tr_b16 v[214:215], v228 offset:17152
    s_waitcnt lgkmcnt(6)
    v_mfma_f32_16x16x32_bf16 v[180:183], v[216:219], v[72:75], v[180:183]
    v_mfma_f32_16x16x32_bf16 v[188:191], v[216:219], v[76:79], v[188:191]
    ds_read_b64_tr_b16 v[216:217], v228 offset:24576
    ds_read_b64_tr_b16 v[218:219], v228 offset:24832
    s_waitcnt lgkmcnt(6)
    v_mfma_f32_16x16x32_bf16 v[196:199], v[220:223], v[72:75], v[196:199]
    v_mfma_f32_16x16x32_bf16 v[204:207], v[220:223], v[76:79], v[204:207]
    ds_read_b64_tr_b16 v[220:221], v228 offset:25088
    ds_read_b64_tr_b16 v[222:223], v228 offset:25344
    s_waitcnt lgkmcnt(6)
    v_mfma_f32_16x16x32_bf16 v[144:147], v[208:211], v[80:83], v[144:147]
    v_mfma_f32_16x16x32_bf16 v[152:155], v[208:211], v[84:87], v[152:155]
    buffer_load_dwordx4 v[136:139], v240, s[44:47], s29 offen offset:2048
    ds_read_b64_tr_b16 v[208:209], v229 offset:16384
    ds_read_b64_tr_b16 v[210:211], v229 offset:16640
    s_waitcnt lgkmcnt(6)
    v_mfma_f32_16x16x32_bf16 v[160:163], v[212:215], v[80:83], v[160:163]
    v_mfma_f32_16x16x32_bf16 v[168:171], v[212:215], v[84:87], v[168:171]
    ds_read_b64_tr_b16 v[212:213], v229 offset:16896
    ds_read_b64_tr_b16 v[214:215], v229 offset:17152
    s_waitcnt lgkmcnt(6)
    v_mfma_f32_16x16x32_bf16 v[176:179], v[216:219], v[80:83], v[176:179]
    v_mfma_f32_16x16x32_bf16 v[184:187], v[216:219], v[84:87], v[184:187]
    ds_read_b64_tr_b16 v[216:217], v229 offset:24576
    ds_read_b64_tr_b16 v[218:219], v229 offset:24832
    s_waitcnt lgkmcnt(6)
    v_mfma_f32_16x16x32_bf16 v[192:195], v[220:223], v[80:83], v[192:195]
    v_mfma_f32_16x16x32_bf16 v[200:203], v[220:223], v[84:87], v[200:203]
    ds_read_b64_tr_b16 v[220:221], v229 offset:25088
    ds_read_b64_tr_b16 v[222:223], v229 offset:25344
    s_waitcnt lgkmcnt(6)
    v_mfma_f32_16x16x32_bf16 v[148:151], v[208:211], v[80:83], v[148:151]
    v_mfma_f32_16x16x32_bf16 v[156:159], v[208:211], v[84:87], v[156:159]
    buffer_load_dwordx4 v[140:143], v240, s[44:47], s29 offen offset:2304
    s_add_u32 s29, s29, 4096
    ds_read_b64_tr_b16 v[208:209], v228 offset:20480
    ds_read_b64_tr_b16 v[210:211], v228 offset:20736
    s_waitcnt lgkmcnt(6)
    v_mfma_f32_16x16x32_bf16 v[164:167], v[212:215], v[80:83], v[164:167]
    v_mfma_f32_16x16x32_bf16 v[172:175], v[212:215], v[84:87], v[172:175]
    ds_read_b64_tr_b16 v[212:213], v228 offset:20992
    ds_read_b64_tr_b16 v[214:215], v228 offset:21248
    s_waitcnt lgkmcnt(6)
    v_mfma_f32_16x16x32_bf16 v[180:183], v[216:219], v[80:83], v[180:183]
    v_mfma_f32_16x16x32_bf16 v[188:191], v[216:219], v[84:87], v[188:191]
    ds_read_b64_tr_b16 v[216:217], v228 offset:28672
    ds_read_b64_tr_b16 v[218:219], v228 offset:28928
    s_waitcnt lgkmcnt(6)
    v_mfma_f32_16x16x32_bf16 v[196:199], v[220:223], v[80:83], v[196:199]
    v_mfma_f32_16x16x32_bf16 v[204:207], v[220:223], v[84:87], v[204:207]
    s_waitcnt vmcnt(10)
    s_barrier
    ds_read_b64_tr_b16 v[220:221], v228 offset:29184
    ds_read_b64_tr_b16 v[222:223], v228 offset:29440
    s_waitcnt lgkmcnt(6)
    v_mfma_f32_16x16x32_bf16 v[144:147], v[208:211], v[88:91], v[144:147]
    v_mfma_f32_16x16x32_bf16 v[152:155], v[208:211], v[92:95], v[152:155]
    s_add_u32 s25, s65, 0x80
    s_add_u32 m0, s24, 32768
    s_nop 0
    buffer_load_dwordx4 v232, s[32:35], s25 offen lds
    ds_read_b64_tr_b16 v[208:209], v229 offset:20480
    ds_read_b64_tr_b16 v[210:211], v229 offset:20736
    s_waitcnt lgkmcnt(6)
    v_mfma_f32_16x16x32_bf16 v[160:163], v[212:215], v[88:91], v[160:163]
    v_mfma_f32_16x16x32_bf16 v[168:171], v[212:215], v[92:95], v[168:171]
    ds_read_b64_tr_b16 v[212:213], v229 offset:20992
    ds_read_b64_tr_b16 v[214:215], v229 offset:21248
    s_waitcnt lgkmcnt(6)
    v_mfma_f32_16x16x32_bf16 v[176:179], v[216:219], v[88:91], v[176:179]
    v_mfma_f32_16x16x32_bf16 v[184:187], v[216:219], v[92:95], v[184:187]
    ds_read_b64_tr_b16 v[216:217], v229 offset:28672
    ds_read_b64_tr_b16 v[218:219], v229 offset:28928
    s_waitcnt lgkmcnt(6)
    v_mfma_f32_16x16x32_bf16 v[192:195], v[220:223], v[88:91], v[192:195]
    v_mfma_f32_16x16x32_bf16 v[200:203], v[220:223], v[92:95], v[200:203]
    s_add_u32 s25, s65, 0x80
    s_add_u32 m0, s24, 40960
    s_nop 0
    buffer_load_dwordx4 v232, s[36:39], s25 offen lds
    ds_read_b64_tr_b16 v[220:221], v229 offset:29184
    ds_read_b64_tr_b16 v[222:223], v229 offset:29440
    s_waitcnt lgkmcnt(6)
    v_mfma_f32_16x16x32_bf16 v[148:151], v[208:211], v[88:91], v[148:151]
    v_mfma_f32_16x16x32_bf16 v[156:159], v[208:211], v[92:95], v[156:159]
    ds_read_b64_tr_b16 v[208:209], v228 offset:32768
    ds_read_b64_tr_b16 v[210:211], v228 offset:33024
    s_waitcnt lgkmcnt(6)
    v_mfma_f32_16x16x32_bf16 v[164:167], v[212:215], v[88:91], v[164:167]
    v_mfma_f32_16x16x32_bf16 v[172:175], v[212:215], v[92:95], v[172:175]
    ds_read_b64_tr_b16 v[212:213], v228 offset:40960
    ds_read_b64_tr_b16 v[214:215], v228 offset:41216
    s_waitcnt lgkmcnt(6)
    v_mfma_f32_16x16x32_bf16 v[180:183], v[216:219], v[88:91], v[180:183]
    v_mfma_f32_16x16x32_bf16 v[188:191], v[216:219], v[92:95], v[188:191]
    s_add_u32 s25, s65, 0x90080
    s_add_u32 m0, s24, 49152
    s_nop 0
    buffer_load_dwordx4 v232, s[32:35], s25 offen lds
    ds_read_b64_tr_b16 v[216:217], v229 offset:32768
    ds_read_b64_tr_b16 v[218:219], v229 offset:33024
    s_waitcnt lgkmcnt(6)
    v_mfma_f32_16x16x32_bf16 v[196:199], v[220:223], v[88:91], v[196:199]
    v_mfma_f32_16x16x32_bf16 v[204:207], v[220:223], v[92:95], v[204:207]
    ds_read_b64_tr_b16 v[220:221], v229 offset:40960
    ds_read_b64_tr_b16 v[222:223], v229 offset:41216
    s_waitcnt lgkmcnt(6)
    v_mfma_f32_16x16x32_bf16 v[144:147], v[208:211], v[96:99], v[144:147]
    v_mfma_f32_16x16x32_bf16 v[152:155], v[208:211], v[100:103], v[152:155]
    ds_read_b64_tr_b16 v[208:209], v228 offset:36864
    ds_read_b64_tr_b16 v[210:211], v228 offset:37120
    s_waitcnt lgkmcnt(6)
    v_mfma_f32_16x16x32_bf16 v[176:179], v[212:215], v[96:99], v[176:179]
    v_mfma_f32_16x16x32_bf16 v[184:187], v[212:215], v[100:103], v[184:187]
    s_add_u32 s25, s65, 0x90080
    s_add_u32 m0, s24, 57344
    s_nop 0
    buffer_load_dwordx4 v232, s[36:39], s25 offen lds
    ds_read_b64_tr_b16 v[212:213], v228 offset:45056
    ds_read_b64_tr_b16 v[214:215], v228 offset:45312
    s_waitcnt lgkmcnt(6)
    v_mfma_f32_16x16x32_bf16 v[148:151], v[216:219], v[96:99], v[148:151]
    v_mfma_f32_16x16x32_bf16 v[156:159], v[216:219], v[100:103], v[156:159]
    ds_read_b64_tr_b16 v[216:217], v229 offset:36864
    ds_read_b64_tr_b16 v[218:219], v229 offset:37120
    s_waitcnt lgkmcnt(6)
    v_mfma_f32_16x16x32_bf16 v[180:183], v[220:223], v[96:99], v[180:183]
    v_mfma_f32_16x16x32_bf16 v[188:191], v[220:223], v[100:103], v[188:191]
    ds_read_b64_tr_b16 v[220:221], v229 offset:45056
    ds_read_b64_tr_b16 v[222:223], v229 offset:45312
    s_waitcnt lgkmcnt(6)
    v_mfma_f32_16x16x32_bf16 v[144:147], v[208:211], v[104:107], v[144:147]
    v_mfma_f32_16x16x32_bf16 v[152:155], v[208:211], v[108:111], v[152:155]
    s_lshl_b32 s74, s22, 3
    s_add_u32 s74, s74, s3
    s_mul_i32 s74, s74, 82944
    s_add_u32 s74, s74, s65
    v_mul_u32_u24 v237, 0x240, v238
    s_mov_b64 exec, 0x1ff
    buffer_load_dword v224, v237, s[32:35], s74 offen offset:128
    buffer_load_dword v224, v237, s[36:39], s74 offen offset:128
    s_mov_b64 exec, -1
    v_xor_b32 v228, 0x10000, v228
    v_xor_b32 v229, 0x10000, v229
    v_xor_b32 v230, 0x10000, v230
    v_xor_b32 v231, 0x10000, v231
    v_xor_b32 v249, 0x10000, v249
    ds_read_b64_tr_b16 v[208:209], v228 offset:0
    ds_read_b64_tr_b16 v[210:211], v228 offset:256
    s_waitcnt lgkmcnt(6)
    v_mfma_f32_16x16x32_bf16 v[176:179], v[212:215], v[104:107], v[176:179]
    v_mfma_f32_16x16x32_bf16 v[184:187], v[212:215], v[108:111], v[184:187]
    ds_read_b64_tr_b16 v[212:213], v228 offset:8192
    ds_read_b64_tr_b16 v[214:215], v228 offset:8448
    s_waitcnt lgkmcnt(6)
    v_mfma_f32_16x16x32_bf16 v[148:151], v[216:219], v[104:107], v[148:151]
    v_mfma_f32_16x16x32_bf16 v[156:159], v[216:219], v[108:111], v[156:159]
    ds_read_b64_tr_b16 v[216:217], v229 offset:0
    ds_read_b64_tr_b16 v[218:219], v229 offset:256
    s_waitcnt lgkmcnt(6)
    v_mfma_f32_16x16x32_bf16 v[180:183], v[220:223], v[104:107], v[180:183]
    v_mfma_f32_16x16x32_bf16 v[188:191], v[220:223], v[108:111], v[188:191]
    s_waitcnt vmcnt(10)
    s_barrier
    ds_read_b64_tr_b16 v[220:221], v229 offset:8192
    ds_read_b64_tr_b16 v[222:223], v229 offset:8448
    s_waitcnt lgkmcnt(6)
    v_mfma_f32_16x16x32_bf16 v[144:147], v[208:211], v[112:115], v[144:147]
    v_mfma_f32_16x16x32_bf16 v[152:155], v[208:211], v[116:119], v[152:155]
    s_add_u32 s25, s65, 0x120080
    s_add_u32 m0, s24, 65536
    s_nop 0
    buffer_load_dwordx4 v232, s[32:35], s25 offen lds
    ds_read_b64_tr_b16 v[208:209], v228 offset:4096
    ds_read_b64_tr_b16 v[210:211], v228 offset:4352
    s_waitcnt lgkmcnt(6)
    v_mfma_f32_16x16x32_bf16 v[176:179], v[212:215], v[112:115], v[176:179]
    v_mfma_f32_16x16x32_bf16 v[184:187], v[212:215], v[116:119], v[184:187]
    ds_read_b64_tr_b16 v[212:213], v228 offset:12288
    ds_read_b64_tr_b16 v[214:215], v228 offset:12544
    s_waitcnt lgkmcnt(6)
    v_mfma_f32_16x16x32_bf16 v[148:151], v[216:219], v[112:115], v[148:151]
    v_mfma_f32_16x16x32_bf16 v[156:159], v[216:219], v[116:119], v[156:159]
    ds_read_b64_tr_b16 v[216:217], v229 offset:4096
    ds_read_b64_tr_b16 v[218:219], v229 offset:4352
    s_waitcnt lgkmcnt(6)
    v_mfma_f32_16x16x32_bf16 v[180:183], v[220:223], v[112:115], v[180:183]
    v_mfma_f32_16x16x32_bf16 v[188:191], v[220:223], v[116:119], v[188:191]
    ds_read_b64_tr_b16 v[220:221], v229 offset:12288
    ds_read_b64_tr_b16 v[222:223], v229 offset:12544
    s_waitcnt lgkmcnt(6)
    v_mfma_f32_16x16x32_bf16 v[144:147], v[208:211], v[120:123], v[144:147]
    v_mfma_f32_16x16x32_bf16 v[152:155], v[208:211], v[124:127], v[152:155]
    s_add_u32 s25, s65, 0x120080
    s_add_u32 m0, s24, 73728
    s_nop 0
    buffer_load_dwordx4 v232, s[36:39], s25 offen lds
    ds_read_b64_tr_b16 v[208:209], v228 offset:16384
    ds_read_b64_tr_b16 v[210:211], v228 offset:16640
    s_waitcnt lgkmcnt(6)
    v_mfma_f32_16x16x32_bf16 v[176:179], v[212:215], v[120:123], v[176:179]
    v_mfma_f32_16x16x32_bf16 v[184:187], v[212:215], v[124:127], v[184:187]
    ds_read_b64_tr_b16 v[212:213], v228 offset:24576
    ds_read_b64_tr_b16 v[214:215], v228 offset:24832
    s_waitcnt lgkmcnt(6)
    v_mfma_f32_16x16x32_bf16 v[148:151], v[216:219], v[120:123], v[148:151]
    v_mfma_f32_16x16x32_bf16 v[156:159], v[216:219], v[124:127], v[156:159]
    ds_read_b64_tr_b16 v[216:217], v229 offset:16384
    ds_read_b64_tr_b16 v[218:219], v229 offset:16640
    s_waitcnt lgkmcnt(6)
    v_mfma_f32_16x16x32_bf16 v[180:183], v[220:223], v[120:123], v[180:183]
    v_mfma_f32_16x16x32_bf16 v[188:191], v[220:223], v[124:127], v[188:191]
    s_waitcnt vmcnt(8)
    ds_read_b64_tr_b16 v[220:221], v229 offset:24576
    ds_read_b64_tr_b16 v[222:223], v229 offset:24832
    s_waitcnt lgkmcnt(6)
    v_mfma_f32_16x16x32_bf16 v[144:147], v[208:211], v[128:131], v[144:147]
    v_mfma_f32_16x16x32_bf16 v[152:155], v[208:211], v[132:135], v[152:155]
    s_add_u32 s25, s65, 0x1b0080
    s_add_u32 m0, s24, 81920
    s_nop 0
    buffer_load_dwordx4 v232, s[32:35], s25 offen lds
    ds_read_b64_tr_b16 v[208:209], v228 offset:20480
    ds_read_b64_tr_b16 v[210:211], v228 offset:20736
    s_waitcnt lgkmcnt(6)
    v_mfma_f32_16x16x32_bf16 v[176:179], v[212:215], v[128:131], v[176:179]
    v_mfma_f32_16x16x32_bf16 v[184:187], v[212:215], v[132:135], v[184:187]
    ds_read_b64_tr_b16 v[212:213], v228 offset:28672
    ds_read_b64_tr_b16 v[214:215], v228 offset:28928
    s_waitcnt lgkmcnt(6)
    v_mfma_f32_16x16x32_bf16 v[148:151], v[216:219], v[128:131], v[148:151]
    v_mfma_f32_16x16x32_bf16 v[156:159], v[216:219], v[132:135], v[156:159]
    ds_read_b64_tr_b16 v[216:217], v229 offset:20480
    ds_read_b64_tr_b16 v[218:219], v229 offset:20736
    s_waitcnt lgkmcnt(6)
    v_mfma_f32_16x16x32_bf16 v[180:183], v[220:223], v[128:131], v[180:183]
    v_mfma_f32_16x16x32_bf16 v[188:191], v[220:223], v[132:135], v[188:191]
    ds_read_b64_tr_b16 v[220:221], v229 offset:28672
    ds_read_b64_tr_b16 v[222:223], v229 offset:28928
    s_waitcnt lgkmcnt(6)
    v_mfma_f32_16x16x32_bf16 v[144:147], v[208:211], v[136:139], v[144:147]
    v_mfma_f32_16x16x32_bf16 v[152:155], v[208:211], v[140:143], v[152:155]
    s_add_u32 s25, s65, 0x1b0080
    s_add_u32 m0, s24, 90112
    s_nop 0
    buffer_load_dwordx4 v232, s[36:39], s25 offen lds
    v_xor_b32 v228, 0x10000, v228
    v_xor_b32 v229, 0x10000, v229
    v_xor_b32 v230, 0x10000, v230
    v_xor_b32 v231, 0x10000, v231
    v_xor_b32 v249, 0x10000, v249
    ds_read_b64_tr_b16 v[208:209], v228 offset:33280
    ds_read_b64_tr_b16 v[210:211], v228 offset:33536
    s_waitcnt lgkmcnt(6)
    v_mfma_f32_16x16x32_bf16 v[176:179], v[212:215], v[136:139], v[176:179]
    v_mfma_f32_16x16x32_bf16 v[184:187], v[212:215], v[140:143], v[184:187]
    ds_read_b64_tr_b16 v[212:213], v228 offset:41472
    ds_read_b64_tr_b16 v[214:215], v228 offset:41728
    s_waitcnt lgkmcnt(6)
    v_mfma_f32_16x16x32_bf16 v[148:151], v[216:219], v[136:139], v[148:151]
    v_mfma_f32_16x16x32_bf16 v[156:159], v[216:219], v[140:143], v[156:159]
    ds_read_b64_tr_b16 v[216:217], v229 offset:33280
    ds_read_b64_tr_b16 v[218:219], v229 offset:33536
    s_waitcnt lgkmcnt(6)
    v_mfma_f32_16x16x32_bf16 v[180:183], v[220:223], v[136:139], v[180:183]
    v_mfma_f32_16x16x32_bf16 v[188:191], v[220:223], v[140:143], v[188:191]
    s_barrier
    ds_read_b64_tr_b16 v[220:221], v229 offset:41472
    ds_read_b64_tr_b16 v[222:223], v229 offset:41728
    s_waitcnt lgkmcnt(6)
    v_mfma_f32_16x16x32_bf16 v[160:163], v[208:211], v[96:99], v[160:163]
    v_mfma_f32_16x16x32_bf16 v[168:171], v[208:211], v[100:103], v[168:171]
    ds_read_b64_tr_b16 v[208:209], v228 offset:37376
    ds_read_b64_tr_b16 v[210:211], v228 offset:37632
    s_waitcnt lgkmcnt(6)
    v_mfma_f32_16x16x32_bf16 v[192:195], v[212:215], v[96:99], v[192:195]
    s_and_b32 s67, s23, 7
    s_lshl_b32 s67, s67, 11
    s_lshr_b32 s26, s23, 3
    s_mul_i32 s26, s26, 36864
    s_add_u32 s67, s67, s26
    s_mul_i32 s26, s28, 165888
    s_add_u32 s67, s67, s26
    s_add_u32 s98, s67, 165888
    v_mul_f32 v176, v144, v176
    v_mfma_f32_16x16x32_bf16 v[200:203], v[212:215], v[100:103], v[200:203]
    s_lshl_b32 s25, s3, 12
    s_add_u32 m0, s25, 114688
    s_nop 0
    buffer_load_dwordx4 v255, s[92:95], s79 offen lds
    s_add_u32 s79, s79, s96
    v_mul_f32 v144, s64, v144
    v_mul_f32 v177, v145, v177
    v_mul_f32 v145, s64, v145
    v_mul_f32 v178, v146, v178
    v_mul_f32 v146, s64, v146
    ds_read_b64_tr_b16 v[212:213], v228 offset:45568
    ds_read_b64_tr_b16 v[214:215], v228 offset:45824
    s_waitcnt lgkmcnt(6)
    v_mfma_f32_16x16x32_bf16 v[164:167], v[216:219], v[96:99], v[164:167]
    v_mul_f32 v179, v147, v179
    v_mul_f32 v147, s64, v147
    v_mfma_f32_16x16x32_bf16 v[172:175], v[216:219], v[100:103], v[172:175]
    v_mul_f32 v180, v148, v180
    v_mul_f32 v148, s64, v148
    v_mul_f32 v181, v149, v181
    v_mul_f32 v149, s64, v149
    v_mul_f32 v182, v150, v182
    ds_read_b64_tr_b16 v[216:217], v229 offset:37376
    ds_read_b64_tr_b16 v[218:219], v229 offset:37632
    s_waitcnt lgkmcnt(6)
    v_mfma_f32_16x16x32_bf16 v[196:199], v[220:223], v[96:99], v[196:199]
    v_mul_f32 v150, s64, v150
    v_mul_f32 v183, v151, v183
    v_mfma_f32_16x16x32_bf16 v[204:207], v[220:223], v[100:103], v[204:207]
    v_mul_f32 v151, s64, v151
    v_exp_f32 v144, v144
    v_exp_f32 v145, v145
    v_add_f32 v144, 1.0, v144
    v_exp_f32 v146, v146
    ds_read_b64_tr_b16 v[220:221], v229 offset:45568
    ds_read_b64_tr_b16 v[222:223], v229 offset:45824
    s_waitcnt lgkmcnt(6)
    v_mfma_f32_16x16x32_bf16 v[160:163], v[208:211], v[104:107], v[160:163]
    v_add_f32 v145, 1.0, v145
    v_exp_f32 v147, v147
    v_mfma_f32_16x16x32_bf16 v[168:171], v[208:211], v[108:111], v[168:171]
    v_add_f32 v146, 1.0, v146
    v_exp_f32 v148, v148
    v_add_f32 v147, 1.0, v147
    v_exp_f32 v149, v149
    v_add_f32 v148, 1.0, v148
    v_xor_b32 v228, 0x10000, v228
    v_xor_b32 v229, 0x10000, v229
    v_xor_b32 v230, 0x10000, v230
    v_xor_b32 v231, 0x10000, v231
    v_xor_b32 v249, 0x10000, v249
    ds_read_b64_tr_b16 v[208:209], v228 offset:512
    ds_read_b64_tr_b16 v[210:211], v228 offset:768
    s_waitcnt lgkmcnt(6)
    v_mfma_f32_16x16x32_bf16 v[192:195], v[212:215], v[104:107], v[192:195]
    v_exp_f32 v150, v150
    v_add_f32 v149, 1.0, v149
    v_mfma_f32_16x16x32_bf16 v[200:203], v[212:215], v[108:111], v[200:203]
    v_exp_f32 v151, v151
    v_add_f32 v150, 1.0, v150
    v_add_f32 v151, 1.0, v151
    v_rcp_f32 v144, v144
    v_rcp_f32 v145, v145
    ds_read_b64_tr_b16 v[212:213], v228 offset:8704
    ds_read_b64_tr_b16 v[214:215], v228 offset:8960
    s_waitcnt lgkmcnt(6)
    v_mfma_f32_16x16x32_bf16 v[164:167], v[216:219], v[104:107], v[164:167]
    v_mul_f32 v176, v176, v144
    v_rcp_f32 v146, v146
    v_mfma_f32_16x16x32_bf16 v[172:175], v[216:219], v[108:111], v[172:175]
    v_mul_f32 v177, v177, v145
    v_rcp_f32 v147, v147
    v_mul_f32 v178, v178, v146
    v_rcp_f32 v148, v148
    v_mul_f32 v179, v179, v147
    ds_read_b64_tr_b16 v[216:217], v229 offset:512
    ds_read_b64_tr_b16 v[218:219], v229 offset:768
    s_waitcnt lgkmcnt(6)
    v_mfma_f32_16x16x32_bf16 v[196:199], v[220:223], v[104:107], v[196:199]
    v_rcp_f32 v149, v149
    v_mul_f32 v180, v180, v148
    v_mfma_f32_16x16x32_bf16 v[204:207], v[220:223], v[108:111], v[204:207]
    v_rcp_f32 v150, v150
    v_mul_f32 v181, v181, v149
    v_rcp_f32 v151, v151
    v_mul_f32 v182, v182, v150
    ds_read_b64_tr_b16 v[220:221], v229 offset:8704
    ds_read_b64_tr_b16 v[222:223], v229 offset:8960
    s_waitcnt lgkmcnt(6)
    v_mfma_f32_16x16x32_bf16 v[160:163], v[208:211], v[112:115], v[160:163]
    v_mul_f32 v183, v183, v151
    v_cvt_pk_bf16_f32 v144, v176, v177
    v_mfma_f32_16x16x32_bf16 v[168:171], v[208:211], v[116:119], v[168:171]
    v_cvt_pk_bf16_f32 v145, v178, v179
    v_cvt_pk_bf16_f32 v146, v180, v181
    v_cvt_pk_bf16_f32 v147, v182, v183
    buffer_store_dwordx4 v[144:147], v238, s[48:51], s67 offen offset:0 sc1
    ds_read_b64_tr_b16 v[208:209], v228 offset:4608
    ds_read_b64_tr_b16 v[210:211], v228 offset:4864
    s_waitcnt lgkmcnt(6)
    v_mfma_f32_16x16x32_bf16 v[192:195], v[212:215], v[112:115], v[192:195]
    v_mul_f32 v184, v152, v184
    v_mul_f32 v152, s64, v152
    v_mfma_f32_16x16x32_bf16 v[200:203], v[212:215], v[116:119], v[200:203]
    s_lshl_b32 s25, s3, 12
    s_add_u32 m0, s25, 115712
    s_nop 0
    buffer_load_dwordx4 v255, s[92:95], s79 offen lds
    s_add_u32 s79, s79, s97
    v_mul_f32 v185, v153, v185
    v_mul_f32 v153, s64, v153
    v_mul_f32 v186, v154, v186
    v_mul_f32 v154, s64, v154
    ds_read_b64_tr_b16 v[212:213], v228 offset:12800
    ds_read_b64_tr_b16 v[214:215], v228 offset:13056
    s_waitcnt lgkmcnt(6)
    v_mfma_f32_16x16x32_bf16 v[164:167], v[216:219], v[112:115], v[164:167]
    v_mul_f32 v187, v155, v187
    v_mul_f32 v155, s64, v155
    v_mfma_f32_16x16x32_bf16 v[172:175], v[216:219], v[116:119], v[172:175]
    v_mul_f32 v188, v156, v188
    v_mul_f32 v156, s64, v156
    v_mul_f32 v189, v157, v189
    v_mul_f32 v157, s64, v157
    ds_read_b64_tr_b16 v[216:217], v229 offset:4608
    ds_read_b64_tr_b16 v[218:219], v229 offset:4864
    s_waitcnt lgkmcnt(6)
    v_mfma_f32_16x16x32_bf16 v[196:199], v[220:223], v[112:115], v[196:199]
    v_mul_f32 v190, v158, v190
    v_mul_f32 v158, s64, v158
    v_mfma_f32_16x16x32_bf16 v[204:207], v[220:223], v[116:119], v[204:207]
    v_mul_f32 v191, v159, v191
    v_mul_f32 v159, s64, v159
    v_exp_f32 v152, v152
    v_exp_f32 v153, v153
    ds_read_b64_tr_b16 v[220:221], v229 offset:12800
    ds_read_b64_tr_b16 v[222:223], v229 offset:13056
    s_waitcnt lgkmcnt(6)
    v_mfma_f32_16x16x32_bf16 v[160:163], v[208:211], v[120:123], v[160:163]
    v_add_f32 v152, 1.0, v152
    v_exp_f32 v154, v154
    v_mfma_f32_16x16x32_bf16 v[168:171], v[208:211], v[124:127], v[168:171]
    v_add_f32 v153, 1.0, v153
    v_exp_f32 v155, v155
    v_add_f32 v154, 1.0, v154
    ds_read_b64_tr_b16 v[208:209], v228 offset:16896
    ds_read_b64_tr_b16 v[210:211], v228 offset:17152
    s_waitcnt lgkmcnt(6)
    v_mfma_f32_16x16x32_bf16 v[192:195], v[212:215], v[120:123], v[192:195]
    v_exp_f32 v156, v156
    v_add_f32 v155, 1.0, v155
    v_mfma_f32_16x16x32_bf16 v[200:203], v[212:215], v[124:127], v[200:203]
    v_exp_f32 v157, v157
    v_add_f32 v156, 1.0, v156
    v_exp_f32 v158, v158
    ds_read_b64_tr_b16 v[212:213], v228 offset:25088
    ds_read_b64_tr_b16 v[214:215], v228 offset:25344
    s_waitcnt lgkmcnt(6)
    v_mfma_f32_16x16x32_bf16 v[164:167], v[216:219], v[120:123], v[164:167]
    v_add_f32 v157, 1.0, v157
    v_exp_f32 v159, v159
    v_mfma_f32_16x16x32_bf16 v[172:175], v[216:219], v[124:127], v[172:175]
    v_add_f32 v158, 1.0, v158
    v_add_f32 v159, 1.0, v159
    v_rcp_f32 v152, v152
    ds_read_b64_tr_b16 v[216:217], v229 offset:16896
    ds_read_b64_tr_b16 v[218:219], v229 offset:17152
    s_waitcnt lgkmcnt(6)
    v_mfma_f32_16x16x32_bf16 v[196:199], v[220:223], v[120:123], v[196:199]
    v_rcp_f32 v153, v153
    v_mul_f32 v184, v184, v152
    v_mfma_f32_16x16x32_bf16 v[204:207], v[220:223], v[124:127], v[204:207]
    v_rcp_f32 v154, v154
    v_mul_f32 v185, v185, v153
    v_rcp_f32 v155, v155
    s_waitcnt vmcnt(9)
    s_barrier
    ds_read_b64_tr_b16 v[220:221], v229 offset:25088
    ds_read_b64_tr_b16 v[222:223], v229 offset:25344
    s_waitcnt lgkmcnt(6)
    v_mfma_f32_16x16x32_bf16 v[160:163], v[208:211], v[128:131], v[160:163]
    v_mul_f32 v186, v186, v154
    v_rcp_f32 v156, v156
    v_mfma_f32_16x16x32_bf16 v[168:171], v[208:211], v[132:135], v[168:171]
    s_add_u32 s25, s65, 0x240080
    s_add_u32 m0, s24, 98304
    s_nop 0
    buffer_load_dwordx4 v232, s[32:35], s25 offen lds
    v_mul_f32 v187, v187, v155
    v_rcp_f32 v157, v157
    ds_read_b64_tr_b16 v[208:209], v228 offset:20992
    ds_read_b64_tr_b16 v[210:211], v228 offset:21248
    s_waitcnt lgkmcnt(6)
    v_mfma_f32_16x16x32_bf16 v[192:195], v[212:215], v[128:131], v[192:195]
    v_mul_f32 v188, v188, v156
    v_rcp_f32 v158, v158
    v_mfma_f32_16x16x32_bf16 v[200:203], v[212:215], v[132:135], v[200:203]
    v_mul_f32 v189, v189, v157
    v_rcp_f32 v159, v159
    ds_read_b64_tr_b16 v[212:213], v228 offset:29184
    ds_read_b64_tr_b16 v[214:215], v228 offset:29440
    s_waitcnt lgkmcnt(6)
    v_mfma_f32_16x16x32_bf16 v[164:167], v[216:219], v[128:131], v[164:167]
    v_mul_f32 v190, v190, v158
    v_mul_f32 v191, v191, v159
    v_mfma_f32_16x16x32_bf16 v[172:175], v[216:219], v[132:135], v[172:175]
    v_cvt_pk_bf16_f32 v152, v184, v185
    ds_read_b64_tr_b16 v[216:217], v229 offset:20992
    ds_read_b64_tr_b16 v[218:219], v229 offset:21248
    s_waitcnt lgkmcnt(6)
    v_mfma_f32_16x16x32_bf16 v[196:199], v[220:223], v[128:131], v[196:199]
    v_cvt_pk_bf16_f32 v153, v186, v187
    v_cvt_pk_bf16_f32 v154, v188, v189
    v_mfma_f32_16x16x32_bf16 v[204:207], v[220:223], v[132:135], v[204:207]
    s_add_u32 s25, s65, 0x240080
    s_add_u32 m0, s24, 106496
    s_nop 0
    buffer_load_dwordx4 v232, s[36:39], s25 offen lds
    v_cvt_pk_bf16_f32 v155, v190, v191
    ds_read_b64_tr_b16 v[220:221], v229 offset:29184
    ds_read_b64_tr_b16 v[222:223], v229 offset:29440
    s_waitcnt lgkmcnt(6)
    v_mfma_f32_16x16x32_bf16 v[160:163], v[208:211], v[136:139], v[160:163]
    buffer_store_dwordx4 v[152:155], v238, s[48:51], s98 offen offset:0 sc1
    v_mfma_f32_16x16x32_bf16 v[168:171], v[208:211], v[140:143], v[168:171]
    ds_read_b64_tr_b16 v[208:209], v228 offset:32768
    ds_read_b64_tr_b16 v[210:211], v228 offset:33024
    s_waitcnt lgkmcnt(6)
    v_mfma_f32_16x16x32_bf16 v[192:195], v[212:215], v[136:139], v[192:195]
    v_mfma_f32_16x16x32_bf16 v[200:203], v[212:215], v[140:143], v[200:203]
    s_add_u32 s25, s65, 0x2d0080
    s_add_u32 m0, s24, 0
    s_nop 0
    buffer_load_dwordx4 v232, s[32:35], s25 offen lds
    ds_read_b64_tr_b16 v[212:213], v228 offset:40960
    ds_read_b64_tr_b16 v[214:215], v228 offset:41216
    s_waitcnt lgkmcnt(6)
    v_mfma_f32_16x16x32_bf16 v[164:167], v[216:219], v[136:139], v[164:167]
    v_mfma_f32_16x16x32_bf16 v[172:175], v[216:219], v[140:143], v[172:175]
    ds_read_b64_tr_b16 v[216:217], v229 offset:32768
    ds_read_b64_tr_b16 v[218:219], v229 offset:33024
    s_waitcnt lgkmcnt(6)
    v_mfma_f32_16x16x32_bf16 v[196:199], v[220:223], v[136:139], v[196:199]
    v_mfma_f32_16x16x32_bf16 v[204:207], v[220:223], v[140:143], v[204:207]
    ds_read_b64_tr_b16 v[220:221], v229 offset:40960
    ds_read_b64_tr_b16 v[222:223], v229 offset:41216
    s_waitcnt lgkmcnt(6)
    v_mfma_f32_16x16x32_bf16 v[144:147], v[208:211], v[0:3], 0
    v_mfma_f32_16x16x32_bf16 v[152:155], v[208:211], v[4:7], 0
    s_add_u32 s25, s65, 0x2d0080
    s_add_u32 m0, s24, 8192
    s_nop 0
    buffer_load_dwordx4 v232, s[36:39], s25 offen lds
    ds_read_b64_tr_b16 v[208:209], v228 offset:36864
    ds_read_b64_tr_b16 v[210:211], v228 offset:37120
    s_waitcnt lgkmcnt(6)
    v_mfma_f32_16x16x32_bf16 v[176:179], v[212:215], v[0:3], 0
    v_mul_f32 v192, v160, v192
    v_mul_f32 v160, s64, v160
    v_mfma_f32_16x16x32_bf16 v[184:187], v[212:215], v[4:7], 0
    v_mul_f32 v193, v161, v193
    v_mul_f32 v161, s64, v161
    v_mul_f32 v194, v162, v194
    v_mul_f32 v162, s64, v162
    v_mul_f32 v195, v163, v195
    ds_read_b64_tr_b16 v[212:213], v228 offset:45056
    ds_read_b64_tr_b16 v[214:215], v228 offset:45312
    s_waitcnt lgkmcnt(6)
    v_mfma_f32_16x16x32_bf16 v[148:151], v[216:219], v[0:3], 0
    v_mul_f32 v163, s64, v163
    v_mul_f32 v196, v164, v196
    v_mfma_f32_16x16x32_bf16 v[156:159], v[216:219], v[4:7], 0
    s_lshl_b32 s25, s3, 12
    s_add_u32 m0, s25, 116736
    s_nop 0
    buffer_load_dwordx4 v255, s[92:95], s79 offen lds
    s_add_u32 s79, s79, s96
    v_mul_f32 v164, s64, v164
    v_mul_f32 v197, v165, v197
    v_mul_f32 v165, s64, v165
    v_mul_f32 v198, v166, v198
    v_mul_f32 v166, s64, v166
    ds_read_b64_tr_b16 v[216:217], v229 offset:36864
    ds_read_b64_tr_b16 v[218:219], v229 offset:37120
    s_waitcnt lgkmcnt(6)
    v_mfma_f32_16x16x32_bf16 v[180:183], v[220:223], v[0:3], 0
    v_mul_f32 v199, v167, v199
    v_mul_f32 v167, s64, v167
    v_mfma_f32_16x16x32_bf16 v[188:191], v[220:223], v[4:7], 0
    v_exp_f32 v160, v160
    v_exp_f32 v161, v161
    v_add_f32 v160, 1.0, v160
    v_exp_f32 v162, v162
    v_add_f32 v161, 1.0, v161
    ds_read_b64_tr_b16 v[220:221], v229 offset:45056
    ds_read_b64_tr_b16 v[222:223], v229 offset:45312
    s_waitcnt lgkmcnt(6)
    v_mfma_f32_16x16x32_bf16 v[144:147], v[208:211], v[8:11], v[144:147]
    v_exp_f32 v163, v163
    v_add_f32 v162, 1.0, v162
    v_mfma_f32_16x16x32_bf16 v[152:155], v[208:211], v[12:15], v[152:155]
    v_exp_f32 v164, v164
    v_add_f32 v163, 1.0, v163
    v_exp_f32 v165, v165
    v_add_f32 v164, 1.0, v164
    v_exp_f32 v166, v166
    ds_read_b64_tr_b16 v[208:209], v228 offset:49152
    ds_read_b64_tr_b16 v[210:211], v228 offset:49408
    s_waitcnt lgkmcnt(6)
    v_mfma_f32_16x16x32_bf16 v[176:179], v[212:215], v[8:11], v[176:179]
    v_add_f32 v165, 1.0, v165
    v_exp_f32 v167, v167
    v_mfma_f32_16x16x32_bf16 v[184:187], v[212:215], v[12:15], v[184:187]
    s_lshl_b32 s25, s3, 12
    s_add_u32 m0, s25, 117760
    s_nop 0
    buffer_load_dwordx4 v255, s[92:95], s79 offen lds
    s_add_u32 s79, s79, s97
    v_add_f32 v166, 1.0, v166
    v_add_f32 v167, 1.0, v167
    v_rcp_f32 v160, v160
    v_rcp_f32 v161, v161
    v_mul_f32 v192, v192, v160
    ds_read_b64_tr_b16 v[212:213], v228 offset:57344
    ds_read_b64_tr_b16 v[214:215], v228 offset:57600
    s_waitcnt lgkmcnt(6)
    v_mfma_f32_16x16x32_bf16 v[148:151], v[216:219], v[8:11], v[148:151]
    v_rcp_f32 v162, v162
    v_mul_f32 v193, v193, v161
    v_mfma_f32_16x16x32_bf16 v[156:159], v[216:219], v[12:15], v[156:159]
    v_rcp_f32 v163, v163
    v_mul_f32 v194, v194, v162
    v_rcp_f32 v164, v164
    v_mul_f32 v195, v195, v163
    v_rcp_f32 v165, v165
    ds_read_b64_tr_b16 v[216:217], v229 offset:49152
    ds_read_b64_tr_b16 v[218:219], v229 offset:49408
    s_waitcnt lgkmcnt(6)
    v_mfma_f32_16x16x32_bf16 v[180:183], v[220:223], v[8:11], v[180:183]
    v_mul_f32 v196, v196, v164
    v_rcp_f32 v166, v166
    v_mfma_f32_16x16x32_bf16 v[188:191], v[220:223], v[12:15], v[188:191]
    v_mul_f32 v197, v197, v165
    v_rcp_f32 v167, v167
    v_mul_f32 v198, v198, v166
    v_mul_f32 v199, v199, v167
    s_waitcnt vmcnt(12)
    s_barrier
    ds_read_b64_tr_b16 v[220:221], v229 offset:57344
    ds_read_b64_tr_b16 v[222:223], v229 offset:57600
    s_waitcnt lgkmcnt(6)
    v_mfma_f32_16x16x32_bf16 v[144:147], v[208:211], v[16:19], v[144:147]
    v_cvt_pk_bf16_f32 v160, v192, v193
    v_cvt_pk_bf16_f32 v161, v194, v195
    v_mfma_f32_16x16x32_bf16 v[152:155], v[208:211], v[20:23], v[152:155]
    v_cvt_pk_bf16_f32 v162, v196, v197
    v_cvt_pk_bf16_f32 v163, v198, v199
    buffer_store_dwordx4 v[160:163], v238, s[48:51], s67 offen offset:1024 sc1
    v_mul_f32 v200, v168, v200
    ds_read_b64_tr_b16 v[208:209], v228 offset:53248
    ds_read_b64_tr_b16 v[210:211], v228 offset:53504
    s_waitcnt lgkmcnt(6)
    v_mfma_f32_16x16x32_bf16 v[176:179], v[212:215], v[16:19], v[176:179]
    v_mul_f32 v168, s64, v168
    v_mul_f32 v201, v169, v201
    v_mfma_f32_16x16x32_bf16 v[184:187], v[212:215], v[20:23], v[184:187]
    s_add_u32 s25, s65, 0x360080
    s_add_u32 m0, s24, 16384
    s_nop 0
    buffer_load_dwordx4 v232, s[32:35], s25 offen lds
    v_mul_f32 v169, s64, v169
    v_mul_f32 v202, v170, v202
    v_mul_f32 v170, s64, v170
    v_mul_f32 v203, v171, v203
    ds_read_b64_tr_b16 v[212:213], v228 offset:61440
    ds_read_b64_tr_b16 v[214:215], v228 offset:61696
    s_waitcnt lgkmcnt(6)
    v_mfma_f32_16x16x32_bf16 v[148:151], v[216:219], v[16:19], v[148:151]
    v_mul_f32 v171, s64, v171
    v_mul_f32 v204, v172, v204
    v_mfma_f32_16x16x32_bf16 v[156:159], v[216:219], v[20:23], v[156:159]
    v_mul_f32 v172, s64, v172
    v_mul_f32 v205, v173, v205
    v_mul_f32 v173, s64, v173
    v_mul_f32 v206, v174, v206
    ds_read_b64_tr_b16 v[216:217], v229 offset:53248
    ds_read_b64_tr_b16 v[218:219], v229 offset:53504
    s_waitcnt lgkmcnt(6)
    v_mfma_f32_16x16x32_bf16 v[180:183], v[220:223], v[16:19], v[180:183]
    v_mul_f32 v174, s64, v174
    v_mul_f32 v207, v175, v207
    v_mfma_f32_16x16x32_bf16 v[188:191], v[220:223], v[20:23], v[188:191]
    v_mul_f32 v175, s64, v175
    v_exp_f32 v168, v168
    v_exp_f32 v169, v169
    v_add_f32 v168, 1.0, v168
    ds_read_b64_tr_b16 v[220:221], v229 offset:61440
    ds_read_b64_tr_b16 v[222:223], v229 offset:61696
    s_waitcnt lgkmcnt(6)
    v_mfma_f32_16x16x32_bf16 v[144:147], v[208:211], v[24:27], v[144:147]
    v_exp_f32 v170, v170
    v_add_f32 v169, 1.0, v169
    v_mfma_f32_16x16x32_bf16 v[152:155], v[208:211], v[28:31], v[152:155]
    v_exp_f32 v171, v171
    v_add_f32 v170, 1.0, v170
    v_exp_f32 v172, v172
    v_xor_b32 v228, 0x10000, v228
    v_xor_b32 v229, 0x10000, v229
    v_xor_b32 v230, 0x10000, v230
    v_xor_b32 v231, 0x10000, v231
    v_xor_b32 v249, 0x10000, v249
    ds_read_b64_tr_b16 v[208:209], v228 offset:0
    ds_read_b64_tr_b16 v[210:211], v228 offset:256
    s_waitcnt lgkmcnt(6)
    v_mfma_f32_16x16x32_bf16 v[176:179], v[212:215], v[24:27], v[176:179]
    v_add_f32 v171, 1.0, v171
    v_exp_f32 v173, v173
    v_mfma_f32_16x16x32_bf16 v[184:187], v[212:215], v[28:31], v[184:187]
    v_add_f32 v172, 1.0, v172
    v_exp_f32 v174, v174
    v_add_f32 v173, 1.0, v173
    ds_read_b64_tr_b16 v[212:213], v228 offset:8192
    ds_read_b64_tr_b16 v[214:215], v228 offset:8448
    s_waitcnt lgkmcnt(6)
    v_mfma_f32_16x16x32_bf16 v[148:151], v[216:219], v[24:27], v[148:151]
    v_exp_f32 v175, v175
    v_add_f32 v174, 1.0, v174
    v_mfma_f32_16x16x32_bf16 v[156:159], v[216:219], v[28:31], v[156:159]
    v_add_f32 v175, 1.0, v175
    v_rcp_f32 v168, v168
    v_rcp_f32 v169, v169
    ds_read_b64_tr_b16 v[216:217], v229 offset:0
    ds_read_b64_tr_b16 v[218:219], v229 offset:256
    s_waitcnt lgkmcnt(6)
    v_mfma_f32_16x16x32_bf16 v[180:183], v[220:223], v[24:27], v[180:183]
    v_mul_f32 v200, v200, v168
    v_rcp_f32 v170, v170
    v_mfma_f32_16x16x32_bf16 v[188:191], v[220:223], v[28:31], v[188:191]
    v_mul_f32 v201, v201, v169
    v_rcp_f32 v171, v171
    v_mul_f32 v202, v202, v170
    ds_read_b64_tr_b16 v[220:221], v229 offset:8192
    ds_read_b64_tr_b16 v[222:223], v229 offset:8448
    s_waitcnt lgkmcnt(6)
    v_mfma_f32_16x16x32_bf16 v[144:147], v[208:211], v[32:35], v[144:147]
    v_rcp_f32 v172, v172
    v_mul_f32 v203, v203, v171
    v_mfma_f32_16x16x32_bf16 v[152:155], v[208:211], v[36:39], v[152:155]
    v_rcp_f32 v173, v173
    v_mul_f32 v204, v204, v172
    ds_read_b64_tr_b16 v[208:209], v228 offset:4096
    ds_read_b64_tr_b16 v[210:211], v228 offset:4352
    s_waitcnt lgkmcnt(6)
    v_mfma_f32_16x16x32_bf16 v[176:179], v[212:215], v[32:35], v[176:179]
    v_rcp_f32 v174, v174
    v_mul_f32 v205, v205, v173
    v_mfma_f32_16x16x32_bf16 v[184:187], v[212:215], v[36:39], v[184:187]
    s_add_u32 s25, s65, 0x360080
    s_add_u32 m0, s24, 24576
    s_nop 0
    buffer_load_dwordx4 v232, s[36:39], s25 offen lds
    v_rcp_f32 v175, v175
    v_mul_f32 v206, v206, v174
    ds_read_b64_tr_b16 v[212:213], v228 offset:12288
    ds_read_b64_tr_b16 v[214:215], v228 offset:12544
    s_waitcnt lgkmcnt(6)
    v_mfma_f32_16x16x32_bf16 v[148:151], v[216:219], v[32:35], v[148:151]
    v_mul_f32 v207, v207, v175
    v_cvt_pk_bf16_f32 v168, v200, v201
    v_mfma_f32_16x16x32_bf16 v[156:159], v[216:219], v[36:39], v[156:159]
    v_cvt_pk_bf16_f32 v169, v202, v203
    ds_read_b64_tr_b16 v[216:217], v229 offset:4096
    ds_read_b64_tr_b16 v[218:219], v229 offset:4352
    s_waitcnt lgkmcnt(6)
    v_mfma_f32_16x16x32_bf16 v[180:183], v[220:223], v[32:35], v[180:183]
    v_cvt_pk_bf16_f32 v170, v204, v205
    v_cvt_pk_bf16_f32 v171, v206, v207
    v_mfma_f32_16x16x32_bf16 v[188:191], v[220:223], v[36:39], v[188:191]
    buffer_store_dwordx4 v[168:171], v238, s[48:51], s98 offen offset:1024 sc1
    ds_read_b64_tr_b16 v[220:221], v229 offset:12288
    ds_read_b64_tr_b16 v[222:223], v229 offset:12544
    s_waitcnt lgkmcnt(6)
    v_mfma_f32_16x16x32_bf16 v[144:147], v[208:211], v[40:43], v[144:147]
    v_mfma_f32_16x16x32_bf16 v[152:155], v[208:211], v[44:47], v[152:155]
    v_xor_b32 v228, 0x10000, v228
    v_xor_b32 v229, 0x10000, v229
    v_xor_b32 v230, 0x10000, v230
    v_xor_b32 v231, 0x10000, v231
    v_xor_b32 v249, 0x10000, v249
    ds_read_b64_tr_b16 v[208:209], v228 offset:33280
    ds_read_b64_tr_b16 v[210:211], v228 offset:33536
    s_waitcnt lgkmcnt(6)
    v_mfma_f32_16x16x32_bf16 v[176:179], v[212:215], v[40:43], v[176:179]
    v_mfma_f32_16x16x32_bf16 v[184:187], v[212:215], v[44:47], v[184:187]
    ds_read_b64_tr_b16 v[212:213], v228 offset:41472
    ds_read_b64_tr_b16 v[214:215], v228 offset:41728
    s_waitcnt lgkmcnt(6)
    v_mfma_f32_16x16x32_bf16 v[148:151], v[216:219], v[40:43], v[148:151]
    v_mfma_f32_16x16x32_bf16 v[156:159], v[216:219], v[44:47], v[156:159]
    ds_read_b64_tr_b16 v[216:217], v229 offset:33280
    ds_read_b64_tr_b16 v[218:219], v229 offset:33536
    s_waitcnt lgkmcnt(6)
    v_mfma_f32_16x16x32_bf16 v[180:183], v[220:223], v[40:43], v[180:183]
    v_mfma_f32_16x16x32_bf16 v[188:191], v[220:223], v[44:47], v[188:191]
    s_barrier
    ds_read_b64_tr_b16 v[220:221], v229 offset:41472
    ds_read_b64_tr_b16 v[222:223], v229 offset:41728
    s_waitcnt lgkmcnt(6)
    v_mfma_f32_16x16x32_bf16 v[160:163], v[208:211], v[0:3], 0
    v_mfma_f32_16x16x32_bf16 v[168:171], v[208:211], v[4:7], 0
    ds_read_b64_tr_b16 v[208:209], v228 offset:37376
    ds_read_b64_tr_b16 v[210:211], v228 offset:37632
    s_waitcnt lgkmcnt(6)
    v_mfma_f32_16x16x32_bf16 v[192:195], v[212:215], v[0:3], 0
    v_mfma_f32_16x16x32_bf16 v[200:203], v[212:215], v[4:7], 0
    s_lshr_b32 s74, s2, 3
    s_lshl_b32 s74, s74, 3
    s_add_u32 s74, s74, s3
    s_mul_i32 s74, s74, 3
    v_mul_u32_u24 v237, 0x240, v238
    s_mul_i32 s75, s20, 1152
    s_mul_i32 s25, s74, 9216
    s_add_u32 s25, s25, s75
    s_mov_b64 exec, 7
    buffer_load_dword v224, v237, s[32:35], s25 offen offset:1024
    buffer_load_dword v224, v237, s[36:39], s25 offen offset:1024
    s_mov_b64 exec, -1
    ds_read_b64_tr_b16 v[212:213], v228 offset:45568
    ds_read_b64_tr_b16 v[214:215], v228 offset:45824
    s_waitcnt lgkmcnt(6)
    v_mfma_f32_16x16x32_bf16 v[164:167], v[216:219], v[0:3], 0
    v_mfma_f32_16x16x32_bf16 v[172:175], v[216:219], v[4:7], 0
    ds_read_b64_tr_b16 v[216:217], v229 offset:37376
    ds_read_b64_tr_b16 v[218:219], v229 offset:37632
    s_waitcnt lgkmcnt(6)
    v_mfma_f32_16x16x32_bf16 v[196:199], v[220:223], v[0:3], 0
    v_mfma_f32_16x16x32_bf16 v[204:207], v[220:223], v[4:7], 0
    ds_read_b64_tr_b16 v[220:221], v229 offset:45568
    ds_read_b64_tr_b16 v[222:223], v229 offset:45824
    s_waitcnt lgkmcnt(6)
    v_mfma_f32_16x16x32_bf16 v[160:163], v[208:211], v[8:11], v[160:163]
    v_permlane16_swap_b32 v0, v4
    v_mfma_f32_16x16x32_bf16 v[168:171], v[208:211], v[12:15], v[168:171]
    ds_read_b64_tr_b16 v[208:209], v228 offset:49664
    ds_read_b64_tr_b16 v[210:211], v228 offset:49920
    s_waitcnt lgkmcnt(6)
    v_mfma_f32_16x16x32_bf16 v[192:195], v[212:215], v[8:11], v[192:195]
    v_permlane16_swap_b32 v1, v5
    v_mfma_f32_16x16x32_bf16 v[200:203], v[212:215], v[12:15], v[200:203]
    ds_read_b64_tr_b16 v[212:213], v228 offset:57856
    ds_read_b64_tr_b16 v[214:215], v228 offset:58112
    s_waitcnt lgkmcnt(6)
    v_mfma_f32_16x16x32_bf16 v[164:167], v[216:219], v[8:11], v[164:167]
    v_permlane16_swap_b32 v2, v6
    v_mfma_f32_16x16x32_bf16 v[172:175], v[216:219], v[12:15], v[172:175]
    ds_read_b64_tr_b16 v[216:217], v229 offset:49664
    ds_read_b64_tr_b16 v[218:219], v229 offset:49920
    s_waitcnt lgkmcnt(6)
    v_mfma_f32_16x16x32_bf16 v[196:199], v[220:223], v[8:11], v[196:199]
    v_permlane16_swap_b32 v3, v7
    v_mfma_f32_16x16x32_bf16 v[204:207], v[220:223], v[12:15], v[204:207]
    ds_read_b64_tr_b16 v[220:221], v229 offset:57856
    ds_read_b64_tr_b16 v[222:223], v229 offset:58112
    s_waitcnt lgkmcnt(6)
    v_mfma_f32_16x16x32_bf16 v[160:163], v[208:211], v[16:19], v[160:163]
    v_permlane16_swap_b32 v8, v12
    v_mfma_f32_16x16x32_bf16 v[168:171], v[208:211], v[20:23], v[168:171]
    ds_read_b64_tr_b16 v[208:209], v228 offset:53760
    ds_read_b64_tr_b16 v[210:211], v228 offset:54016
    s_waitcnt lgkmcnt(6)
    v_mfma_f32_16x16x32_bf16 v[192:195], v[212:215], v[16:19], v[192:195]
    v_permlane16_swap_b32 v9, v13
    v_mfma_f32_16x16x32_bf16 v[200:203], v[212:215], v[20:23], v[200:203]
    v_lshrrev_b32 v237, 5, v238
    v_mul_u32_u24 v237, 0x480, v237
    s_movk_i32 s75, 16
    s_mul_i32 s25, s74, 3456
    s_mul_i32 s75, s20, 144
    s_add_u32 s25, s25, s75
    s_mov_b64 exec, 0x15555
    buffer_load_dword v224, v237, s[40:43], s25 offen
    buffer_load_dword v224, v237, s[40:43], s25 offen offset:128
    s_mov_b64 exec, -1
    ds_read_b64_tr_b16 v[212:213], v228 offset:61952
    ds_read_b64_tr_b16 v[214:215], v228 offset:62208
    s_waitcnt lgkmcnt(6)
    v_mfma_f32_16x16x32_bf16 v[164:167], v[216:219], v[16:19], v[164:167]
    v_permlane16_swap_b32 v10, v14
    v_mfma_f32_16x16x32_bf16 v[172:175], v[216:219], v[20:23], v[172:175]
    ds_read_b64_tr_b16 v[216:217], v229 offset:53760
    ds_read_b64_tr_b16 v[218:219], v229 offset:54016
    s_waitcnt lgkmcnt(6)
    v_mfma_f32_16x16x32_bf16 v[196:199], v[220:223], v[16:19], v[196:199]
    v_permlane16_swap_b32 v11, v15
    v_mfma_f32_16x16x32_bf16 v[204:207], v[220:223], v[20:23], v[204:207]
    ds_read_b64_tr_b16 v[220:221], v229 offset:61952
    ds_read_b64_tr_b16 v[222:223], v229 offset:62208
    s_waitcnt lgkmcnt(6)
    v_mfma_f32_16x16x32_bf16 v[160:163], v[208:211], v[24:27], v[160:163]
    v_permlane16_swap_b32 v16, v20
    v_mfma_f32_16x16x32_bf16 v[168:171], v[208:211], v[28:31], v[168:171]
    v_xor_b32 v228, 0x10000, v228
    v_xor_b32 v229, 0x10000, v229
    v_xor_b32 v230, 0x10000, v230
    v_xor_b32 v231, 0x10000, v231
    v_xor_b32 v249, 0x10000, v249
    ds_read_b64_tr_b16 v[208:209], v228 offset:512
    ds_read_b64_tr_b16 v[210:211], v228 offset:768
    s_waitcnt lgkmcnt(6)
    v_mfma_f32_16x16x32_bf16 v[192:195], v[212:215], v[24:27], v[192:195]
    v_permlane16_swap_b32 v17, v21
    v_mfma_f32_16x16x32_bf16 v[200:203], v[212:215], v[28:31], v[200:203]
    ds_read_b64_tr_b16 v[212:213], v228 offset:8704
    ds_read_b64_tr_b16 v[214:215], v228 offset:8960
    s_waitcnt lgkmcnt(6)
    v_mfma_f32_16x16x32_bf16 v[164:167], v[216:219], v[24:27], v[164:167]
    v_permlane16_swap_b32 v18, v22
    v_mfma_f32_16x16x32_bf16 v[172:175], v[216:219], v[28:31], v[172:175]
    ds_read_b64_tr_b16 v[216:217], v229 offset:512
    ds_read_b64_tr_b16 v[218:219], v229 offset:768
    s_waitcnt lgkmcnt(6)
    v_mfma_f32_16x16x32_bf16 v[196:199], v[220:223], v[24:27], v[196:199]
    v_permlane16_swap_b32 v19, v23
    v_mfma_f32_16x16x32_bf16 v[204:207], v[220:223], v[28:31], v[204:207]
    s_waitcnt vmcnt(18)
    s_barrier
    ds_read_b64_tr_b16 v[220:221], v229 offset:8704
    ds_read_b64_tr_b16 v[222:223], v229 offset:8960
    s_waitcnt lgkmcnt(6)
    v_mfma_f32_16x16x32_bf16 v[160:163], v[208:211], v[32:35], v[160:163]
    v_permlane16_swap_b32 v24, v28
    v_mfma_f32_16x16x32_bf16 v[168:171], v[208:211], v[36:39], v[168:171]
    s_add_u32 s25, s65, 0x3f0080
    s_add_u32 m0, s24, 32768
    s_nop 0
    buffer_load_dwordx4 v232, s[32:35], s25 offen lds
    ds_read_b64_tr_b16 v[208:209], v228 offset:4608
    ds_read_b64_tr_b16 v[210:211], v228 offset:4864
    s_waitcnt lgkmcnt(6)
    v_mfma_f32_16x16x32_bf16 v[192:195], v[212:215], v[32:35], v[192:195]
    v_permlane16_swap_b32 v25, v29
    v_mfma_f32_16x16x32_bf16 v[200:203], v[212:215], v[36:39], v[200:203]
    ds_read_b64_tr_b16 v[212:213], v228 offset:12800
    ds_read_b64_tr_b16 v[214:215], v228 offset:13056
    s_waitcnt lgkmcnt(6)
    v_mfma_f32_16x16x32_bf16 v[164:167], v[216:219], v[32:35], v[164:167]
    v_permlane16_swap_b32 v26, v30
    v_mfma_f32_16x16x32_bf16 v[172:175], v[216:219], v[36:39], v[172:175]
    ds_read_b64_tr_b16 v[216:217], v229 offset:4608
    ds_read_b64_tr_b16 v[218:219], v229 offset:4864
    s_waitcnt lgkmcnt(6)
    v_mfma_f32_16x16x32_bf16 v[196:199], v[220:223], v[32:35], v[196:199]
    v_permlane16_swap_b32 v27, v31
    v_mfma_f32_16x16x32_bf16 v[204:207], v[220:223], v[36:39], v[204:207]
    ds_read_b64_tr_b16 v[220:221], v229 offset:12800
    ds_read_b64_tr_b16 v[222:223], v229 offset:13056
    s_waitcnt lgkmcnt(6)
    v_mfma_f32_16x16x32_bf16 v[160:163], v[208:211], v[40:43], v[160:163]
    v_permlane16_swap_b32 v32, v36
    v_mfma_f32_16x16x32_bf16 v[168:171], v[208:211], v[44:47], v[168:171]
    s_add_u32 s25, s65, 0x3f0080
    s_add_u32 m0, s24, 40960
    s_nop 0
    buffer_load_dwordx4 v232, s[36:39], s25 offen lds
    ds_read_b64_tr_b16 v[208:209], v228 offset:16384
    ds_read_b64_tr_b16 v[210:211], v228 offset:16640
    s_waitcnt lgkmcnt(6)
    v_mfma_f32_16x16x32_bf16 v[192:195], v[212:215], v[40:43], v[192:195]
    v_permlane16_swap_b32 v33, v37
    v_mfma_f32_16x16x32_bf16 v[200:203], v[212:215], v[44:47], v[200:203]
    ds_read_b64_tr_b16 v[212:213], v228 offset:16896
    ds_read_b64_tr_b16 v[214:215], v228 offset:17152
    s_waitcnt lgkmcnt(6)
    v_mfma_f32_16x16x32_bf16 v[164:167], v[216:219], v[40:43], v[164:167]
    v_permlane16_swap_b32 v34, v38
    v_mfma_f32_16x16x32_bf16 v[172:175], v[216:219], v[44:47], v[172:175]
    ds_read_b64_tr_b16 v[216:217], v228 offset:24576
    ds_read_b64_tr_b16 v[218:219], v228 offset:24832
    s_waitcnt lgkmcnt(6)
    v_mfma_f32_16x16x32_bf16 v[196:199], v[220:223], v[40:43], v[196:199]
    v_permlane16_swap_b32 v35, v39
    v_mfma_f32_16x16x32_bf16 v[204:207], v[220:223], v[44:47], v[204:207]
    ds_read_b64_tr_b16 v[220:221], v228 offset:25088
    ds_read_b64_tr_b16 v[222:223], v228 offset:25344
    s_waitcnt lgkmcnt(6)
    v_mfma_f32_16x16x32_bf16 v[144:147], v[208:211], v[48:51], v[144:147]
    v_permlane16_swap_b32 v40, v44
    v_mfma_f32_16x16x32_bf16 v[152:155], v[208:211], v[52:55], v[152:155]
    s_add_u32 s25, s65, 0x480080
    s_add_u32 m0, s24, 49152
    s_nop 0
    buffer_load_dwordx4 v232, s[32:35], s25 offen lds
    ds_read_b64_tr_b16 v[208:209], v229 offset:16384
    ds_read_b64_tr_b16 v[210:211], v229 offset:16640
    s_waitcnt lgkmcnt(6)
    v_mfma_f32_16x16x32_bf16 v[160:163], v[212:215], v[48:51], v[160:163]
    v_permlane16_swap_b32 v41, v45
    v_mfma_f32_16x16x32_bf16 v[168:171], v[212:215], v[52:55], v[168:171]
    ds_read_b64_tr_b16 v[212:213], v229 offset:16896
    ds_read_b64_tr_b16 v[214:215], v229 offset:17152
    s_waitcnt lgkmcnt(6)
    v_mfma_f32_16x16x32_bf16 v[176:179], v[216:219], v[48:51], v[176:179]
    v_permlane16_swap_b32 v42, v46
    v_mfma_f32_16x16x32_bf16 v[184:187], v[216:219], v[52:55], v[184:187]
    ds_read_b64_tr_b16 v[216:217], v229 offset:24576
    ds_read_b64_tr_b16 v[218:219], v229 offset:24832
    s_waitcnt lgkmcnt(6)
    v_mfma_f32_16x16x32_bf16 v[192:195], v[220:223], v[48:51], v[192:195]
    v_permlane16_swap_b32 v43, v47
    v_mfma_f32_16x16x32_bf16 v[200:203], v[220:223], v[52:55], v[200:203]
    ds_read_b64_tr_b16 v[220:221], v229 offset:25088
    ds_read_b64_tr_b16 v[222:223], v229 offset:25344
    s_waitcnt lgkmcnt(6)
    v_mfma_f32_16x16x32_bf16 v[148:151], v[208:211], v[48:51], v[148:151]
    v_mfma_f32_16x16x32_bf16 v[156:159], v[208:211], v[52:55], v[156:159]
    s_add_u32 s25, s65, 0x480080
    s_add_u32 m0, s24, 57344
    s_nop 0
    buffer_load_dwordx4 v232, s[36:39], s25 offen lds
    ds_read_b64_tr_b16 v[208:209], v228 offset:20480
    ds_read_b64_tr_b16 v[210:211], v228 offset:20736
    s_waitcnt lgkmcnt(6)
    v_mfma_f32_16x16x32_bf16 v[164:167], v[212:215], v[48:51], v[164:167]
    v_mfma_f32_16x16x32_bf16 v[172:175], v[212:215], v[52:55], v[172:175]
    ds_read_b64_tr_b16 v[212:213], v228 offset:20992
    ds_read_b64_tr_b16 v[214:215], v228 offset:21248
    s_waitcnt lgkmcnt(6)
    v_mfma_f32_16x16x32_bf16 v[180:183], v[216:219], v[48:51], v[180:183]
    v_mfma_f32_16x16x32_bf16 v[188:191], v[216:219], v[52:55], v[188:191]
    ds_read_b64_tr_b16 v[216:217], v228 offset:28672
    ds_read_b64_tr_b16 v[218:219], v228 offset:28928
    s_waitcnt lgkmcnt(6)
    v_mfma_f32_16x16x32_bf16 v[196:199], v[220:223], v[48:51], v[196:199]
    v_mfma_f32_16x16x32_bf16 v[204:207], v[220:223], v[52:55], v[204:207]
    s_waitcnt vmcnt(17)
    s_barrier
    ds_read_b64_tr_b16 v[220:221], v228 offset:29184
    ds_read_b64_tr_b16 v[222:223], v228 offset:29440
    s_waitcnt lgkmcnt(6)
    v_mfma_f32_16x16x32_bf16 v[144:147], v[208:211], v[56:59], v[144:147]
    v_permlane16_swap_b32 v48, v52
    v_mfma_f32_16x16x32_bf16 v[152:155], v[208:211], v[60:63], v[152:155]
    s_waitcnt vmcnt(12)
    ds_read_b64_tr_b16 v[240:241], v254
    ds_read_b64_tr_b16 v[242:243], v254 offset:1024
    ds_read_b64_tr_b16 v[208:209], v229 offset:20480
    ds_read_b64_tr_b16 v[210:211], v229 offset:20736
    s_waitcnt lgkmcnt(8)
    v_mfma_f32_16x16x32_bf16 v[160:163], v[212:215], v[56:59], v[160:163]
    v_permlane16_swap_b32 v49, v53
    v_mfma_f32_16x16x32_bf16 v[168:171], v[212:215], v[60:63], v[168:171]
    s_add_u32 s25, s66, 0x0
    s_add_u32 m0, s24, 65536
    s_mov_b64 exec, s[68:69]
    buffer_load_dwordx4 v233, s[40:43], s25 offen lds
    s_mov_b64 exec, -1
    ds_read_b64_tr_b16 v[212:213], v229 offset:20992
    ds_read_b64_tr_b16 v[214:215], v229 offset:21248
    s_waitcnt lgkmcnt(8)
    v_mfma_f32_16x16x32_bf16 v[176:179], v[216:219], v[56:59], v[176:179]
    v_permlane16_swap_b32 v50, v54
    v_mfma_f32_16x16x32_bf16 v[184:187], v[216:219], v[60:63], v[184:187]
    v_xor_b32 v237, 32, v254
    ds_read_b64_tr_b16 v[244:245], v237
    ds_read_b64_tr_b16 v[246:247], v237 offset:1024
    ds_read_b64_tr_b16 v[216:217], v229 offset:28672
    ds_read_b64_tr_b16 v[218:219], v229 offset:28928
    s_waitcnt lgkmcnt(10)
    v_mfma_f32_16x16x32_bf16 v[192:195], v[220:223], v[56:59], v[192:195]
    v_permlane16_swap_b32 v51, v55
    v_mfma_f32_16x16x32_bf16 v[200:203], v[220:223], v[60:63], v[200:203]
    ds_read_b64_tr_b16 v[220:221], v229 offset:29184
    ds_read_b64_tr_b16 v[222:223], v229 offset:29440
    s_waitcnt lgkmcnt(8)
    v_mfma_f32_16x16x32_bf16 v[148:151], v[208:211], v[56:59], v[148:151]
    v_mfma_f32_16x16x32_bf16 v[156:159], v[208:211], v[60:63], v[156:159]
    ds_read_b64_tr_b16 v[208:209], v228 offset:32768
    ds_read_b64_tr_b16 v[210:211], v228 offset:33024
    s_waitcnt lgkmcnt(8)
    v_mfma_f32_16x16x32_bf16 v[164:167], v[212:215], v[56:59], v[164:167]
    v_mfma_f32_16x16x32_bf16 v[172:175], v[212:215], v[60:63], v[172:175]
    ds_read_b64_tr_b16 v[212:213], v228 offset:33280
    ds_read_b64_tr_b16 v[214:215], v228 offset:33536
    s_waitcnt lgkmcnt(6)
    v_mfma_f32_16x16x32_bf16 v[180:183], v[216:219], v[56:59], v[180:183]
    v_mfma_f32_16x16x32_bf16 v[188:191], v[216:219], v[60:63], v[188:191]
    buffer_store_dwordx4 v[240:243], v250, s[60:63], s78 offen sc1
    ds_read_b64_tr_b16 v[216:217], v228 offset:40960
    ds_read_b64_tr_b16 v[218:219], v228 offset:41216
    s_waitcnt lgkmcnt(6)
    v_mfma_f32_16x16x32_bf16 v[196:199], v[220:223], v[56:59], v[196:199]
    v_mfma_f32_16x16x32_bf16 v[204:207], v[220:223], v[60:63], v[204:207]
    ds_read_b64_tr_b16 v[220:221], v228 offset:41472
    ds_read_b64_tr_b16 v[222:223], v228 offset:41728
    s_waitcnt lgkmcnt(6)
    v_mfma_f32_16x16x32_bf16 v[144:147], v[208:211], v[64:67], v[144:147]
    v_permlane16_swap_b32 v56, v60
    v_mfma_f32_16x16x32_bf16 v[152:155], v[208:211], v[68:71], v[152:155]
    ds_read_b64_tr_b16 v[208:209], v229 offset:32768
    ds_read_b64_tr_b16 v[210:211], v229 offset:33024
    s_waitcnt lgkmcnt(6)
    v_mfma_f32_16x16x32_bf16 v[160:163], v[212:215], v[64:67], v[160:163]
    v_permlane16_swap_b32 v57, v61
    v_mfma_f32_16x16x32_bf16 v[168:171], v[212:215], v[68:71], v[168:171]
    s_add_u32 m0, s24, 73728
    s_mov_b64 exec, s[30:31]
    global_load_lds_dwordx4 v[234:235], off
    s_mov_b64 exec, -1
    v_add_co_u32 v234, s[70:71], v234, v236
    s_nop 1
    v_addc_co_u32 v235, s[70:71], 0, v235, s[70:71]
    ds_read_b64_tr_b16 v[212:213], v229 offset:33280
    ds_read_b64_tr_b16 v[214:215], v229 offset:33536
    s_waitcnt lgkmcnt(6)
    v_mfma_f32_16x16x32_bf16 v[176:179], v[216:219], v[64:67], v[176:179]
    v_permlane16_swap_b32 v58, v62
    v_mfma_f32_16x16x32_bf16 v[184:187], v[216:219], v[68:71], v[184:187]
    v_xor_b32 v237, 64, v254
    ds_read_b64_tr_b16 v[240:241], v237
    ds_read_b64_tr_b16 v[242:243], v237 offset:1024
    ds_read_b64_tr_b16 v[216:217], v229 offset:40960
    ds_read_b64_tr_b16 v[218:219], v229 offset:41216
    s_waitcnt lgkmcnt(8)
    v_mfma_f32_16x16x32_bf16 v[192:195], v[220:223], v[64:67], v[192:195]
    v_permlane16_swap_b32 v59, v63
    v_mfma_f32_16x16x32_bf16 v[200:203], v[220:223], v[68:71], v[200:203]
    ds_read_b64_tr_b16 v[220:221], v229 offset:41472
    ds_read_b64_tr_b16 v[222:223], v229 offset:41728
    s_waitcnt lgkmcnt(8)
    v_mfma_f32_16x16x32_bf16 v[148:151], v[208:211], v[64:67], v[148:151]
    v_mfma_f32_16x16x32_bf16 v[156:159], v[208:211], v[68:71], v[156:159]
    buffer_store_dwordx4 v[244:247], v251, s[60:63], s78 offen sc1
    ds_read_b64_tr_b16 v[208:209], v228 offset:36864
    ds_read_b64_tr_b16 v[210:211], v228 offset:37120
    s_waitcnt lgkmcnt(8)
    v_mfma_f32_16x16x32_bf16 v[164:167], v[212:215], v[64:67], v[164:167]
    v_mfma_f32_16x16x32_bf16 v[172:175], v[212:215], v[68:71], v[172:175]
    ds_read_b64_tr_b16 v[212:213], v228 offset:37376
    ds_read_b64_tr_b16 v[214:215], v228 offset:37632
    s_waitcnt lgkmcnt(6)
    v_mfma_f32_16x16x32_bf16 v[180:183], v[216:219], v[64:67], v[180:183]
    v_mfma_f32_16x16x32_bf16 v[188:191], v[216:219], v[68:71], v[188:191]
    ds_read_b64_tr_b16 v[216:217], v228 offset:45056
    ds_read_b64_tr_b16 v[218:219], v228 offset:45312
    s_waitcnt lgkmcnt(6)
    v_mfma_f32_16x16x32_bf16 v[196:199], v[220:223], v[64:67], v[196:199]
    v_mfma_f32_16x16x32_bf16 v[204:207], v[220:223], v[68:71], v[204:207]
    s_barrier
    ds_read_b64_tr_b16 v[220:221], v228 offset:45568
    ds_read_b64_tr_b16 v[222:223], v228 offset:45824
    s_waitcnt lgkmcnt(6)
    v_mfma_f32_16x16x32_bf16 v[144:147], v[208:211], v[72:75], v[144:147]
    v_permlane16_swap_b32 v64, v68
    v_mfma_f32_16x16x32_bf16 v[152:155], v[208:211], v[76:79], v[152:155]
    v_xor_b32 v237, 96, v254
    ds_read_b64_tr_b16 v[244:245], v237
    ds_read_b64_tr_b16 v[246:247], v237 offset:1024
    ds_read_b64_tr_b16 v[208:209], v229 offset:36864
    ds_read_b64_tr_b16 v[210:211], v229 offset:37120
    s_waitcnt lgkmcnt(8)
    v_mfma_f32_16x16x32_bf16 v[160:163], v[212:215], v[72:75], v[160:163]
    v_permlane16_swap_b32 v65, v69
    v_mfma_f32_16x16x32_bf16 v[168:171], v[212:215], v[76:79], v[168:171]
    s_add_u32 s25, s66, 0x36000
    s_add_u32 m0, s24, 81920
    s_mov_b64 exec, s[68:69]
    buffer_load_dwordx4 v233, s[40:43], s25 offen lds
    s_mov_b64 exec, -1
    ds_read_b64_tr_b16 v[212:213], v229 offset:37376
    ds_read_b64_tr_b16 v[214:215], v229 offset:37632
    s_waitcnt lgkmcnt(8)
    v_mfma_f32_16x16x32_bf16 v[176:179], v[216:219], v[72:75], v[176:179]
    v_permlane16_swap_b32 v66, v70
    v_mfma_f32_16x16x32_bf16 v[184:187], v[216:219], v[76:79], v[184:187]
    buffer_store_dwordx4 v[240:243], v252, s[60:63], s78 offen sc1
    ds_read_b64_tr_b16 v[216:217], v229 offset:45056
    ds_read_b64_tr_b16 v[218:219], v229 offset:45312
    s_waitcnt lgkmcnt(8)
    v_mfma_f32_16x16x32_bf16 v[192:195], v[220:223], v[72:75], v[192:195]
    v_permlane16_swap_b32 v67, v71
    v_mfma_f32_16x16x32_bf16 v[200:203], v[220:223], v[76:79], v[200:203]
    ds_read_b64_tr_b16 v[220:221], v229 offset:45568
    ds_read_b64_tr_b16 v[222:223], v229 offset:45824
    s_waitcnt lgkmcnt(6)
    v_mfma_f32_16x16x32_bf16 v[148:151], v[208:211], v[72:75], v[148:151]
    v_mfma_f32_16x16x32_bf16 v[156:159], v[208:211], v[76:79], v[156:159]
    v_xor_b32 v228, 0x10000, v228
    v_xor_b32 v229, 0x10000, v229
    v_xor_b32 v230, 0x10000, v230
    v_xor_b32 v231, 0x10000, v231
    v_xor_b32 v249, 0x10000, v249
    ds_read_b64_tr_b16 v[208:209], v228 offset:0
    ds_read_b64_tr_b16 v[210:211], v228 offset:256
    s_waitcnt lgkmcnt(6)
    v_mfma_f32_16x16x32_bf16 v[164:167], v[212:215], v[72:75], v[164:167]
    v_mfma_f32_16x16x32_bf16 v[172:175], v[212:215], v[76:79], v[172:175]
    ds_read_b64_tr_b16 v[212:213], v228 offset:512
    ds_read_b64_tr_b16 v[214:215], v228 offset:768
    s_waitcnt lgkmcnt(6)
    v_mfma_f32_16x16x32_bf16 v[180:183], v[216:219], v[72:75], v[180:183]
    v_mfma_f32_16x16x32_bf16 v[188:191], v[216:219], v[76:79], v[188:191]
    buffer_store_dwordx4 v[244:247], v253, s[60:63], s78 offen sc1
    ds_read_b64_tr_b16 v[216:217], v228 offset:8192
    ds_read_b64_tr_b16 v[218:219], v228 offset:8448
    s_waitcnt lgkmcnt(6)
    v_mfma_f32_16x16x32_bf16 v[196:199], v[220:223], v[72:75], v[196:199]
    v_mfma_f32_16x16x32_bf16 v[204:207], v[220:223], v[76:79], v[204:207]
    ds_read_b64_tr_b16 v[220:221], v228 offset:8704
    ds_read_b64_tr_b16 v[222:223], v228 offset:8960
    s_waitcnt lgkmcnt(6)
    v_mfma_f32_16x16x32_bf16 v[144:147], v[208:211], v[80:83], v[144:147]
    v_permlane16_swap_b32 v72, v76
    v_mfma_f32_16x16x32_bf16 v[152:155], v[208:211], v[84:87], v[152:155]
    ds_read_b64_tr_b16 v[208:209], v229 offset:0
    ds_read_b64_tr_b16 v[210:211], v229 offset:256
    s_waitcnt lgkmcnt(6)
    v_mfma_f32_16x16x32_bf16 v[160:163], v[212:215], v[80:83], v[160:163]
    v_permlane16_swap_b32 v73, v77
    v_mfma_f32_16x16x32_bf16 v[168:171], v[212:215], v[84:87], v[168:171]
    s_add_u32 m0, s24, 90112
    s_mov_b64 exec, s[30:31]
    global_load_lds_dwordx4 v[234:235], off
    s_mov_b64 exec, -1
    v_add_co_u32 v234, s[70:71], v234, v236
    s_nop 1
    v_addc_co_u32 v235, s[70:71], 0, v235, s[70:71]
    ds_read_b64_tr_b16 v[212:213], v229 offset:512
    ds_read_b64_tr_b16 v[214:215], v229 offset:768
    s_waitcnt lgkmcnt(6)
    v_mfma_f32_16x16x32_bf16 v[176:179], v[216:219], v[80:83], v[176:179]
    v_permlane16_swap_b32 v74, v78
    v_mfma_f32_16x16x32_bf16 v[184:187], v[216:219], v[84:87], v[184:187]
    v_mov_b32 v240, 0
    v_mov_b32 v241, 0
    v_mov_b32 v242, 0
    v_mov_b32 v243, 0
    ds_read_b64_tr_b16 v[216:217], v229 offset:8192
    ds_read_b64_tr_b16 v[218:219], v229 offset:8448
    s_waitcnt lgkmcnt(6)
    v_mfma_f32_16x16x32_bf16 v[192:195], v[220:223], v[80:83], v[192:195]
    v_permlane16_swap_b32 v75, v79
    v_mfma_f32_16x16x32_bf16 v[200:203], v[220:223], v[84:87], v[200:203]
    ds_read_b64_tr_b16 v[220:221], v229 offset:8704
    ds_read_b64_tr_b16 v[222:223], v229 offset:8960
    s_waitcnt lgkmcnt(6)
    v_mfma_f32_16x16x32_bf16 v[148:151], v[208:211], v[80:83], v[148:151]
    v_mfma_f32_16x16x32_bf16 v[156:159], v[208:211], v[84:87], v[156:159]
    v_mov_b32 v244, 0
    v_mov_b32 v245, 0
    v_mov_b32 v246, 0
    v_mov_b32 v247, 0
    ds_read_b64_tr_b16 v[208:209], v228 offset:4096
    ds_read_b64_tr_b16 v[210:211], v228 offset:4352
    s_waitcnt lgkmcnt(6)
    v_mfma_f32_16x16x32_bf16 v[164:167], v[212:215], v[80:83], v[164:167]
    v_mfma_f32_16x16x32_bf16 v[172:175], v[212:215], v[84:87], v[172:175]
    ds_read_b64_tr_b16 v[212:213], v228 offset:4608
    ds_read_b64_tr_b16 v[214:215], v228 offset:4864
    s_waitcnt lgkmcnt(6)
    v_mfma_f32_16x16x32_bf16 v[180:183], v[216:219], v[80:83], v[180:183]
    v_mfma_f32_16x16x32_bf16 v[188:191], v[216:219], v[84:87], v[188:191]
    ds_read_b64_tr_b16 v[216:217], v228 offset:12288
    ds_read_b64_tr_b16 v[218:219], v228 offset:12544
    s_waitcnt lgkmcnt(6)
    v_mfma_f32_16x16x32_bf16 v[196:199], v[220:223], v[80:83], v[196:199]
    v_mfma_f32_16x16x32_bf16 v[204:207], v[220:223], v[84:87], v[204:207]
    s_waitcnt vmcnt(10)
    s_barrier
    ds_read_b64_tr_b16 v[220:221], v228 offset:12800
    ds_read_b64_tr_b16 v[222:223], v228 offset:13056
    s_waitcnt lgkmcnt(6)
    v_mfma_f32_16x16x32_bf16 v[144:147], v[208:211], v[88:91], v[144:147]
    v_permlane16_swap_b32 v80, v84
    v_mfma_f32_16x16x32_bf16 v[152:155], v[208:211], v[92:95], v[152:155]
    s_add_u32 s25, s66, 0x6c000
    s_add_u32 m0, s24, 98304
    s_mov_b64 exec, s[68:69]
    buffer_load_dwordx4 v233, s[40:43], s25 offen lds
    s_mov_b64 exec, -1
    ds_read_b64_tr_b16 v[208:209], v229 offset:4096
    ds_read_b64_tr_b16 v[210:211], v229 offset:4352
    s_waitcnt lgkmcnt(6)
    v_mfma_f32_16x16x32_bf16 v[160:163], v[212:215], v[88:91], v[160:163]
    v_permlane16_swap_b32 v81, v85
    v_mfma_f32_16x16x32_bf16 v[168:171], v[212:215], v[92:95], v[168:171]
    ds_read_b64_tr_b16 v[212:213], v229 offset:4608
    ds_read_b64_tr_b16 v[214:215], v229 offset:4864
    s_waitcnt lgkmcnt(6)
    v_mfma_f32_16x16x32_bf16 v[176:179], v[216:219], v[88:91], v[176:179]
    v_permlane16_swap_b32 v82, v86
    v_mfma_f32_16x16x32_bf16 v[184:187], v[216:219], v[92:95], v[184:187]
    ds_read_b64_tr_b16 v[216:217], v229 offset:12288
    ds_read_b64_tr_b16 v[218:219], v229 offset:12544
    s_waitcnt lgkmcnt(6)
    v_mfma_f32_16x16x32_bf16 v[192:195], v[220:223], v[88:91], v[192:195]
    v_permlane16_swap_b32 v83, v87
    v_mfma_f32_16x16x32_bf16 v[200:203], v[220:223], v[92:95], v[200:203]
    s_add_u32 m0, s24, 106496
    s_mov_b64 exec, s[30:31]
    global_load_lds_dwordx4 v[234:235], off
    s_mov_b64 exec, -1
    v_add_co_u32 v234, s[70:71], v234, v236
    s_nop 1
    v_addc_co_u32 v235, s[70:71], 0, v235, s[70:71]
    ds_read_b64_tr_b16 v[220:221], v229 offset:12800
    ds_read_b64_tr_b16 v[222:223], v229 offset:13056
    s_waitcnt lgkmcnt(6)
    v_mfma_f32_16x16x32_bf16 v[148:151], v[208:211], v[88:91], v[148:151]
    v_mfma_f32_16x16x32_bf16 v[156:159], v[208:211], v[92:95], v[156:159]
    ds_read_b64_tr_b16 v[208:209], v228 offset:16384
    ds_read_b64_tr_b16 v[210:211], v228 offset:16640
    s_waitcnt lgkmcnt(6)
    v_mfma_f32_16x16x32_bf16 v[164:167], v[212:215], v[88:91], v[164:167]
    v_mfma_f32_16x16x32_bf16 v[172:175], v[212:215], v[92:95], v[172:175]
    ds_read_b64_tr_b16 v[212:213], v228 offset:24576
    ds_read_b64_tr_b16 v[214:215], v228 offset:24832
    s_waitcnt lgkmcnt(6)
    v_mfma_f32_16x16x32_bf16 v[180:183], v[216:219], v[88:91], v[180:183]
    v_mfma_f32_16x16x32_bf16 v[188:191], v[216:219], v[92:95], v[188:191]
    v_lshrrev_b32 v237, 8, v238
    v_lshlrev_b32 v237, 9, v237
    s_movk_i32 s75, 0xf0
    v_and_or_b32 v237, v238, s75, v237
    s_lshl_b32 s74, s22, 3
    s_max_u32 s74, s74, 1
    s_sub_u32 s74, s74, 1
    s_mul_i32 s74, s74, 36864
    s_lshl_b32 s75, s3, 11
    s_add_u32 s74, s74, s75
    s_add_u32 s74, s74, 256
    s_add_u32 m0, s24, 139264
    s_nop 0
    buffer_load_dwordx4 v237, s[44:47], s74 offen lds
    s_add_u32 s74, s74, 16384
    ds_read_b64_tr_b16 v[216:217], v229 offset:16384
    ds_read_b64_tr_b16 v[218:219], v229 offset:16640
    s_waitcnt lgkmcnt(6)
    v_mfma_f32_16x16x32_bf16 v[196:199], v[220:223], v[88:91], v[196:199]
    v_mfma_f32_16x16x32_bf16 v[204:207], v[220:223], v[92:95], v[204:207]
    ds_read_b64_tr_b16 v[220:221], v229 offset:24576
    ds_read_b64_tr_b16 v[222:223], v229 offset:24832
    s_waitcnt lgkmcnt(6)
    v_mfma_f32_16x16x32_bf16 v[144:147], v[208:211], v[96:99], v[144:147]
    v_permlane16_swap_b32 v88, v92
    v_mfma_f32_16x16x32_bf16 v[152:155], v[208:211], v[100:103], v[152:155]
    ds_read_b64_tr_b16 v[208:209], v228 offset:20480
    ds_read_b64_tr_b16 v[210:211], v228 offset:20736
    s_waitcnt lgkmcnt(6)
    v_mfma_f32_16x16x32_bf16 v[176:179], v[212:215], v[96:99], v[176:179]
    v_permlane16_swap_b32 v89, v93
    v_mfma_f32_16x16x32_bf16 v[184:187], v[212:215], v[100:103], v[184:187]
    s_add_u32 m0, s24, 147456
    s_nop 0
    buffer_load_dwordx4 v237, s[44:47], s74 offen lds
    s_add_u32 s74, s74, 16384
    ds_read_b64_tr_b16 v[212:213], v228 offset:28672
    ds_read_b64_tr_b16 v[214:215], v228 offset:28928
    s_waitcnt lgkmcnt(6)
    v_mfma_f32_16x16x32_bf16 v[148:151], v[216:219], v[96:99], v[148:151]
    v_permlane16_swap_b32 v90, v94
    v_mfma_f32_16x16x32_bf16 v[156:159], v[216:219], v[100:103], v[156:159]
    ds_read_b64_tr_b16 v[216:217], v229 offset:20480
    ds_read_b64_tr_b16 v[218:219], v229 offset:20736
    s_waitcnt lgkmcnt(6)
    v_mfma_f32_16x16x32_bf16 v[180:183], v[220:223], v[96:99], v[180:183]
    v_permlane16_swap_b32 v91, v95
    v_mfma_f32_16x16x32_bf16 v[188:191], v[220:223], v[100:103], v[188:191]
    ds_read_b64_tr_b16 v[220:221], v229 offset:28672
    ds_read_b64_tr_b16 v[222:223], v229 offset:28928
    s_waitcnt lgkmcnt(6)
    v_mfma_f32_16x16x32_bf16 v[144:147], v[208:211], v[104:107], v[144:147]
    v_mfma_f32_16x16x32_bf16 v[152:155], v[208:211], v[108:111], v[152:155]
    s_cmp_ge_u32 s3, 2
    s_cbranch_scc1 K_NOH3
    s_add_u32 m0, s24, 155648
    s_nop 0
    buffer_load_dwordx4 v237, s[44:47], s74 offen lds
K_NOH3:
    ds_read_b64_tr_b16 v[208:209], v228 offset:32768
    ds_read_b64_tr_b16 v[210:211], v228 offset:33024
    s_waitcnt lgkmcnt(6)
    v_mfma_f32_16x16x32_bf16 v[176:179], v[212:215], v[104:107], v[176:179]
    v_mfma_f32_16x16x32_bf16 v[184:187], v[212:215], v[108:111], v[184:187]
    ds_read_b64_tr_b16 v[212:213], v228 offset:40960
    ds_read_b64_tr_b16 v[214:215], v228 offset:41216
    s_waitcnt lgkmcnt(6)
    v_mfma_f32_16x16x32_bf16 v[148:151], v[216:219], v[104:107], v[148:151]
    v_mfma_f32_16x16x32_bf16 v[156:159], v[216:219], v[108:111], v[156:159]
    ds_read_b64_tr_b16 v[216:217], v229 offset:32768
    ds_read_b64_tr_b16 v[218:219], v229 offset:33024
    s_waitcnt lgkmcnt(6)
    v_mfma_f32_16x16x32_bf16 v[180:183], v[220:223], v[104:107], v[180:183]
    v_mfma_f32_16x16x32_bf16 v[188:191], v[220:223], v[108:111], v[188:191]
    s_waitcnt vmcnt(12)
    s_barrier
    ds_read_b64_tr_b16 v[220:221], v229 offset:40960
    ds_read_b64_tr_b16 v[222:223], v229 offset:41216
    s_waitcnt lgkmcnt(6)
    v_mfma_f32_16x16x32_bf16 v[144:147], v[208:211], v[112:115], v[144:147]
    v_mfma_f32_16x16x32_bf16 v[152:155], v[208:211], v[116:119], v[152:155]
    ds_read_b64_tr_b16 v[208:209], v228 offset:36864
    ds_read_b64_tr_b16 v[210:211], v228 offset:37120
    s_waitcnt lgkmcnt(6)
    v_mfma_f32_16x16x32_bf16 v[176:179], v[212:215], v[112:115], v[176:179]
    v_mfma_f32_16x16x32_bf16 v[184:187], v[212:215], v[116:119], v[184:187]
    s_add_u32 s25, s66, 0xa2000
    s_add_u32 m0, s24, 0
    s_mov_b64 exec, s[68:69]
    buffer_load_dwordx4 v233, s[40:43], s25 offen lds
    s_mov_b64 exec, -1
    ds_read_b64_tr_b16 v[212:213], v228 offset:45056
    ds_read_b64_tr_b16 v[214:215], v228 offset:45312
    s_waitcnt lgkmcnt(6)
    v_mfma_f32_16x16x32_bf16 v[148:151], v[216:219], v[112:115], v[148:151]
    v_mfma_f32_16x16x32_bf16 v[156:159], v[216:219], v[116:119], v[156:159]
    ds_read_b64_tr_b16 v[216:217], v229 offset:36864
    ds_read_b64_tr_b16 v[218:219], v229 offset:37120
    s_waitcnt lgkmcnt(6)
    v_mfma_f32_16x16x32_bf16 v[180:183], v[220:223], v[112:115], v[180:183]
    v_mfma_f32_16x16x32_bf16 v[188:191], v[220:223], v[116:119], v[188:191]
    ds_read_b64_tr_b16 v[220:221], v229 offset:45056
    ds_read_b64_tr_b16 v[222:223], v229 offset:45312
    s_waitcnt lgkmcnt(6)
    v_mfma_f32_16x16x32_bf16 v[144:147], v[208:211], v[120:123], v[144:147]
    v_mfma_f32_16x16x32_bf16 v[152:155], v[208:211], v[124:127], v[152:155]
    ds_read_b64_tr_b16 v[208:209], v228 offset:49152
    ds_read_b64_tr_b16 v[210:211], v228 offset:49408
    s_waitcnt lgkmcnt(6)
    v_mfma_f32_16x16x32_bf16 v[176:179], v[212:215], v[120:123], v[176:179]
    v_mfma_f32_16x16x32_bf16 v[184:187], v[212:215], v[124:127], v[184:187]
    ds_read_b64_tr_b16 v[212:213], v228 offset:57344
    ds_read_b64_tr_b16 v[214:215], v228 offset:57600
    s_waitcnt lgkmcnt(6)
    v_mfma_f32_16x16x32_bf16 v[148:151], v[216:219], v[120:123], v[148:151]
    v_mfma_f32_16x16x32_bf16 v[156:159], v[216:219], v[124:127], v[156:159]
    ds_read_b64_tr_b16 v[216:217], v229 offset:49152
    ds_read_b64_tr_b16 v[218:219], v229 offset:49408
    s_waitcnt lgkmcnt(6)
    v_mfma_f32_16x16x32_bf16 v[180:183], v[220:223], v[120:123], v[180:183]
    v_mfma_f32_16x16x32_bf16 v[188:191], v[220:223], v[124:127], v[188:191]
    ds_read_b64_tr_b16 v[220:221], v229 offset:57344
    ds_read_b64_tr_b16 v[222:223], v229 offset:57600
    s_waitcnt lgkmcnt(6)
    v_mfma_f32_16x16x32_bf16 v[144:147], v[208:211], v[128:131], v[144:147]
    v_mfma_f32_16x16x32_bf16 v[152:155], v[208:211], v[132:135], v[152:155]
    ds_read_b64_tr_b16 v[208:209], v228 offset:53248
    ds_read_b64_tr_b16 v[210:211], v228 offset:53504
    s_waitcnt lgkmcnt(6)
    v_mfma_f32_16x16x32_bf16 v[176:179], v[212:215], v[128:131], v[176:179]
    v_mfma_f32_16x16x32_bf16 v[184:187], v[212:215], v[132:135], v[184:187]
    s_add_u32 m0, s24, 8192
    s_mov_b64 exec, s[30:31]
    global_load_lds_dwordx4 v[234:235], off
    s_mov_b64 exec, -1
    v_add_co_u32 v234, s[70:71], v234, v236
    s_nop 1
    v_addc_co_u32 v235, s[70:71], 0, v235, s[70:71]
    ds_read_b64_tr_b16 v[212:213], v228 offset:61440
    ds_read_b64_tr_b16 v[214:215], v228 offset:61696
    s_waitcnt lgkmcnt(6)
    v_mfma_f32_16x16x32_bf16 v[148:151], v[216:219], v[128:131], v[148:151]
    v_mfma_f32_16x16x32_bf16 v[156:159], v[216:219], v[132:135], v[156:159]
    ds_read_b64_tr_b16 v[216:217], v229 offset:53248
    ds_read_b64_tr_b16 v[218:219], v229 offset:53504
    s_waitcnt lgkmcnt(6)
    v_mfma_f32_16x16x32_bf16 v[180:183], v[220:223], v[128:131], v[180:183]
    v_mfma_f32_16x16x32_bf16 v[188:191], v[220:223], v[132:135], v[188:191]
    ds_read_b64_tr_b16 v[220:221], v229 offset:61440
    ds_read_b64_tr_b16 v[222:223], v229 offset:61696
    s_waitcnt lgkmcnt(6)
    v_mfma_f32_16x16x32_bf16 v[144:147], v[208:211], v[136:139], v[144:147]
    v_mfma_f32_16x16x32_bf16 v[152:155], v[208:211], v[140:143], v[152:155]
    ds_read_b64_tr_b16 v[208:209], v228 offset:16896
    ds_read_b64_tr_b16 v[210:211], v228 offset:17152
    s_waitcnt lgkmcnt(6)
    v_mfma_f32_16x16x32_bf16 v[176:179], v[212:215], v[136:139], v[176:179]
    v_mfma_f32_16x16x32_bf16 v[184:187], v[212:215], v[140:143], v[184:187]
    ds_read_b64_tr_b16 v[212:213], v228 offset:25088
    ds_read_b64_tr_b16 v[214:215], v228 offset:25344
    s_waitcnt lgkmcnt(6)
    v_mfma_f32_16x16x32_bf16 v[148:151], v[216:219], v[136:139], v[148:151]
    v_mfma_f32_16x16x32_bf16 v[156:159], v[216:219], v[140:143], v[156:159]
    ds_read_b64_tr_b16 v[216:217], v229 offset:16896
    ds_read_b64_tr_b16 v[218:219], v229 offset:17152
    s_waitcnt lgkmcnt(6)
    v_mfma_f32_16x16x32_bf16 v[180:183], v[220:223], v[136:139], v[180:183]
    v_mfma_f32_16x16x32_bf16 v[188:191], v[220:223], v[140:143], v[188:191]
    s_barrier
    ds_read_b64_tr_b16 v[220:221], v229 offset:25088
    ds_read_b64_tr_b16 v[222:223], v229 offset:25344
    s_waitcnt lgkmcnt(6)
    v_mfma_f32_16x16x32_bf16 v[160:163], v[208:211], v[96:99], v[160:163]
    v_mfma_f32_16x16x32_bf16 v[168:171], v[208:211], v[100:103], v[168:171]
    ds_read_b64_tr_b16 v[208:209], v228 offset:20992
    ds_read_b64_tr_b16 v[210:211], v228 offset:21248
    s_waitcnt lgkmcnt(6)
    v_mfma_f32_16x16x32_bf16 v[192:195], v[212:215], v[96:99], v[192:195]
    s_and_b32 s67, s23, 7
    s_lshl_b32 s67, s67, 11
    s_lshr_b32 s26, s23, 3
    s_mul_i32 s26, s26, 36864
    s_add_u32 s67, s67, s26
    s_add_u32 s67, s67, 16384
    s_mul_i32 s26, s28, 165888
    s_add_u32 s67, s67, s26
    s_add_u32 s98, s67, 165888
    v_mul_f32 v176, v144, v176
    v_mfma_f32_16x16x32_bf16 v[200:203], v[212:215], v[100:103], v[200:203]
    v_mul_f32 v144, s64, v144
    v_mul_f32 v177, v145, v177
    v_mul_f32 v145, s64, v145
    v_mul_f32 v178, v146, v178
    v_mul_f32 v146, s64, v146
    ds_read_b64_tr_b16 v[212:213], v228 offset:29184
    ds_read_b64_tr_b16 v[214:215], v228 offset:29440
    s_waitcnt lgkmcnt(6)
    v_mfma_f32_16x16x32_bf16 v[164:167], v[216:219], v[96:99], v[164:167]
    v_mul_f32 v179, v147, v179
    v_mul_f32 v147, s64, v147
    v_mfma_f32_16x16x32_bf16 v[172:175], v[216:219], v[100:103], v[172:175]
    v_mul_f32 v180, v148, v180
    v_mul_f32 v148, s64, v148
    v_mul_f32 v181, v149, v181
    v_mul_f32 v149, s64, v149
    v_mul_f32 v182, v150, v182
    ds_read_b64_tr_b16 v[216:217], v229 offset:20992
    ds_read_b64_tr_b16 v[218:219], v229 offset:21248
    s_waitcnt lgkmcnt(6)
    v_mfma_f32_16x16x32_bf16 v[196:199], v[220:223], v[96:99], v[196:199]
    v_mul_f32 v150, s64, v150
    v_mul_f32 v183, v151, v183
    v_mfma_f32_16x16x32_bf16 v[204:207], v[220:223], v[100:103], v[204:207]
    v_mul_f32 v151, s64, v151
    v_exp_f32 v144, v144
    v_exp_f32 v145, v145
    v_add_f32 v144, 1.0, v144
    v_exp_f32 v146, v146
    ds_read_b64_tr_b16 v[220:221], v229 offset:29184
    ds_read_b64_tr_b16 v[222:223], v229 offset:29440
    s_waitcnt lgkmcnt(6)
    v_mfma_f32_16x16x32_bf16 v[160:163], v[208:211], v[104:107], v[160:163]
    v_permlane16_swap_b32 v96, v100
    v_mfma_f32_16x16x32_bf16 v[168:171], v[208:211], v[108:111], v[168:171]
    v_add_f32 v145, 1.0, v145
    v_exp_f32 v147, v147
    v_add_f32 v146, 1.0, v146
    v_exp_f32 v148, v148
    v_add_f32 v147, 1.0, v147
    ds_read_b64_tr_b16 v[208:209], v228 offset:33280
    ds_read_b64_tr_b16 v[210:211], v228 offset:33536
    s_waitcnt lgkmcnt(6)
    v_mfma_f32_16x16x32_bf16 v[192:195], v[212:215], v[104:107], v[192:195]
    v_permlane16_swap_b32 v97, v101
    v_mfma_f32_16x16x32_bf16 v[200:203], v[212:215], v[108:111], v[200:203]
    v_exp_f32 v149, v149
    v_add_f32 v148, 1.0, v148
    v_exp_f32 v150, v150
    v_add_f32 v149, 1.0, v149
    v_exp_f32 v151, v151
    ds_read_b64_tr_b16 v[212:213], v228 offset:41472
    ds_read_b64_tr_b16 v[214:215], v228 offset:41728
    s_waitcnt lgkmcnt(6)
    v_mfma_f32_16x16x32_bf16 v[164:167], v[216:219], v[104:107], v[164:167]
    v_permlane16_swap_b32 v98, v102
    v_mfma_f32_16x16x32_bf16 v[172:175], v[216:219], v[108:111], v[172:175]
    v_add_f32 v150, 1.0, v150
    v_add_f32 v151, 1.0, v151
    v_rcp_f32 v144, v144
    v_rcp_f32 v145, v145
    v_mul_f32 v176, v176, v144
    ds_read_b64_tr_b16 v[216:217], v229 offset:33280
    ds_read_b64_tr_b16 v[218:219], v229 offset:33536
    s_waitcnt lgkmcnt(6)
    v_mfma_f32_16x16x32_bf16 v[196:199], v[220:223], v[104:107], v[196:199]
    v_permlane16_swap_b32 v99, v103
    v_mfma_f32_16x16x32_bf16 v[204:207], v[220:223], v[108:111], v[204:207]
    v_rcp_f32 v146, v146
    v_mul_f32 v177, v177, v145
    v_rcp_f32 v147, v147
    v_mul_f32 v178, v178, v146
    v_rcp_f32 v148, v148
    ds_read_b64_tr_b16 v[220:221], v229 offset:41472
    ds_read_b64_tr_b16 v[222:223], v229 offset:41728
    s_waitcnt lgkmcnt(6)
    v_mfma_f32_16x16x32_bf16 v[160:163], v[208:211], v[112:115], v[160:163]
    v_permlane16_swap_b32 v104, v108
    v_mfma_f32_16x16x32_bf16 v[168:171], v[208:211], v[116:119], v[168:171]
    v_mul_f32 v179, v179, v147
    v_rcp_f32 v149, v149
    v_mul_f32 v180, v180, v148
    v_rcp_f32 v150, v150
    v_mul_f32 v181, v181, v149
    ds_read_b64_tr_b16 v[208:209], v228 offset:37376
    ds_read_b64_tr_b16 v[210:211], v228 offset:37632
    s_waitcnt lgkmcnt(6)
    v_mfma_f32_16x16x32_bf16 v[192:195], v[212:215], v[112:115], v[192:195]
    v_permlane16_swap_b32 v105, v109
    v_mfma_f32_16x16x32_bf16 v[200:203], v[212:215], v[116:119], v[200:203]
    v_rcp_f32 v151, v151
    v_mul_f32 v182, v182, v150
    v_mul_f32 v183, v183, v151
    v_cvt_pk_bf16_f32 v144, v176, v177
    v_cvt_pk_bf16_f32 v145, v178, v179
    ds_read_b64_tr_b16 v[212:213], v228 offset:45568
    ds_read_b64_tr_b16 v[214:215], v228 offset:45824
    s_waitcnt lgkmcnt(6)
    v_mfma_f32_16x16x32_bf16 v[164:167], v[216:219], v[112:115], v[164:167]
    v_permlane16_swap_b32 v106, v110
    v_mfma_f32_16x16x32_bf16 v[172:175], v[216:219], v[116:119], v[172:175]
    v_cvt_pk_bf16_f32 v146, v180, v181
    v_cvt_pk_bf16_f32 v147, v182, v183
    buffer_store_dwordx4 v[144:147], v238, s[48:51], s67 offen offset:0 sc1
    v_mul_f32 v184, v152, v184
    v_mul_f32 v152, s64, v152
    ds_read_b64_tr_b16 v[216:217], v229 offset:37376
    ds_read_b64_tr_b16 v[218:219], v229 offset:37632
    s_waitcnt lgkmcnt(6)
    v_mfma_f32_16x16x32_bf16 v[196:199], v[220:223], v[112:115], v[196:199]
    v_permlane16_swap_b32 v107, v111
    v_mfma_f32_16x16x32_bf16 v[204:207], v[220:223], v[116:119], v[204:207]
    v_mul_f32 v185, v153, v185
    v_mul_f32 v153, s64, v153
    v_mul_f32 v186, v154, v186
    v_mul_f32 v154, s64, v154
    v_mul_f32 v187, v155, v187
    ds_read_b64_tr_b16 v[220:221], v229 offset:45568
    ds_read_b64_tr_b16 v[222:223], v229 offset:45824
    s_waitcnt lgkmcnt(6)
    v_mfma_f32_16x16x32_bf16 v[160:163], v[208:211], v[120:123], v[160:163]
    v_permlane16_swap_b32 v112, v116
    v_mfma_f32_16x16x32_bf16 v[168:171], v[208:211], v[124:127], v[168:171]
    v_mul_f32 v155, s64, v155
    v_mul_f32 v188, v156, v188
    v_mul_f32 v156, s64, v156
    v_mul_f32 v189, v157, v189
    v_mul_f32 v157, s64, v157
    ds_read_b64_tr_b16 v[208:209], v228 offset:49664
    ds_read_b64_tr_b16 v[210:211], v228 offset:49920
    s_waitcnt lgkmcnt(6)
    v_mfma_f32_16x16x32_bf16 v[192:195], v[212:215], v[120:123], v[192:195]
    v_permlane16_swap_b32 v113, v117
    v_mfma_f32_16x16x32_bf16 v[200:203], v[212:215], v[124:127], v[200:203]
    v_mul_f32 v190, v158, v190
    v_mul_f32 v158, s64, v158
    v_mul_f32 v191, v159, v191
    v_mul_f32 v159, s64, v159
    v_exp_f32 v152, v152
    ds_read_b64_tr_b16 v[212:213], v228 offset:57856
    ds_read_b64_tr_b16 v[214:215], v228 offset:58112
    s_waitcnt lgkmcnt(6)
    v_mfma_f32_16x16x32_bf16 v[164:167], v[216:219], v[120:123], v[164:167]
    v_permlane16_swap_b32 v114, v118
    v_mfma_f32_16x16x32_bf16 v[172:175], v[216:219], v[124:127], v[172:175]
    v_exp_f32 v153, v153
    v_add_f32 v152, 1.0, v152
    v_exp_f32 v154, v154
    v_add_f32 v153, 1.0, v153
    ds_read_b64_tr_b16 v[216:217], v229 offset:49664
    ds_read_b64_tr_b16 v[218:219], v229 offset:49920
    s_waitcnt lgkmcnt(6)
    v_mfma_f32_16x16x32_bf16 v[196:199], v[220:223], v[120:123], v[196:199]
    v_permlane16_swap_b32 v115, v119
    v_mfma_f32_16x16x32_bf16 v[204:207], v[220:223], v[124:127], v[204:207]
    v_exp_f32 v155, v155
    v_add_f32 v154, 1.0, v154
    v_exp_f32 v156, v156
    v_add_f32 v155, 1.0, v155
    s_waitcnt vmcnt(7)
    s_waitcnt vmcnt(3)
    s_barrier
    ds_read_b64_tr_b16 v[220:221], v229 offset:57856
    ds_read_b64_tr_b16 v[222:223], v229 offset:58112
    s_waitcnt lgkmcnt(6)
    v_mfma_f32_16x16x32_bf16 v[160:163], v[208:211], v[128:131], v[160:163]
    v_permlane16_swap_b32 v120, v124
    v_mfma_f32_16x16x32_bf16 v[168:171], v[208:211], v[132:135], v[168:171]
    s_add_u32 s25, s66, 0xd8000
    s_add_u32 m0, s24, 16384
    s_mov_b64 exec, s[68:69]
    buffer_load_dwordx4 v233, s[40:43], s25 offen lds
    s_mov_b64 exec, -1
    v_exp_f32 v157, v157
    v_add_f32 v156, 1.0, v156
    v_exp_f32 v158, v158
    v_add_f32 v157, 1.0, v157
    ds_read_b64_tr_b16 v[208:209], v228 offset:53760
    ds_read_b64_tr_b16 v[210:211], v228 offset:54016
    s_waitcnt lgkmcnt(6)
    v_mfma_f32_16x16x32_bf16 v[192:195], v[212:215], v[128:131], v[192:195]
    v_permlane16_swap_b32 v121, v125
    v_mfma_f32_16x16x32_bf16 v[200:203], v[212:215], v[132:135], v[200:203]
    v_exp_f32 v159, v159
    v_add_f32 v158, 1.0, v158
    v_add_f32 v159, 1.0, v159
    v_rcp_f32 v152, v152
    ds_read_b64_tr_b16 v[212:213], v228 offset:61952
    ds_read_b64_tr_b16 v[214:215], v228 offset:62208
    s_waitcnt lgkmcnt(6)
    v_mfma_f32_16x16x32_bf16 v[164:167], v[216:219], v[128:131], v[164:167]
    v_permlane16_swap_b32 v122, v126
    v_mfma_f32_16x16x32_bf16 v[172:175], v[216:219], v[132:135], v[172:175]
    v_rcp_f32 v153, v153
    v_mul_f32 v184, v184, v152
    v_rcp_f32 v154, v154
    v_mul_f32 v185, v185, v153
    ds_read_b64_tr_b16 v[216:217], v229 offset:53760
    ds_read_b64_tr_b16 v[218:219], v229 offset:54016
    s_waitcnt lgkmcnt(6)
    v_mfma_f32_16x16x32_bf16 v[196:199], v[220:223], v[128:131], v[196:199]
    v_permlane16_swap_b32 v123, v127
    v_mfma_f32_16x16x32_bf16 v[204:207], v[220:223], v[132:135], v[204:207]
    v_rcp_f32 v155, v155
    v_mul_f32 v186, v186, v154
    v_rcp_f32 v156, v156
    v_mul_f32 v187, v187, v155
    s_mov_b64 exec, s[72:73]
    ds_read_b128 v[240:243], v248 offset:0
    s_mov_b64 exec, -1
    s_mov_b64 exec, s[72:73]
    ds_read_b128 v[244:247], v248 offset:512
    s_mov_b64 exec, -1
    ds_read_b64_tr_b16 v[220:221], v229 offset:61952
    ds_read_b64_tr_b16 v[222:223], v229 offset:62208
    s_waitcnt lgkmcnt(8)
    v_mfma_f32_16x16x32_bf16 v[160:163], v[208:211], v[136:139], v[160:163]
    v_permlane16_swap_b32 v128, v132
    v_mfma_f32_16x16x32_bf16 v[168:171], v[208:211], v[140:143], v[168:171]
    s_add_u32 m0, s24, 24576
    s_mov_b64 exec, s[30:31]
    global_load_lds_dwordx4 v[234:235], off
    s_mov_b64 exec, -1
    v_add_co_u32 v234, s[70:71], v234, v236
    s_nop 1
    v_addc_co_u32 v235, s[70:71], 0, v235, s[70:71]
    v_rcp_f32 v157, v157
    v_mul_f32 v188, v188, v156
    v_rcp_f32 v158, v158
    v_mul_f32 v189, v189, v157
    v_xor_b32 v228, 0x10000, v228
    v_xor_b32 v229, 0x10000, v229
    v_xor_b32 v230, 0x10000, v230
    v_xor_b32 v231, 0x10000, v231
    v_xor_b32 v249, 0x10000, v249
    ds_read_b64_tr_b16 v[208:209], v249 offset:8192
    ds_read_b64_tr_b16 v[210:211], v249 offset:8704
    s_waitcnt lgkmcnt(8)
    v_mfma_f32_16x16x32_bf16 v[192:195], v[212:215], v[136:139], v[192:195]
    v_permlane16_swap_b32 v129, v133
    v_mfma_f32_16x16x32_bf16 v[200:203], v[212:215], v[140:143], v[200:203]
    v_rcp_f32 v159, v159
    v_mul_f32 v190, v190, v158
    v_mul_f32 v191, v191, v159
    v_cvt_pk_bf16_f32 v152, v184, v185
    ds_read_b64_tr_b16 v[212:213], v231 offset:0
    ds_read_b64_tr_b16 v[214:215], v231 offset:512
    s_waitcnt lgkmcnt(8)
    v_mfma_f32_16x16x32_bf16 v[164:167], v[216:219], v[136:139], v[164:167]
    v_permlane16_swap_b32 v130, v134
    v_mfma_f32_16x16x32_bf16 v[172:175], v[216:219], v[140:143], v[172:175]
    v_cvt_pk_bf16_f32 v153, v186, v187
    v_cvt_pk_bf16_f32 v154, v188, v189
    v_cvt_pk_bf16_f32 v155, v190, v191
    buffer_store_dwordx4 v[152:155], v238, s[48:51], s98 offen offset:0 sc1
    ds_read_b64_tr_b16 v[216:217], v249 offset:10240
    ds_read_b64_tr_b16 v[218:219], v249 offset:10752
    s_waitcnt lgkmcnt(6)
    v_mfma_f32_16x16x32_bf16 v[196:199], v[220:223], v[136:139], v[196:199]
    v_permlane16_swap_b32 v131, v135
    v_mfma_f32_16x16x32_bf16 v[204:207], v[220:223], v[140:143], v[204:207]
    s_add_u32 s25, s66, 0x10e000
    s_add_u32 m0, s24, 32768
    s_mov_b64 exec, s[68:69]
    buffer_load_dwordx4 v233, s[40:43], s25 offen lds
    s_mov_b64 exec, -1
    ds_read_b64_tr_b16 v[220:221], v231 offset:2048
    ds_read_b64_tr_b16 v[222:223], v231 offset:2560
    s_waitcnt lgkmcnt(6)
    v_mfma_f32_32x32x16_bf16 v[144:159], v[208:211], v[0:3], 0
    v_permlane16_swap_b32 v136, v140
    v_permlane16_swap_b32 v137, v141
    ds_read_b64_tr_b16 v[208:209], v249 offset:12288
    ds_read_b64_tr_b16 v[210:211], v249 offset:12800
    s_waitcnt lgkmcnt(6)
    v_mfma_f32_16x16x32_bf16 v[224:227], v[212:215], v[240:243], 0
    v_mfma_f32_32x32x16_bf16 v[176:191], v[212:215], v[0:3], 0
    v_permlane16_swap_b32 v138, v142
    v_permlane16_swap_b32 v139, v143
    s_mov_b64 exec, s[72:73]
    ds_read_b128 v[240:243], v248 offset:1024
    s_mov_b64 exec, -1
    v_mul_f32 v192, v160, v192
    v_mul_f32 v160, s64, v160
    v_mul_f32 v193, v161, v193
    v_mul_f32 v161, s64, v161
    v_mul_f32 v194, v162, v194
    ds_read_b64_tr_b16 v[212:213], v231 offset:4096
    ds_read_b64_tr_b16 v[214:215], v231 offset:4608
    s_waitcnt lgkmcnt(7)
    v_mfma_f32_32x32x16_bf16 v[144:159], v[216:219], v[4:7], v[144:159]
    s_add_u32 m0, s24, 40960
    s_mov_b64 exec, s[30:31]
    global_load_lds_dwordx4 v[234:235], off
    s_mov_b64 exec, -1
    v_add_co_u32 v234, s[70:71], v234, v236
    s_nop 1
    v_addc_co_u32 v235, s[70:71], 0, v235, s[70:71]
    v_mul_f32 v162, s64, v162
    v_mul_f32 v195, v163, v195
    v_mul_f32 v163, s64, v163
    v_mul_f32 v196, v164, v196
    v_mul_f32 v164, s64, v164
    ds_read_b64_tr_b16 v[216:217], v249 offset:14336
    ds_read_b64_tr_b16 v[218:219], v249 offset:14848
    s_waitcnt lgkmcnt(7)
    v_mfma_f32_16x16x32_bf16 v[224:227], v[220:223], v[244:247], v[224:227]
    v_mfma_f32_32x32x16_bf16 v[176:191], v[220:223], v[4:7], v[176:191]
    s_mov_b64 exec, s[72:73]
    ds_read_b128 v[244:247], v248 offset:1536
    s_mov_b64 exec, -1
    v_mul_f32 v197, v165, v197
    v_mul_f32 v165, s64, v165
    v_mul_f32 v198, v166, v198
    v_mul_f32 v166, s64, v166
    v_mul_f32 v199, v167, v199
    ds_read_b64_tr_b16 v[220:221], v231 offset:6144
    ds_read_b64_tr_b16 v[222:223], v231 offset:6656
    s_waitcnt lgkmcnt(8)
    v_mfma_f32_32x32x16_bf16 v[144:159], v[208:211], v[8:11], v[144:159]
    v_mul_f32 v167, s64, v167
    v_exp_f32 v160, v160
    v_exp_f32 v161, v161
    v_add_f32 v160, 1.0, v160
    v_exp_f32 v162, v162
    ds_read_b64_tr_b16 v[208:209], v249 offset:24576
    ds_read_b64_tr_b16 v[210:211], v249 offset:25088
    s_waitcnt lgkmcnt(7)
    v_mfma_f32_16x16x32_bf16 v[224:227], v[212:215], v[240:243], v[224:227]
    v_mfma_f32_32x32x16_bf16 v[176:191], v[212:215], v[8:11], v[176:191]
    s_mov_b64 exec, s[72:73]
    ds_read_b128 v[240:243], v248 offset:2048
    s_mov_b64 exec, -1
    v_add_f32 v161, 1.0, v161
    v_exp_f32 v163, v163
    v_add_f32 v162, 1.0, v162
    v_exp_f32 v164, v164
    v_add_f32 v163, 1.0, v163
    s_barrier
    ds_read_b64_tr_b16 v[212:213], v231 offset:16384
    ds_read_b64_tr_b16 v[214:215], v231 offset:16896
    s_waitcnt lgkmcnt(8)
    v_mfma_f32_32x32x16_bf16 v[144:159], v[216:219], v[12:15], v[144:159]
    v_exp_f32 v165, v165
    v_add_f32 v164, 1.0, v164
    v_exp_f32 v166, v166
    v_add_f32 v165, 1.0, v165
    v_exp_f32 v167, v167
    ds_read_b64_tr_b16 v[216:217], v249 offset:26624
    ds_read_b64_tr_b16 v[218:219], v249 offset:27136
    s_waitcnt lgkmcnt(7)
    v_mfma_f32_16x16x32_bf16 v[224:227], v[220:223], v[244:247], v[224:227]
    v_mfma_f32_32x32x16_bf16 v[176:191], v[220:223], v[12:15], v[176:191]
    s_mov_b64 exec, s[72:73]
    ds_read_b128 v[244:247], v248 offset:2560
    s_mov_b64 exec, -1
    s_add_u32 s25, s66, 0x144000
    s_add_u32 m0, s24, 49152
    s_mov_b64 exec, s[68:69]
    buffer_load_dwordx4 v233, s[40:43], s25 offen lds
    s_mov_b64 exec, -1
    v_add_f32 v166, 1.0, v166
    v_add_f32 v167, 1.0, v167
    v_rcp_f32 v160, v160
    v_rcp_f32 v161, v161
    v_mul_f32 v192, v192, v160
    ds_read_b64_tr_b16 v[220:221], v231 offset:18432
    ds_read_b64_tr_b16 v[222:223], v231 offset:18944
    s_waitcnt lgkmcnt(8)
    v_mfma_f32_32x32x16_bf16 v[144:159], v[208:211], v[16:19], v[144:159]
    v_rcp_f32 v162, v162
    v_mul_f32 v193, v193, v161
    v_rcp_f32 v163, v163
    v_mul_f32 v194, v194, v162
    v_rcp_f32 v164, v164
    ds_read_b64_tr_b16 v[208:209], v249 offset:28672
    ds_read_b64_tr_b16 v[210:211], v249 offset:29184
    s_waitcnt lgkmcnt(7)
    v_mfma_f32_16x16x32_bf16 v[224:227], v[212:215], v[240:243], v[224:227]
    v_mfma_f32_32x32x16_bf16 v[176:191], v[212:215], v[16:19], v[176:191]
    s_mov_b64 exec, s[72:73]
    ds_read_b128 v[240:243], v248 offset:3072
    s_mov_b64 exec, -1
    v_mul_f32 v195, v195, v163
    v_rcp_f32 v165, v165
    v_mul_f32 v196, v196, v164
    v_rcp_f32 v166, v166
    v_mul_f32 v197, v197, v165
    ds_read_b64_tr_b16 v[212:213], v231 offset:20480
    ds_read_b64_tr_b16 v[214:215], v231 offset:20992
    s_waitcnt lgkmcnt(8)
    v_mfma_f32_32x32x16_bf16 v[144:159], v[216:219], v[20:23], v[144:159]
    v_rcp_f32 v167, v167
    v_mul_f32 v198, v198, v166
    v_mul_f32 v199, v199, v167
    v_cvt_pk_bf16_f32 v160, v192, v193
    v_cvt_pk_bf16_f32 v161, v194, v195
    ds_read_b64_tr_b16 v[216:217], v249 offset:30720
    ds_read_b64_tr_b16 v[218:219], v249 offset:31232
    s_waitcnt lgkmcnt(7)
    v_mfma_f32_16x16x32_bf16 v[224:227], v[220:223], v[244:247], v[224:227]
    v_mfma_f32_32x32x16_bf16 v[176:191], v[220:223], v[20:23], v[176:191]
    s_mov_b64 exec, s[72:73]
    ds_read_b128 v[244:247], v248 offset:3584
    s_mov_b64 exec, -1
    v_cvt_pk_bf16_f32 v162, v196, v197
    v_cvt_pk_bf16_f32 v163, v198, v199
    buffer_store_dwordx4 v[160:163], v238, s[48:51], s67 offen offset:1024 sc1
    v_mul_f32 v200, v168, v200
    v_mul_f32 v168, s64, v168
    ds_read_b64_tr_b16 v[220:221], v231 offset:22528
    ds_read_b64_tr_b16 v[222:223], v231 offset:23040
    s_waitcnt lgkmcnt(8)
    v_mfma_f32_32x32x16_bf16 v[144:159], v[208:211], v[24:27], v[144:159]
    s_add_u32 m0, s24, 57344
    s_mov_b64 exec, s[30:31]
    global_load_lds_dwordx4 v[234:235], off
    s_mov_b64 exec, -1
    v_add_co_u32 v234, s[70:71], v234, v236
    s_nop 1
    v_addc_co_u32 v235, s[70:71], 0, v235, s[70:71]
    v_mul_f32 v201, v169, v201
    v_mul_f32 v169, s64, v169
    v_mul_f32 v202, v170, v202
    v_mul_f32 v170, s64, v170
    v_mul_f32 v203, v171, v203
    ds_read_b64_tr_b16 v[208:209], v249 offset:40960
    ds_read_b64_tr_b16 v[210:211], v249 offset:41472
    s_waitcnt lgkmcnt(7)
    v_mfma_f32_16x16x32_bf16 v[224:227], v[212:215], v[240:243], v[224:227]
    v_mfma_f32_32x32x16_bf16 v[176:191], v[212:215], v[24:27], v[176:191]
    s_mov_b64 exec, s[72:73]
    ds_read_b128 v[240:243], v248 offset:4096
    s_mov_b64 exec, -1
    v_mul_f32 v171, s64, v171
    v_mul_f32 v204, v172, v204
    v_mul_f32 v172, s64, v172
    v_mul_f32 v205, v173, v205
    v_mul_f32 v173, s64, v173
    ds_read_b64_tr_b16 v[212:213], v231 offset:32768
    ds_read_b64_tr_b16 v[214:215], v231 offset:33280
    s_waitcnt lgkmcnt(8)
    v_mfma_f32_32x32x16_bf16 v[144:159], v[216:219], v[28:31], v[144:159]
    v_mul_f32 v206, v174, v206
    v_mul_f32 v174, s64, v174
    v_mul_f32 v207, v175, v207
    v_mul_f32 v175, s64, v175
    v_exp_f32 v168, v168
    ds_read_b64_tr_b16 v[216:217], v249 offset:43008
    ds_read_b64_tr_b16 v[218:219], v249 offset:43520
    s_waitcnt lgkmcnt(7)
    v_mfma_f32_16x16x32_bf16 v[224:227], v[220:223], v[244:247], v[224:227]
    v_mfma_f32_32x32x16_bf16 v[176:191], v[220:223], v[28:31], v[176:191]
    s_mov_b64 exec, s[72:73]
    ds_read_b128 v[244:247], v248 offset:4608
    s_mov_b64 exec, -1
    v_exp_f32 v169, v169
    v_add_f32 v168, 1.0, v168
    v_exp_f32 v170, v170
    v_add_f32 v169, 1.0, v169
    v_exp_f32 v171, v171
    ds_read_b64_tr_b16 v[220:221], v231 offset:34816
    ds_read_b64_tr_b16 v[222:223], v231 offset:35328
    s_waitcnt lgkmcnt(8)
    v_mfma_f32_32x32x16_bf16 v[144:159], v[208:211], v[32:35], v[144:159]
    v_add_f32 v170, 1.0, v170
    v_exp_f32 v172, v172
    v_add_f32 v171, 1.0, v171
    v_exp_f32 v173, v173
    v_add_f32 v172, 1.0, v172
    ds_read_b64_tr_b16 v[208:209], v249 offset:45056
    ds_read_b64_tr_b16 v[210:211], v249 offset:45568
    s_waitcnt lgkmcnt(7)
    v_mfma_f32_16x16x32_bf16 v[224:227], v[212:215], v[240:243], v[224:227]
    v_mfma_f32_32x32x16_bf16 v[176:191], v[212:215], v[32:35], v[176:191]
    s_mov_b64 exec, s[72:73]
    ds_read_b128 v[240:243], v248 offset:5120
    s_mov_b64 exec, -1
    v_exp_f32 v174, v174
    v_add_f32 v173, 1.0, v173
    v_exp_f32 v175, v175
    v_add_f32 v174, 1.0, v174
    v_add_f32 v175, 1.0, v175
    s_barrier
    ds_read_b64_tr_b16 v[212:213], v231 offset:36864
    ds_read_b64_tr_b16 v[214:215], v231 offset:37376
    s_waitcnt lgkmcnt(8)
    v_mfma_f32_32x32x16_bf16 v[144:159], v[216:219], v[36:39], v[144:159]
    v_rcp_f32 v168, v168
    v_rcp_f32 v169, v169
    v_mul_f32 v200, v200, v168
    v_rcp_f32 v170, v170
    v_mul_f32 v201, v201, v169
    ds_read_b64_tr_b16 v[216:217], v249 offset:47104
    ds_read_b64_tr_b16 v[218:219], v249 offset:47616
    s_waitcnt lgkmcnt(7)
    v_mfma_f32_16x16x32_bf16 v[224:227], v[220:223], v[244:247], v[224:227]
    v_mfma_f32_32x32x16_bf16 v[176:191], v[220:223], v[36:39], v[176:191]
    s_mov_b64 exec, s[72:73]
    ds_read_b128 v[244:247], v248 offset:5632
    s_mov_b64 exec, -1
    v_rcp_f32 v171, v171
    v_mul_f32 v202, v202, v170
    v_rcp_f32 v172, v172
    v_mul_f32 v203, v203, v171
    ds_read_b64_tr_b16 v[220:221], v231 offset:38912
    ds_read_b64_tr_b16 v[222:223], v231 offset:39424
    s_waitcnt lgkmcnt(8)
    v_mfma_f32_32x32x16_bf16 v[144:159], v[208:211], v[40:43], v[144:159]
    v_rcp_f32 v173, v173
    v_mul_f32 v204, v204, v172
    v_rcp_f32 v174, v174
    v_mul_f32 v205, v205, v173
    ds_read_b64_tr_b16 v[208:209], v230 offset:0
    ds_read_b64_tr_b16 v[210:211], v230 offset:512
    s_waitcnt lgkmcnt(7)
    v_mfma_f32_16x16x32_bf16 v[224:227], v[212:215], v[240:243], v[224:227]
    v_mfma_f32_32x32x16_bf16 v[176:191], v[212:215], v[40:43], v[176:191]
    s_mov_b64 exec, s[72:73]
    ds_read_b128 v[240:243], v248 offset:6144
    s_mov_b64 exec, -1
    v_rcp_f32 v175, v175
    v_mul_f32 v206, v206, v174
    v_mul_f32 v207, v207, v175
    v_cvt_pk_bf16_f32 v168, v200, v201
    ds_read_b64_tr_b16 v[212:213], v230 offset:2048
    ds_read_b64_tr_b16 v[214:215], v230 offset:2560
    s_waitcnt lgkmcnt(8)
    v_mfma_f32_32x32x16_bf16 v[144:159], v[216:219], v[44:47], v[144:159]
    v_cvt_pk_bf16_f32 v169, v202, v203
    v_cvt_pk_bf16_f32 v170, v204, v205
    v_cvt_pk_bf16_f32 v171, v206, v207
    buffer_store_dwordx4 v[168:171], v238, s[48:51], s98 offen offset:1024 sc1
    ds_read_b64_tr_b16 v[216:217], v230 offset:4096
    ds_read_b64_tr_b16 v[218:219], v230 offset:4608
    s_waitcnt lgkmcnt(7)
    v_mfma_f32_16x16x32_bf16 v[224:227], v[220:223], v[244:247], v[224:227]
    v_mfma_f32_32x32x16_bf16 v[176:191], v[220:223], v[44:47], v[176:191]
    s_mov_b64 exec, s[72:73]
    ds_read_b128 v[244:247], v248 offset:6656
    s_mov_b64 exec, -1
    ds_read_b64_tr_b16 v[220:221], v230 offset:6144
    ds_read_b64_tr_b16 v[222:223], v230 offset:6656
    s_waitcnt lgkmcnt(8)
    v_mfma_f32_32x32x16_bf16 v[160:175], v[208:211], v[0:3], 0
    ds_read_b64_tr_b16 v[208:209], v230 offset:16384
    ds_read_b64_tr_b16 v[210:211], v230 offset:16896
    s_waitcnt lgkmcnt(7)
    v_mfma_f32_32x32x16_bf16 v[160:175], v[212:215], v[4:7], v[160:175]
    ds_read_b64_tr_b16 v[212:213], v230 offset:18432
    ds_read_b64_tr_b16 v[214:215], v230 offset:18944
    s_waitcnt lgkmcnt(7)
    v_mfma_f32_32x32x16_bf16 v[160:175], v[216:219], v[8:11], v[160:175]
    ds_read_b64_tr_b16 v[216:217], v230 offset:20480
    ds_read_b64_tr_b16 v[218:219], v230 offset:20992
    s_waitcnt lgkmcnt(6)
    v_mfma_f32_32x32x16_bf16 v[160:175], v[220:223], v[12:15], v[160:175]
    ds_read_b64_tr_b16 v[220:221], v230 offset:22528
    ds_read_b64_tr_b16 v[222:223], v230 offset:23040
    s_waitcnt lgkmcnt(6)
    v_mfma_f32_32x32x16_bf16 v[160:175], v[208:211], v[16:19], v[160:175]
    ds_read_b64_tr_b16 v[208:209], v230 offset:32768
    ds_read_b64_tr_b16 v[210:211], v230 offset:33280
    s_waitcnt lgkmcnt(6)
    v_mfma_f32_32x32x16_bf16 v[160:175], v[212:215], v[20:23], v[160:175]
    s_waitcnt vmcnt(10)
    s_barrier
    ds_read_b64_tr_b16 v[212:213], v230 offset:34816
    ds_read_b64_tr_b16 v[214:215], v230 offset:35328
    s_waitcnt lgkmcnt(6)
    v_mfma_f32_32x32x16_bf16 v[160:175], v[216:219], v[24:27], v[160:175]
    ds_read_b64_tr_b16 v[216:217], v230 offset:36864
    ds_read_b64_tr_b16 v[218:219], v230 offset:37376
    s_waitcnt lgkmcnt(6)
    v_mfma_f32_32x32x16_bf16 v[160:175], v[220:223], v[28:31], v[160:175]
    s_add_u32 s25, s66, 0x17a000
    s_add_u32 m0, s24, 65536
    s_mov_b64 exec, s[68:69]
    buffer_load_dwordx4 v233, s[40:43], s25 offen lds
    s_mov_b64 exec, -1
    ds_read_b64_tr_b16 v[220:221], v230 offset:38912
    ds_read_b64_tr_b16 v[222:223], v230 offset:39424
    s_waitcnt lgkmcnt(6)
    v_mfma_f32_32x32x16_bf16 v[160:175], v[208:211], v[32:35], v[160:175]
    v_xor_b32 v228, 0x10000, v228
    v_xor_b32 v229, 0x10000, v229
    v_xor_b32 v230, 0x10000, v230
    v_xor_b32 v231, 0x10000, v231
    v_xor_b32 v249, 0x10000, v249
    ds_read_b64_tr_b16 v[208:209], v249 offset:8192
    ds_read_b64_tr_b16 v[210:211], v249 offset:8704
    s_waitcnt lgkmcnt(6)
    v_mfma_f32_32x32x16_bf16 v[160:175], v[212:215], v[36:39], v[160:175]
    ds_read_b64_tr_b16 v[212:213], v230 offset:0
    ds_read_b64_tr_b16 v[214:215], v230 offset:512
    s_waitcnt lgkmcnt(6)
    v_mfma_f32_32x32x16_bf16 v[160:175], v[216:219], v[40:43], v[160:175]
    ds_read_b64_tr_b16 v[216:217], v231 offset:0
    ds_read_b64_tr_b16 v[218:219], v231 offset:512
    s_waitcnt lgkmcnt(6)
    v_mfma_f32_32x32x16_bf16 v[160:175], v[220:223], v[44:47], v[160:175]
    ds_read_b64_tr_b16 v[220:221], v249 offset:10240
    ds_read_b64_tr_b16 v[222:223], v249 offset:10752
    s_waitcnt lgkmcnt(6)
    v_mfma_f32_32x32x16_bf16 v[144:159], v[208:211], v[48:51], v[144:159]
    s_add_u32 m0, s24, 73728
    s_mov_b64 exec, s[30:31]
    global_load_lds_dwordx4 v[234:235], off
    s_mov_b64 exec, -1
    v_add_co_u32 v234, s[70:71], v234, v236
    s_nop 1
    v_addc_co_u32 v235, s[70:71], 0, v235, s[70:71]
    ds_read_b64_tr_b16 v[208:209], v230 offset:2048
    ds_read_b64_tr_b16 v[210:211], v230 offset:2560
    s_waitcnt lgkmcnt(6)
    v_mfma_f32_32x32x16_bf16 v[160:175], v[212:215], v[48:51], v[160:175]
    ds_read_b64_tr_b16 v[212:213], v231 offset:2048
    ds_read_b64_tr_b16 v[214:215], v231 offset:2560
    s_waitcnt lgkmcnt(6)
    v_mfma_f32_16x16x32_bf16 v[224:227], v[216:219], v[240:243], v[224:227]
    v_mfma_f32_32x32x16_bf16 v[176:191], v[216:219], v[48:51], v[176:191]
    s_mov_b64 exec, s[72:73]
    ds_read_b128 v[240:243], v248 offset:7168
    s_mov_b64 exec, -1
    ds_read_b64_tr_b16 v[216:217], v249 offset:12288
    ds_read_b64_tr_b16 v[218:219], v249 offset:12800
    s_waitcnt lgkmcnt(7)
    v_mfma_f32_32x32x16_bf16 v[144:159], v[220:223], v[52:55], v[144:159]
    ds_read_b64_tr_b16 v[220:221], v230 offset:4096
    ds_read_b64_tr_b16 v[222:223], v230 offset:4608
    s_waitcnt lgkmcnt(7)
    v_mfma_f32_32x32x16_bf16 v[160:175], v[208:211], v[52:55], v[160:175]
    ds_read_b64_tr_b16 v[208:209], v231 offset:4096
    ds_read_b64_tr_b16 v[210:211], v231 offset:4608
    s_waitcnt lgkmcnt(7)
    v_mfma_f32_16x16x32_bf16 v[224:227], v[212:215], v[244:247], v[224:227]
    v_mfma_f32_32x32x16_bf16 v[176:191], v[212:215], v[52:55], v[176:191]
    s_mov_b64 exec, s[72:73]
    ds_read_b128 v[244:247], v248 offset:7680
    s_mov_b64 exec, -1
    s_waitcnt vmcnt(9)
    s_waitcnt vmcnt(2)
    s_barrier
    s_waitcnt lgkmcnt(0)
    s_cmp_eq_u32 s3, 0
    s_cbranch_scc0 SIG2_3281
    s_memrealtime s[90:91]
    v_mov_b32 v252, 0
    s_lshl_b32 s25, s2, 3
    s_waitcnt lgkmcnt(0)
    v_mov_b32 v250, s90
    v_xor_b32 v251, 0x5bd1e995, v250
    s_mov_b64 exec, 1
    buffer_store_dwordx2 v[250:251], v252, s[52:55], s25 offen offset:2048 sc1
    s_mov_b64 exec, -1
SIG2_3281:
    ds_read_b64_tr_b16 v[212:213], v249 offset:14336
    ds_read_b64_tr_b16 v[214:215], v249 offset:14848
    v_mfma_f32_32x32x16_bf16 v[144:159], v[216:219], v[56:59], v[144:159]
    ds_read_b64_tr_b16 v[216:217], v230 offset:6144
    ds_read_b64_tr_b16 v[218:219], v230 offset:6656
    v_mfma_f32_32x32x16_bf16 v[160:175], v[220:223], v[56:59], v[160:175]
    s_add_u32 s25, s66, 0x1b0000
    s_add_u32 m0, s24, 81920
    s_mov_b64 exec, s[68:69]
    buffer_load_dwordx4 v233, s[40:43], s25 offen lds
    s_mov_b64 exec, -1
    ds_read_b64_tr_b16 v[220:221], v231 offset:6144
    ds_read_b64_tr_b16 v[222:223], v231 offset:6656
    v_mfma_f32_16x16x32_bf16 v[224:227], v[208:211], v[240:243], v[224:227]
    v_mfma_f32_32x32x16_bf16 v[176:191], v[208:211], v[56:59], v[176:191]
    s_mov_b64 exec, s[72:73]
    ds_read_b128 v[240:243], v248 offset:8192
    s_mov_b64 exec, -1
    ds_read_b64_tr_b16 v[208:209], v249 offset:24576
    ds_read_b64_tr_b16 v[210:211], v249 offset:25088
    s_waitcnt lgkmcnt(7)
    v_mfma_f32_32x32x16_bf16 v[144:159], v[212:215], v[60:63], v[144:159]
    ds_read_b64_tr_b16 v[212:213], v230 offset:16384
    ds_read_b64_tr_b16 v[214:215], v230 offset:16896
    s_waitcnt lgkmcnt(7)
    v_mfma_f32_32x32x16_bf16 v[160:175], v[216:219], v[60:63], v[160:175]
    ds_read_b64_tr_b16 v[216:217], v231 offset:16384
    ds_read_b64_tr_b16 v[218:219], v231 offset:16896
    s_waitcnt lgkmcnt(7)
    v_mfma_f32_16x16x32_bf16 v[224:227], v[220:223], v[244:247], v[224:227]
    v_mfma_f32_32x32x16_bf16 v[176:191], v[220:223], v[60:63], v[176:191]
    s_mov_b64 exec, s[72:73]
    ds_read_b128 v[244:247], v248 offset:8704
    s_mov_b64 exec, -1
    ds_read_b64_tr_b16 v[220:221], v249 offset:26624
    ds_read_b64_tr_b16 v[222:223], v249 offset:27136
    s_waitcnt lgkmcnt(7)
    v_mfma_f32_32x32x16_bf16 v[144:159], v[208:211], v[64:67], v[144:159]
    s_add_u32 m0, s24, 90112
    s_mov_b64 exec, s[30:31]
    global_load_lds_dwordx4 v[234:235], off
    s_mov_b64 exec, -1
    ds_read_b64_tr_b16 v[208:209], v230 offset:18432
    ds_read_b64_tr_b16 v[210:211], v230 offset:18944
    s_waitcnt lgkmcnt(7)
    v_mfma_f32_32x32x16_bf16 v[160:175], v[212:215], v[64:67], v[160:175]
    ds_read_b64_tr_b16 v[212:213], v231 offset:18432
    ds_read_b64_tr_b16 v[214:215], v231 offset:18944
    s_waitcnt lgkmcnt(7)
    v_mfma_f32_16x16x32_bf16 v[224:227], v[216:219], v[240:243], v[224:227]
    v_mfma_f32_32x32x16_bf16 v[176:191], v[216:219], v[64:67], v[176:191]
    s_mov_b64 exec, s[72:73]
    ds_read_b128 v[240:243], v248 offset:9216
    s_mov_b64 exec, -1
    ds_read_b64_tr_b16 v[216:217], v249 offset:28672
    ds_read_b64_tr_b16 v[218:219], v249 offset:29184
    s_waitcnt lgkmcnt(7)
    v_mfma_f32_32x32x16_bf16 v[144:159], v[220:223], v[68:71], v[144:159]
    ds_read_b64_tr_b16 v[220:221], v230 offset:20480
    ds_read_b64_tr_b16 v[222:223], v230 offset:20992
    s_waitcnt lgkmcnt(7)
    v_mfma_f32_32x32x16_bf16 v[160:175], v[208:211], v[68:71], v[160:175]
    ds_read_b64_tr_b16 v[208:209], v231 offset:20480
    ds_read_b64_tr_b16 v[210:211], v231 offset:20992
    s_waitcnt lgkmcnt(7)
    v_mfma_f32_16x16x32_bf16 v[224:227], v[212:215], v[244:247], v[224:227]
    v_mfma_f32_32x32x16_bf16 v[176:191], v[212:215], v[68:71], v[176:191]
    s_mov_b64 exec, s[72:73]
    ds_read_b128 v[244:247], v248 offset:9728
    s_mov_b64 exec, -1
    s_barrier
    ds_read_b64_tr_b16 v[212:213], v249 offset:30720
    ds_read_b64_tr_b16 v[214:215], v249 offset:31232
    s_waitcnt lgkmcnt(7)
    v_mfma_f32_32x32x16_bf16 v[144:159], v[216:219], v[72:75], v[144:159]
    ds_read_b64_tr_b16 v[216:217], v230 offset:22528
    ds_read_b64_tr_b16 v[218:219], v230 offset:23040
    s_waitcnt lgkmcnt(7)
    v_mfma_f32_32x32x16_bf16 v[160:175], v[220:223], v[72:75], v[160:175]
    ds_read_b64_tr_b16 v[220:221], v231 offset:22528
    ds_read_b64_tr_b16 v[222:223], v231 offset:23040
    s_waitcnt lgkmcnt(7)
    v_mfma_f32_16x16x32_bf16 v[224:227], v[208:211], v[240:243], v[224:227]
    v_mfma_f32_32x32x16_bf16 v[176:191], v[208:211], v[72:75], v[176:191]
    s_mov_b64 exec, s[72:73]
    ds_read_b128 v[240:243], v248 offset:10240
    s_mov_b64 exec, -1
    ds_read_b64_tr_b16 v[208:209], v249 offset:40960
    ds_read_b64_tr_b16 v[210:211], v249 offset:41472
    s_waitcnt lgkmcnt(7)
    v_mfma_f32_32x32x16_bf16 v[144:159], v[212:215], v[76:79], v[144:159]
    ds_read_b64_tr_b16 v[212:213], v230 offset:32768
    ds_read_b64_tr_b16 v[214:215], v230 offset:33280
    s_waitcnt lgkmcnt(7)
    v_mfma_f32_32x32x16_bf16 v[160:175], v[216:219], v[76:79], v[160:175]
    ds_read_b64_tr_b16 v[216:217], v231 offset:32768
    ds_read_b64_tr_b16 v[218:219], v231 offset:33280
    s_waitcnt lgkmcnt(7)
    v_mfma_f32_16x16x32_bf16 v[224:227], v[220:223], v[244:247], v[224:227]
    v_mfma_f32_32x32x16_bf16 v[176:191], v[220:223], v[76:79], v[176:191]
    s_mov_b64 exec, s[72:73]
    ds_read_b128 v[244:247], v248 offset:10752
    s_mov_b64 exec, -1
    ds_read_b64_tr_b16 v[220:221], v249 offset:43008
    ds_read_b64_tr_b16 v[222:223], v249 offset:43520
    s_waitcnt lgkmcnt(7)
    v_mfma_f32_32x32x16_bf16 v[144:159], v[208:211], v[80:83], v[144:159]
    ds_read_b64_tr_b16 v[208:209], v230 offset:34816
    ds_read_b64_tr_b16 v[210:211], v230 offset:35328
    s_waitcnt lgkmcnt(7)
    v_mfma_f32_32x32x16_bf16 v[160:175], v[212:215], v[80:83], v[160:175]
    ds_read_b64_tr_b16 v[212:213], v231 offset:34816
    ds_read_b64_tr_b16 v[214:215], v231 offset:35328
    s_waitcnt lgkmcnt(7)
    v_mfma_f32_16x16x32_bf16 v[224:227], v[216:219], v[240:243], v[224:227]
    v_mfma_f32_32x32x16_bf16 v[176:191], v[216:219], v[80:83], v[176:191]
    s_mov_b64 exec, s[72:73]
    ds_read_b128 v[240:243], v248 offset:11264
    s_mov_b64 exec, -1
    ds_read_b64_tr_b16 v[216:217], v249 offset:45056
    ds_read_b64_tr_b16 v[218:219], v249 offset:45568
    s_waitcnt lgkmcnt(7)
    v_mfma_f32_32x32x16_bf16 v[144:159], v[220:223], v[84:87], v[144:159]
    ds_read_b64_tr_b16 v[220:221], v230 offset:36864
    ds_read_b64_tr_b16 v[222:223], v230 offset:37376
    s_waitcnt lgkmcnt(7)
    v_mfma_f32_32x32x16_bf16 v[160:175], v[208:211], v[84:87], v[160:175]
    ds_read_b64_tr_b16 v[208:209], v231 offset:36864
    ds_read_b64_tr_b16 v[210:211], v231 offset:37376
    s_waitcnt lgkmcnt(7)
    v_mfma_f32_16x16x32_bf16 v[224:227], v[212:215], v[244:247], v[224:227]
    v_mfma_f32_32x32x16_bf16 v[176:191], v[212:215], v[84:87], v[176:191]
    s_mov_b64 exec, s[72:73]
    ds_read_b128 v[244:247], v248 offset:11776
    s_mov_b64 exec, -1
    s_barrier
    ds_read_b64_tr_b16 v[212:213], v249 offset:47104
    ds_read_b64_tr_b16 v[214:215], v249 offset:47616
    s_waitcnt lgkmcnt(7)
    v_mfma_f32_32x32x16_bf16 v[144:159], v[216:219], v[88:91], v[144:159]
    ds_read_b64_tr_b16 v[216:217], v230 offset:38912
    ds_read_b64_tr_b16 v[218:219], v230 offset:39424
    s_waitcnt lgkmcnt(7)
    v_mfma_f32_32x32x16_bf16 v[160:175], v[220:223], v[88:91], v[160:175]
    ds_read_b64_tr_b16 v[220:221], v231 offset:38912
    ds_read_b64_tr_b16 v[222:223], v231 offset:39424
    s_waitcnt lgkmcnt(7)
    v_mfma_f32_16x16x32_bf16 v[224:227], v[208:211], v[240:243], v[224:227]
    v_mfma_f32_32x32x16_bf16 v[176:191], v[208:211], v[88:91], v[176:191]
    s_mov_b64 exec, s[72:73]
    ds_read_b128 v[240:243], v248 offset:12288
    s_mov_b64 exec, -1
    ds_read_b64_tr_b16 v[208:209], v249 offset:57344
    ds_read_b64_tr_b16 v[210:211], v249 offset:57856
    s_waitcnt lgkmcnt(7)
    v_mfma_f32_32x32x16_bf16 v[144:159], v[212:215], v[92:95], v[144:159]
    ds_read_b64_tr_b16 v[212:213], v230 offset:49152
    ds_read_b64_tr_b16 v[214:215], v230 offset:49664
    s_waitcnt lgkmcnt(7)
    v_mfma_f32_32x32x16_bf16 v[160:175], v[216:219], v[92:95], v[160:175]
    ds_read_b64_tr_b16 v[216:217], v231 offset:49152
    ds_read_b64_tr_b16 v[218:219], v231 offset:49664
    s_waitcnt lgkmcnt(7)
    v_mfma_f32_16x16x32_bf16 v[224:227], v[220:223], v[244:247], v[224:227]
    v_mfma_f32_32x32x16_bf16 v[176:191], v[220:223], v[92:95], v[176:191]
    s_mov_b64 exec, s[72:73]
    ds_read_b128 v[244:247], v248 offset:12800
    s_mov_b64 exec, -1
    ds_read_b64_tr_b16 v[220:221], v249 offset:59392
    ds_read_b64_tr_b16 v[222:223], v249 offset:59904
    s_waitcnt lgkmcnt(7)
    v_mfma_f32_32x32x16_bf16 v[144:159], v[208:211], v[96:99], v[144:159]
    ds_read_b64_tr_b16 v[208:209], v230 offset:51200
    ds_read_b64_tr_b16 v[210:211], v230 offset:51712
    s_waitcnt lgkmcnt(7)
    v_mfma_f32_32x32x16_bf16 v[160:175], v[212:215], v[96:99], v[160:175]
    ds_read_b64_tr_b16 v[212:213], v231 offset:51200
    ds_read_b64_tr_b16 v[214:215], v231 offset:51712
    s_waitcnt lgkmcnt(7)
    v_mfma_f32_16x16x32_bf16 v[224:227], v[216:219], v[240:243], v[224:227]
    v_mfma_f32_32x32x16_bf16 v[176:191], v[216:219], v[96:99], v[176:191]
    s_mov_b64 exec, s[72:73]
    ds_read_b128 v[240:243], v248 offset:13312
    s_mov_b64 exec, -1
    ds_read_b64_tr_b16 v[216:217], v249 offset:61440
    ds_read_b64_tr_b16 v[218:219], v249 offset:61952
    s_waitcnt lgkmcnt(7)
    v_mfma_f32_32x32x16_bf16 v[144:159], v[220:223], v[100:103], v[144:159]
    ds_read_b64_tr_b16 v[220:221], v230 offset:53248
    ds_read_b64_tr_b16 v[222:223], v230 offset:53760
    s_waitcnt lgkmcnt(7)
    v_mfma_f32_32x32x16_bf16 v[160:175], v[208:211], v[100:103], v[160:175]
    ds_read_b64_tr_b16 v[208:209], v231 offset:53248
    ds_read_b64_tr_b16 v[210:211], v231 offset:53760
    s_waitcnt lgkmcnt(7)
    v_mfma_f32_16x16x32_bf16 v[224:227], v[212:215], v[244:247], v[224:227]
    v_mfma_f32_32x32x16_bf16 v[176:191], v[212:215], v[100:103], v[176:191]
    s_mov_b64 exec, s[72:73]
    ds_read_b128 v[244:247], v248 offset:13824
    s_mov_b64 exec, -1
    s_waitcnt vmcnt(2)
    s_barrier
    ds_read_b64_tr_b16 v[212:213], v249 offset:63488
    ds_read_b64_tr_b16 v[214:215], v249 offset:64000
    s_waitcnt lgkmcnt(7)
    v_mfma_f32_32x32x16_bf16 v[144:159], v[216:219], v[104:107], v[144:159]
    ds_read_b64_tr_b16 v[216:217], v230 offset:55296
    ds_read_b64_tr_b16 v[218:219], v230 offset:55808
    s_waitcnt lgkmcnt(7)
    v_mfma_f32_32x32x16_bf16 v[160:175], v[220:223], v[104:107], v[160:175]
    ds_read_b64_tr_b16 v[220:221], v231 offset:55296
    ds_read_b64_tr_b16 v[222:223], v231 offset:55808
    s_waitcnt lgkmcnt(7)
    v_mfma_f32_16x16x32_bf16 v[224:227], v[208:211], v[240:243], v[224:227]
    v_mfma_f32_32x32x16_bf16 v[176:191], v[208:211], v[104:107], v[176:191]
    s_mov_b64 exec, s[72:73]
    ds_read_b128 v[240:243], v248 offset:14336
    s_mov_b64 exec, -1
    v_xor_b32 v228, 0x10000, v228
    v_xor_b32 v229, 0x10000, v229
    v_xor_b32 v230, 0x10000, v230
    v_xor_b32 v231, 0x10000, v231
    v_xor_b32 v249, 0x10000, v249
    ds_read_b64_tr_b16 v[208:209], v249 offset:8192
    ds_read_b64_tr_b16 v[210:211], v249 offset:8704
    s_waitcnt lgkmcnt(7)
    v_mfma_f32_32x32x16_bf16 v[144:159], v[212:215], v[108:111], v[144:159]
    ds_read_b64_tr_b16 v[212:213], v230 offset:0
    ds_read_b64_tr_b16 v[214:215], v230 offset:512
    s_waitcnt lgkmcnt(7)
    v_mfma_f32_32x32x16_bf16 v[160:175], v[216:219], v[108:111], v[160:175]
    ds_read_b64_tr_b16 v[216:217], v231 offset:0
    ds_read_b64_tr_b16 v[218:219], v231 offset:512
    s_waitcnt lgkmcnt(7)
    v_mfma_f32_16x16x32_bf16 v[224:227], v[220:223], v[244:247], v[224:227]
    v_mfma_f32_32x32x16_bf16 v[176:191], v[220:223], v[108:111], v[176:191]
    s_mov_b64 exec, s[72:73]
    ds_read_b128 v[244:247], v248 offset:14848
    s_mov_b64 exec, -1
    ds_read_b64_tr_b16 v[220:221], v249 offset:10240
    ds_read_b64_tr_b16 v[222:223], v249 offset:10752
    s_waitcnt lgkmcnt(7)
    v_mfma_f32_32x32x16_bf16 v[144:159], v[208:211], v[112:115], v[144:159]
    ds_read_b64_tr_b16 v[208:209], v230 offset:2048
    ds_read_b64_tr_b16 v[210:211], v230 offset:2560
    s_waitcnt lgkmcnt(7)
    v_mfma_f32_32x32x16_bf16 v[160:175], v[212:215], v[112:115], v[160:175]
    ds_read_b64_tr_b16 v[212:213], v231 offset:2048
    ds_read_b64_tr_b16 v[214:215], v231 offset:2560
    s_waitcnt lgkmcnt(7)
    v_mfma_f32_16x16x32_bf16 v[224:227], v[216:219], v[240:243], v[224:227]
    v_mfma_f32_32x32x16_bf16 v[176:191], v[216:219], v[112:115], v[176:191]
    s_mov_b64 exec, s[72:73]
    ds_read_b128 v[240:243], v248 offset:15360
    s_mov_b64 exec, -1
    ds_read_b64_tr_b16 v[216:217], v249 offset:12288
    ds_read_b64_tr_b16 v[218:219], v249 offset:12800
    s_waitcnt lgkmcnt(7)
    v_mfma_f32_32x32x16_bf16 v[144:159], v[220:223], v[116:119], v[144:159]
    ds_read_b64_tr_b16 v[220:221], v230 offset:4096
    ds_read_b64_tr_b16 v[222:223], v230 offset:4608
    s_waitcnt lgkmcnt(7)
    v_mfma_f32_32x32x16_bf16 v[160:175], v[208:211], v[116:119], v[160:175]
    ds_read_b64_tr_b16 v[208:209], v231 offset:4096
    ds_read_b64_tr_b16 v[210:211], v231 offset:4608
    s_waitcnt lgkmcnt(7)
    v_mfma_f32_16x16x32_bf16 v[224:227], v[212:215], v[244:247], v[224:227]
    v_mfma_f32_32x32x16_bf16 v[176:191], v[212:215], v[116:119], v[176:191]
    s_mov_b64 exec, s[72:73]
    ds_read_b128 v[244:247], v248 offset:15872
    s_mov_b64 exec, -1
    s_waitcnt vmcnt(0)
    s_barrier
    ds_read_b64_tr_b16 v[212:213], v249 offset:14336
    ds_read_b64_tr_b16 v[214:215], v249 offset:14848
    s_waitcnt lgkmcnt(7)
    v_mfma_f32_32x32x16_bf16 v[144:159], v[216:219], v[120:123], v[144:159]
    ds_read_b64_tr_b16 v[216:217], v230 offset:6144
    ds_read_b64_tr_b16 v[218:219], v230 offset:6656
    s_waitcnt lgkmcnt(7)
    v_mfma_f32_32x32x16_bf16 v[160:175], v[220:223], v[120:123], v[160:175]
    ds_read_b64_tr_b16 v[220:221], v231 offset:6144
    ds_read_b64_tr_b16 v[222:223], v231 offset:6656
    s_waitcnt lgkmcnt(7)
    v_mfma_f32_16x16x32_bf16 v[224:227], v[208:211], v[240:243], v[224:227]
    v_mfma_f32_32x32x16_bf16 v[176:191], v[208:211], v[120:123], v[176:191]
    s_mov_b64 exec, s[72:73]
    ds_read_b128 v[240:243], v248 offset:16384
    s_mov_b64 exec, -1
    ds_read_b64_tr_b16 v[208:209], v249 offset:24576
    ds_read_b64_tr_b16 v[210:211], v249 offset:25088
    s_waitcnt lgkmcnt(7)
    v_mfma_f32_32x32x16_bf16 v[144:159], v[212:215], v[124:127], v[144:159]
    ds_read_b64_tr_b16 v[212:213], v230 offset:16384
    ds_read_b64_tr_b16 v[214:215], v230 offset:16896
    s_waitcnt lgkmcnt(7)
    v_mfma_f32_32x32x16_bf16 v[160:175], v[216:219], v[124:127], v[160:175]
    ds_read_b64_tr_b16 v[216:217], v231 offset:16384
    ds_read_b64_tr_b16 v[218:219], v231 offset:16896
    s_waitcnt lgkmcnt(7)
    v_mfma_f32_16x16x32_bf16 v[224:227], v[220:223], v[244:247], v[224:227]
    v_mfma_f32_32x32x16_bf16 v[176:191], v[220:223], v[124:127], v[176:191]
    s_mov_b64 exec, s[72:73]
    ds_read_b128 v[244:247], v248 offset:16896
    s_mov_b64 exec, -1
    ds_read_b64_tr_b16 v[220:221], v249 offset:26624
    ds_read_b64_tr_b16 v[222:223], v249 offset:27136
    s_waitcnt lgkmcnt(7)
    v_mfma_f32_32x32x16_bf16 v[144:159], v[208:211], v[128:131], v[144:159]
    ds_read_b64_tr_b16 v[208:209], v230 offset:18432
    ds_read_b64_tr_b16 v[210:211], v230 offset:18944
    s_waitcnt lgkmcnt(7)
    v_mfma_f32_32x32x16_bf16 v[160:175], v[212:215], v[128:131], v[160:175]
    ds_read_b64_tr_b16 v[212:213], v231 offset:18432
    ds_read_b64_tr_b16 v[214:215], v231 offset:18944
    s_waitcnt lgkmcnt(7)
    v_mfma_f32_16x16x32_bf16 v[224:227], v[216:219], v[240:243], v[224:227]
    v_mfma_f32_32x32x16_bf16 v[176:191], v[216:219], v[128:131], v[176:191]
    s_mov_b64 exec, s[72:73]
    ds_read_b128 v[240:243], v248 offset:17408
    s_mov_b64 exec, -1
    ds_read_b64_tr_b16 v[216:217], v249 offset:28672
    ds_read_b64_tr_b16 v[218:219], v249 offset:29184
    s_waitcnt lgkmcnt(7)
    v_mfma_f32_32x32x16_bf16 v[144:159], v[220:223], v[132:135], v[144:159]
    ds_read_b64_tr_b16 v[220:221], v230 offset:20480
    ds_read_b64_tr_b16 v[222:223], v230 offset:20992
    s_waitcnt lgkmcnt(7)
    v_mfma_f32_32x32x16_bf16 v[160:175], v[208:211], v[132:135], v[160:175]
    ds_read_b64_tr_b16 v[208:209], v231 offset:20480
    ds_read_b64_tr_b16 v[210:211], v231 offset:20992
    s_waitcnt lgkmcnt(7)
    v_mfma_f32_16x16x32_bf16 v[224:227], v[212:215], v[244:247], v[224:227]
    v_mfma_f32_32x32x16_bf16 v[176:191], v[212:215], v[132:135], v[176:191]
    s_mov_b64 exec, s[72:73]
    ds_read_b128 v[244:247], v248 offset:17920
    s_mov_b64 exec, -1
    s_waitcnt lgkmcnt(0)
    s_barrier
    ds_read_b64_tr_b16 v[212:213], v249 offset:30720
    ds_read_b64_tr_b16 v[214:215], v249 offset:31232
    v_mfma_f32_32x32x16_bf16 v[144:159], v[216:219], v[136:139], v[144:159]
    ds_read_b64_tr_b16 v[216:217], v230 offset:22528
    ds_read_b64_tr_b16 v[218:219], v230 offset:23040
    v_mfma_f32_32x32x16_bf16 v[160:175], v[220:223], v[136:139], v[160:175]
    ds_read_b64_tr_b16 v[220:221], v231 offset:22528
    ds_read_b64_tr_b16 v[222:223], v231 offset:23040
    v_mfma_f32_16x16x32_bf16 v[224:227], v[208:211], v[240:243], v[224:227]
    v_mfma_f32_32x32x16_bf16 v[176:191], v[208:211], v[136:139], v[176:191]
    s_waitcnt lgkmcnt(4)
    v_mfma_f32_32x32x16_bf16 v[144:159], v[212:215], v[140:143], v[144:159]
    s_waitcnt lgkmcnt(2)
    v_mfma_f32_32x32x16_bf16 v[160:175], v[216:219], v[140:143], v[160:175]
    s_waitcnt lgkmcnt(0)
    v_mfma_f32_16x16x32_bf16 v[224:227], v[220:223], v[244:247], v[224:227]
    v_mfma_f32_32x32x16_bf16 v[176:191], v[220:223], v[140:143], v[176:191]
    v_bfe_u32 v196, v238, 4, 5
    v_lshrrev_b32 v197, 9, v238
    v_cmp_eq_u32 s[74:75], 1, v197
    s_lshl_b32 s26, s3, 5
    s_add_u32 s26, s26, 16
    v_add_u32 v198, s26, v196
    v_mul_u32_u24 v199, 21760, v197
    v_add_u32 v199, 114688, v199
    v_mad_u32_u24 v200, v198, 5, 0
    v_lshl_add_u32 v200, v200, 4, v199
    s_nop 1
    v_cndmask_b32 v202, v184, v170, s[74:75]
    v_cndmask_b32 v203, v185, v171, s[74:75]
    ds_write_b128 v200, v[176:179]
    ds_write_b128 v200, v[180:183] offset:16
    ds_write_b128 v200, v[172:175] offset:32
    ds_write_b128 v200, v[188:191] offset:48
    ds_write_b64 v200, v[202:203] offset:64
    v_bfe_u32 v204, v238, 4, 4
    v_mul_u32_u24 v204, 80, v204
    v_bfe_u32 v205, v238, 8, 1
    s_mov_b32 s26, 21760
    v_mad_u32_u24 v204, v205, s26, v204
    v_add_u32 v204, 114688, v204
    s_cmp_eq_u32 s3, 0
    s_cbranch_scc0 K1_HW1
    v_lshl_add_u32 v204, v197, 4, v204
    ds_write_b128 v204, v[224:227]
K1_HW1:
    s_cmp_eq_u32 s3, 1
    s_cbranch_scc0 K1_HW2
    s_mov_b64 exec, s[74:75]
    ds_write_b128 v204, v[224:227] offset:48
    s_mov_b64 exec, 0xffff
    ds_write_b64 v204, v[224:225] offset:64
    s_mov_b64 exec, -1
K1_HW2:
    s_and_b32 s67, s23, 7
    s_lshl_b32 s67, s67, 9
    s_lshr_b32 s26, s23, 3
    s_mul_i32 s26, s26, 36864
    s_add_u32 s67, s67, s26
    s_add_u32 s67, s67, 32768
    v_mul_f32 v208, s64, v144
    v_mul_f32 v209, s64, v145
    v_mul_f32 v210, s64, v146
    v_mul_f32 v211, s64, v147
    v_mul_f32 v212, s64, v148
    v_mul_f32 v213, s64, v149
    v_mul_f32 v214, s64, v150
    v_mul_f32 v215, s64, v151
    v_exp_f32 v208, v208
    v_exp_f32 v209, v209
    v_exp_f32 v210, v210
    v_exp_f32 v211, v211
    v_exp_f32 v212, v212
    v_exp_f32 v213, v213
    v_exp_f32 v214, v214
    v_exp_f32 v215, v215
    v_mul_f32 v144, v144, v152
    v_mul_f32 v145, v145, v153
    v_mul_f32 v146, v146, v154
    v_mul_f32 v147, v147, v155
    v_mul_f32 v148, v148, v156
    v_mul_f32 v149, v149, v157
    v_mul_f32 v150, v150, v158
    v_mul_f32 v151, v151, v159
    v_add_f32 v208, 1.0, v208
    v_add_f32 v209, 1.0, v209
    v_add_f32 v210, 1.0, v210
    v_add_f32 v211, 1.0, v211
    v_add_f32 v212, 1.0, v212
    v_add_f32 v213, 1.0, v213
    v_add_f32 v214, 1.0, v214
    v_add_f32 v215, 1.0, v215
    v_rcp_f32 v208, v208
    v_rcp_f32 v209, v209
    v_rcp_f32 v210, v210
    v_rcp_f32 v211, v211
    v_rcp_f32 v212, v212
    v_rcp_f32 v213, v213
    v_rcp_f32 v214, v214
    v_rcp_f32 v215, v215
    v_mul_f32 v144, v144, v208
    v_mul_f32 v145, v145, v209
    v_mul_f32 v146, v146, v210
    v_mul_f32 v147, v147, v211
    v_mul_f32 v148, v148, v212
    v_mul_f32 v149, v149, v213
    v_mul_f32 v150, v150, v214
    v_mul_f32 v151, v151, v215
    v_cvt_pk_bf16_f32 v216, v144, v145
    v_cvt_pk_bf16_f32 v217, v146, v147
    v_cvt_pk_bf16_f32 v218, v148, v149
    v_cvt_pk_bf16_f32 v219, v150, v151
    buffer_store_dwordx4 v[216:219], v239, s[48:51], s67 offen offset:0 sc1
    v_cndmask_b32 v168, v168, 0, s[74:75]
    v_cndmask_b32 v169, v169, 0, s[74:75]
    s_cmp_eq_u32 s22, 0
    s_cselect_b32 s27, 16, 0
    s_waitcnt lgkmcnt(0)
    v_subrev_u32 v200, 0, v198
    v_max_u32 v144, s27, v200
    v_mad_u32_u24 v144, v144, 5, 0
    v_lshl_add_u32 v144, v144, 4, v199
    v_subrev_u32 v201, 2, v198
    v_max_u32 v145, s27, v201
    v_mad_u32_u24 v145, v145, 5, 0
    v_lshl_add_u32 v145, v145, 4, v199
    v_subrev_u32 v202, 4, v198
    v_max_u32 v146, s27, v202
    v_mad_u32_u24 v146, v146, 5, 0
    v_lshl_add_u32 v146, v146, 4, v199
    v_subrev_u32 v203, 6, v198
    v_max_u32 v147, s27, v203
    v_mad_u32_u24 v147, v147, 5, 0
    v_lshl_add_u32 v147, v147, 4, v199
    v_subrev_u32 v204, 8, v198
    v_max_u32 v148, s27, v204
    v_mad_u32_u24 v148, v148, 5, 0
    v_lshl_add_u32 v148, v148, 4, v199
    v_subrev_u32 v205, 10, v198
    v_max_u32 v149, s27, v205
    v_mad_u32_u24 v149, v149, 5, 0
    v_lshl_add_u32 v149, v149, 4, v199
    v_subrev_u32 v206, 12, v198
    v_max_u32 v150, s27, v206
    v_mad_u32_u24 v150, v150, 5, 0
    v_lshl_add_u32 v150, v150, 4, v199
    v_subrev_u32 v207, 14, v198
    v_max_u32 v151, s27, v207
    v_mad_u32_u24 v151, v151, 5, 0
    v_lshl_add_u32 v151, v151, 4, v199
    s_barrier
    s_cmp_eq_u32 s22, 0
    s_cselect_b32 s27, 16, 0
    s_and_b32 s30, s2, 3
    s_lshr_b32 s20, s2, 6
    s_lshl_b32 s20, s20, 1
    s_and_b32 s26, s2, 1
    s_add_u32 s20, s20, s26
    s_bfe_u32 s21, s2, 0x40002
    s_lshl_b32 s21, s21, 3
    s_bfe_u32 s26, s2, 0x10001
    s_lshl_b32 s26, s26, 2
    s_add_u32 s21, s21, s26
    s_and_b32 s26, s3, 3
    s_add_u32 s21, s21, s26
    s_mul_i32 s26, s30, 36864
    s_mul_i32 s28, s21, 165888
    s_add_u32 s28, s28, s26
    s_xor_b32 s65, s21, 4
    s_mul_i32 s65, s65, 165888
    s_add_u32 s65, s65, s26
    s_add_u32 s29, s28, 0
    buffer_load_dwordx4 v[0:3], v238, s[48:51], s29 offen offset:0
    s_add_u32 s66, s65, 0
    buffer_load_dwordx4 v[4:7], v238, s[48:51], s66 offen offset:0
    buffer_load_dwordx4 v[8:11], v238, s[48:51], s29 offen offset:1024
    buffer_load_dwordx4 v[12:15], v238, s[48:51], s66 offen offset:1024
    buffer_load_dwordx4 v[16:19], v238, s[48:51], s29 offen offset:2048
    buffer_load_dwordx4 v[20:23], v238, s[48:51], s66 offen offset:2048
    ds_read_b128 v[176:179], v144 offset:0
    ds_read_b128 v[180:183], v144 offset:16
    ds_read_b64 v[184:185], v144 offset:64
    ds_read_b128 v[208:211], v145 offset:0
    ds_read_b128 v[212:215], v145 offset:16
    ds_read_b64 v[216:217], v145 offset:64
    ds_read_b128 v[218:221], v146 offset:0
    ds_read_b128 v[222:225], v146 offset:16
    ds_read_b64 v[226:227], v146 offset:64
    s_waitcnt lgkmcnt(6)
    v_mul_f32 v152, v160, v176
    v_fmac_f32 v152, v161, v177
    v_fmac_f32 v152, v162, v178
    v_fmac_f32 v152, v163, v179
    v_fmac_f32 v152, v164, v180
    v_fmac_f32 v152, v165, v181
    v_fmac_f32 v152, v166, v182
    v_fmac_f32 v152, v167, v183
    v_fmac_f32 v152, v168, v184
    v_fmac_f32 v152, v169, v185
    ds_read_b128 v[176:179], v147 offset:0
    ds_read_b128 v[180:183], v147 offset:16
    ds_read_b64 v[184:185], v147 offset:64
    s_waitcnt lgkmcnt(6)
    v_mul_f32 v153, v160, v208
    v_fmac_f32 v153, v161, v209
    v_fmac_f32 v153, v162, v210
    v_fmac_f32 v153, v163, v211
    v_fmac_f32 v153, v164, v212
    v_fmac_f32 v153, v165, v213
    v_fmac_f32 v153, v166, v214
    v_fmac_f32 v153, v167, v215
    v_fmac_f32 v153, v168, v216
    v_fmac_f32 v153, v169, v217
    ds_read_b128 v[208:211], v148 offset:0
    ds_read_b128 v[212:215], v148 offset:16
    ds_read_b64 v[216:217], v148 offset:64
    s_waitcnt lgkmcnt(6)
    v_mul_f32 v154, v160, v218
    v_fmac_f32 v154, v161, v219
    v_fmac_f32 v154, v162, v220
    v_fmac_f32 v154, v163, v221
    v_fmac_f32 v154, v164, v222
    v_fmac_f32 v154, v165, v223
    v_fmac_f32 v154, v166, v224
    v_fmac_f32 v154, v167, v225
    v_fmac_f32 v154, v168, v226
    v_fmac_f32 v154, v169, v227
    ds_read_b128 v[218:221], v149 offset:0
    ds_read_b128 v[222:225], v149 offset:16
    ds_read_b64 v[226:227], v149 offset:64
    s_waitcnt lgkmcnt(6)
    v_mul_f32 v155, v160, v176
    v_fmac_f32 v155, v161, v177
    v_fmac_f32 v155, v162, v178
    v_fmac_f32 v155, v163, v179
    v_fmac_f32 v155, v164, v180
    v_fmac_f32 v155, v165, v181
    v_fmac_f32 v155, v166, v182
    v_fmac_f32 v155, v167, v183
    v_fmac_f32 v155, v168, v184
    v_fmac_f32 v155, v169, v185
    ds_read_b128 v[176:179], v150 offset:0
    ds_read_b128 v[180:183], v150 offset:16
    ds_read_b64 v[184:185], v150 offset:64
    s_waitcnt lgkmcnt(6)
    v_mul_f32 v156, v160, v208
    v_fmac_f32 v156, v161, v209
    v_fmac_f32 v156, v162, v210
    v_fmac_f32 v156, v163, v211
    v_fmac_f32 v156, v164, v212
    v_fmac_f32 v156, v165, v213
    v_fmac_f32 v156, v166, v214
    v_fmac_f32 v156, v167, v215
    v_fmac_f32 v156, v168, v216
    v_fmac_f32 v156, v169, v217
    ds_read_b128 v[208:211], v151 offset:0
    ds_read_b128 v[212:215], v151 offset:16
    ds_read_b64 v[216:217], v151 offset:64
    s_waitcnt lgkmcnt(6)
    v_mul_f32 v157, v160, v218
    v_fmac_f32 v157, v161, v219
    v_fmac_f32 v157, v162, v220
    v_fmac_f32 v157, v163, v221
    v_fmac_f32 v157, v164, v222
    v_fmac_f32 v157, v165, v223
    v_fmac_f32 v157, v166, v224
    v_fmac_f32 v157, v167, v225
    v_fmac_f32 v157, v168, v226
    v_fmac_f32 v157, v169, v227
    s_waitcnt lgkmcnt(3)
    v_mul_f32 v158, v160, v176
    v_fmac_f32 v158, v161, v177
    v_fmac_f32 v158, v162, v178
    v_fmac_f32 v158, v163, v179
    v_fmac_f32 v158, v164, v180
    v_fmac_f32 v158, v165, v181
    v_fmac_f32 v158, v166, v182
    v_fmac_f32 v158, v167, v183
    v_fmac_f32 v158, v168, v184
    v_fmac_f32 v158, v169, v185
    s_waitcnt lgkmcnt(0)
    v_mul_f32 v159, v160, v208
    v_fmac_f32 v159, v161, v209
    v_fmac_f32 v159, v162, v210
    v_fmac_f32 v159, v163, v211
    v_fmac_f32 v159, v164, v212
    v_fmac_f32 v159, v165, v213
    v_fmac_f32 v159, v166, v214
    v_fmac_f32 v159, v167, v215
    v_fmac_f32 v159, v168, v216
    v_fmac_f32 v159, v169, v217
    buffer_load_dwordx4 v[24:27], v238, s[48:51], s29 offen offset:3072
    buffer_load_dwordx4 v[28:31], v238, s[48:51], s66 offen offset:3072
    s_add_u32 s29, s28, 4096
    buffer_load_dwordx4 v[32:35], v238, s[48:51], s29 offen offset:0
    s_add_u32 s66, s65, 4096
    buffer_load_dwordx4 v[36:39], v238, s[48:51], s66 offen offset:0
    ds_read_b128 v[176:179], v144 offset:32
    ds_read_b128 v[180:183], v144 offset:48
    ds_read_b64 v[184:185], v144 offset:64
    ds_read_b128 v[208:211], v145 offset:32
    ds_read_b128 v[212:215], v145 offset:48
    ds_read_b64 v[216:217], v145 offset:64
    v_mov_b32 v195, 0xceabfb8f
    v_cmp_le_u32 vcc, s27, v200
    v_mov_b32 v200, v152
    s_nop 1
    v_permlane32_swap_b32 v152, v200
    v_add_f32 v152, v152, v200
    v_mul_f32 v152, 0x3eae1a93, v152
    v_cndmask_b32 v152, v195, v152, vcc
    v_cmp_le_u32 vcc, s27, v201
    v_mov_b32 v201, v153
    s_nop 1
    v_permlane32_swap_b32 v153, v201
    v_add_f32 v153, v153, v201
    v_mul_f32 v153, 0x3eae1a93, v153
    v_cndmask_b32 v153, v195, v153, vcc
    v_cmp_le_u32 vcc, s27, v202
    v_mov_b32 v202, v154
    s_nop 1
    v_permlane32_swap_b32 v154, v202
    v_add_f32 v154, v154, v202
    v_mul_f32 v154, 0x3eae1a93, v154
    v_cndmask_b32 v154, v195, v154, vcc
    v_cmp_le_u32 vcc, s27, v203
    v_mov_b32 v203, v155
    s_nop 1
    v_permlane32_swap_b32 v155, v203
    v_add_f32 v155, v155, v203
    v_mul_f32 v155, 0x3eae1a93, v155
    v_cndmask_b32 v155, v195, v155, vcc
    v_cmp_le_u32 vcc, s27, v204
    v_mov_b32 v204, v156
    s_nop 1
    v_permlane32_swap_b32 v156, v204
    v_add_f32 v156, v156, v204
    v_mul_f32 v156, 0x3eae1a93, v156
    v_cndmask_b32 v156, v195, v156, vcc
    v_cmp_le_u32 vcc, s27, v205
    v_mov_b32 v205, v157
    s_nop 1
    v_permlane32_swap_b32 v157, v205
    v_add_f32 v157, v157, v205
    v_mul_f32 v157, 0x3eae1a93, v157
    v_cndmask_b32 v157, v195, v157, vcc
    v_cmp_le_u32 vcc, s27, v206
    v_mov_b32 v206, v158
    s_nop 1
    v_permlane32_swap_b32 v158, v206
    v_add_f32 v158, v158, v206
    v_mul_f32 v158, 0x3eae1a93, v158
    v_cndmask_b32 v158, v195, v158, vcc
    v_cmp_le_u32 vcc, s27, v207
    v_mov_b32 v207, v159
    s_nop 1
    v_permlane32_swap_b32 v159, v207
    v_add_f32 v159, v159, v207
    v_mul_f32 v159, 0x3eae1a93, v159
    v_cndmask_b32 v159, v195, v159, vcc
    v_max3_f32 v200, v152, v153, v154
    v_max3_f32 v200, v200, v155, v156
    v_max3_f32 v200, v200, v157, v158
    v_max_f32 v200, v200, v159
    v_sub_f32 v152, v152, v200
    v_sub_f32 v153, v153, v200
    v_sub_f32 v154, v154, v200
    v_sub_f32 v155, v155, v200
    v_sub_f32 v156, v156, v200
    v_sub_f32 v157, v157, v200
    v_sub_f32 v158, v158, v200
    v_sub_f32 v159, v159, v200
    v_exp_f32 v152, v152
    v_exp_f32 v153, v153
    v_exp_f32 v154, v154
    v_exp_f32 v155, v155
    v_exp_f32 v156, v156
    v_exp_f32 v157, v157
    v_exp_f32 v158, v158
    v_exp_f32 v159, v159
    v_add_f32 v201, v152, v153
    v_add_f32 v201, v201, v154
    v_add_f32 v201, v201, v155
    v_add_f32 v201, v201, v156
    v_add_f32 v201, v201, v157
    v_add_f32 v201, v201, v158
    v_add_f32 v201, v201, v159
    v_rcp_f32 v201, v201
    buffer_load_dwordx4 v[40:43], v238, s[48:51], s29 offen offset:1024
    buffer_load_dwordx4 v[44:47], v238, s[48:51], s66 offen offset:1024
    buffer_load_dwordx4 v[48:51], v238, s[48:51], s29 offen offset:2048
    buffer_load_dwordx4 v[52:55], v238, s[48:51], s66 offen offset:2048
    ds_read_b128 v[218:221], v146 offset:32
    ds_read_b128 v[222:225], v146 offset:48
    ds_read_b64 v[226:227], v146 offset:64
    s_waitcnt lgkmcnt(6)
    v_mul_f32 v160, v152, v176
    v_mul_f32 v161, v152, v177
    v_mul_f32 v162, v152, v178
    v_mul_f32 v163, v152, v179
    v_mul_f32 v164, v152, v180
    v_mul_f32 v165, v152, v181
    v_mul_f32 v166, v152, v182
    v_mul_f32 v167, v152, v183
    v_mul_f32 v168, v152, v184
    v_mul_f32 v169, v152, v185
    ds_read_b128 v[176:179], v147 offset:32
    ds_read_b128 v[180:183], v147 offset:48
    ds_read_b64 v[184:185], v147 offset:64
    s_waitcnt lgkmcnt(6)
    v_fmac_f32 v160, v153, v208
    v_fmac_f32 v161, v153, v209
    v_fmac_f32 v162, v153, v210
    v_fmac_f32 v163, v153, v211
    v_fmac_f32 v164, v153, v212
    v_fmac_f32 v165, v153, v213
    v_fmac_f32 v166, v153, v214
    v_fmac_f32 v167, v153, v215
    v_fmac_f32 v168, v153, v216
    v_fmac_f32 v169, v153, v217
    ds_read_b128 v[208:211], v148 offset:32
    ds_read_b128 v[212:215], v148 offset:48
    ds_read_b64 v[216:217], v148 offset:64
    s_waitcnt lgkmcnt(6)
    v_fmac_f32 v160, v154, v218
    v_fmac_f32 v161, v154, v219
    v_fmac_f32 v162, v154, v220
    v_fmac_f32 v163, v154, v221
    v_fmac_f32 v164, v154, v222
    v_fmac_f32 v165, v154, v223
    v_fmac_f32 v166, v154, v224
    v_fmac_f32 v167, v154, v225
    v_fmac_f32 v168, v154, v226
    v_fmac_f32 v169, v154, v227
    ds_read_b128 v[218:221], v149 offset:32
    ds_read_b128 v[222:225], v149 offset:48
    ds_read_b64 v[226:227], v149 offset:64
    s_waitcnt lgkmcnt(6)
    v_fmac_f32 v160, v155, v176
    v_fmac_f32 v161, v155, v177
    v_fmac_f32 v162, v155, v178
    v_fmac_f32 v163, v155, v179
    v_fmac_f32 v164, v155, v180
    v_fmac_f32 v165, v155, v181
    v_fmac_f32 v166, v155, v182
    v_fmac_f32 v167, v155, v183
    v_fmac_f32 v168, v155, v184
    v_fmac_f32 v169, v155, v185
    ds_read_b128 v[176:179], v150 offset:32
    ds_read_b128 v[180:183], v150 offset:48
    ds_read_b64 v[184:185], v150 offset:64
    s_waitcnt lgkmcnt(6)
    v_fmac_f32 v160, v156, v208
    v_fmac_f32 v161, v156, v209
    v_fmac_f32 v162, v156, v210
    v_fmac_f32 v163, v156, v211
    v_fmac_f32 v164, v156, v212
    v_fmac_f32 v165, v156, v213
    v_fmac_f32 v166, v156, v214
    v_fmac_f32 v167, v156, v215
    v_fmac_f32 v168, v156, v216
    v_fmac_f32 v169, v156, v217
    ds_read_b128 v[208:211], v151 offset:32
    ds_read_b128 v[212:215], v151 offset:48
    ds_read_b64 v[216:217], v151 offset:64
    s_waitcnt lgkmcnt(6)
    v_fmac_f32 v160, v157, v218
    v_fmac_f32 v161, v157, v219
    v_fmac_f32 v162, v157, v220
    v_fmac_f32 v163, v157, v221
    v_fmac_f32 v164, v157, v222
    v_fmac_f32 v165, v157, v223
    v_fmac_f32 v166, v157, v224
    v_fmac_f32 v167, v157, v225
    v_fmac_f32 v168, v157, v226
    v_fmac_f32 v169, v157, v227
    s_waitcnt lgkmcnt(3)
    v_fmac_f32 v160, v158, v176
    v_fmac_f32 v161, v158, v177
    v_fmac_f32 v162, v158, v178
    v_fmac_f32 v163, v158, v179
    v_fmac_f32 v164, v158, v180
    v_fmac_f32 v165, v158, v181
    v_fmac_f32 v166, v158, v182
    v_fmac_f32 v167, v158, v183
    v_fmac_f32 v168, v158, v184
    v_fmac_f32 v169, v158, v185
    s_waitcnt lgkmcnt(0)
    v_fmac_f32 v160, v159, v208
    v_fmac_f32 v161, v159, v209
    v_fmac_f32 v162, v159, v210
    v_fmac_f32 v163, v159, v211
    v_fmac_f32 v164, v159, v212
    v_fmac_f32 v165, v159, v213
    v_fmac_f32 v166, v159, v214
    v_fmac_f32 v167, v159, v215
    v_fmac_f32 v168, v159, v216
    v_fmac_f32 v169, v159, v217
    v_mul_f32 v160, v160, v201
    v_mul_f32 v161, v161, v201
    v_mul_f32 v162, v162, v201
    v_mul_f32 v163, v163, v201
    v_mul_f32 v164, v164, v201
    v_mul_f32 v165, v165, v201
    v_mul_f32 v166, v166, v201
    v_mul_f32 v167, v167, v201
    v_mul_f32 v168, v168, v201
    v_mul_f32 v169, v169, v201
    v_cvt_pk_bf16_f32 v186, v160, v161
    v_cvt_pk_bf16_f32 v187, v162, v163
    v_cvt_pk_bf16_f32 v188, v164, v165
    v_cvt_pk_bf16_f32 v189, v166, v167
    v_cvt_pk_bf16_f32 v190, v168, v169
    buffer_load_dwordx4 v[56:59], v238, s[48:51], s29 offen offset:3072
    buffer_load_dwordx4 v[60:63], v238, s[48:51], s66 offen offset:3072
    s_add_u32 s29, s28, 8192
    buffer_load_dwordx4 v[64:67], v238, s[48:51], s29 offen offset:0
    s_add_u32 s66, s65, 8192
    buffer_load_dwordx4 v[68:71], v238, s[48:51], s66 offen offset:0
    s_lshl_b32 s26, s23, 9
    s_add_u32 s26, s26, 147456
    s_lshr_b32 s27, s23, 2
    s_lshl_b32 s27, s27, 8
    s_and_b32 s25, s23, 3
    s_lshl_b32 s25, s25, 2
    s_add_u32 s27, s27, s25
    s_add_u32 s27, s27, 163584
    buffer_store_dwordx4 v[186:189], v239, s[48:51], s26 offen sc1
    s_mov_b64 exec, s[74:75]
    buffer_store_dword v190, v239, s[48:51], s27 offen sc1
    s_mov_b64 exec, -1
    s_load_dwordx2 s[6:7], s[0:1], 56
    v_mbcnt_lo_u32_b32 v213, -1, 0
    v_mbcnt_hi_u32_b32 v213, -1, v213
    v_lshrrev_b32 v227, 4, v213
    v_and_b32 v228, 7, v213
    v_lshl_add_u32 v228, v227, 3, v228
    v_lshlrev_b32 v228, 4, v228
    v_bfe_u32 v229, v213, 3, 1
    v_mul_u32_u24 v237, 0x4800, v229
    v_add_u32 v228, v228, v237
    v_add_u32 v204, 0, v238
    v_add_u32 v208, 4096, v228
    v_add_u32 v205, 36864, v238
    v_add_u32 v209, 40960, v228
    v_add_u32 v206, 73728, v238
    v_add_u32 v210, 77824, v228
    v_add_u32 v207, 110592, v238
    v_add_u32 v211, 114688, v228
    s_add_u32 s44, s12, 0x3400000
    s_addc_u32 s45, s13, 0
    s_mov_b32 s46, 0xf00000
    s_mov_b32 s47, 0x00020000
    s_mov_b32 s36, s4
    s_mov_b32 s37, s5
    s_mov_b32 s38, 0x240000
    s_mov_b32 s39, 0x00020000
    v_and_b32 v229, 15, v213
    s_lshl_b32 s27, s21, 4
    v_add_u32 v229, s27, v229
    v_mul_u32_u24 v229, 0x480, v229
    s_mul_i32 s27, s20, 144
    v_lshl_add_u32 v229, v227, 3, v229
    v_add_u32 v214, s27, v229
    v_cmp_gt_u32 vcc, 2, v227
    v_mov_b32 v230, 0x7fff0000
    s_nop 0
    v_cndmask_b32 v215, v230, v214, vcc
    v_lshlrev_b32 v233, 3, v213
    v_and_b32 v230, 0xff, v233
    v_min_u32 v231, 2, v213
    v_lshlrev_b32 v234, 3, v231
    v_add_u32 v231, 1, v231
    v_xor_b32 v235, s2, v231
    v_lshl_add_u32 v236, v235, 7, v234
    buffer_load_dwordx2 v[216:217], v214, s[36:39], 0 offen offset:0
    buffer_load_dwordx2 v[218:219], v214, s[36:39], 0 offen offset:32
    buffer_load_dwordx2 v[220:221], v214, s[36:39], 0 offen offset:64
    buffer_load_dwordx2 v[222:223], v214, s[36:39], 0 offen offset:96
    buffer_load_dwordx2 v[224:225], v215, s[36:39], 0 offen offset:128
    s_waitcnt lgkmcnt(0)
    s_mov_b32 s40, s6
    s_mov_b32 s41, s7
    s_mov_b32 s42, 0x240000
    s_mov_b32 s43, 0x00020000
    s_branch K_P2
K_G2:
    s_waitcnt vmcnt(20)
    s_barrier
    ds_read_b64_tr_b16 v[208:209], v228 offset:0
    ds_read_b64_tr_b16 v[210:211], v228 offset:256
    ds_read_b64_tr_b16 v[212:213], v228 offset:512
    ds_read_b64_tr_b16 v[214:215], v228 offset:768
    ds_read_b64_tr_b16 v[216:217], v228 offset:8192
    ds_read_b64_tr_b16 v[218:219], v228 offset:8448
    s_waitcnt vmcnt(8)
    ds_read_b64_tr_b16 v[220:221], v228 offset:8704
    ds_read_b64_tr_b16 v[222:223], v228 offset:8960
    s_waitcnt lgkmcnt(6)
    v_mfma_f32_16x16x32_bf16 v[144:147], v[208:211], v[0:3], 0
    v_mfma_f32_16x16x32_bf16 v[152:155], v[208:211], v[4:7], 0
    ds_read_b64_tr_b16 v[208:209], v229 offset:0
    ds_read_b64_tr_b16 v[210:211], v229 offset:256
    s_waitcnt lgkmcnt(6)
    v_mfma_f32_16x16x32_bf16 v[160:163], v[212:215], v[0:3], 0
    v_mfma_f32_16x16x32_bf16 v[168:171], v[212:215], v[4:7], 0
    buffer_load_dwordx4 v[48:51], v240, s[44:47], s29 offen offset:0
    ds_read_b64_tr_b16 v[212:213], v229 offset:512
    ds_read_b64_tr_b16 v[214:215], v229 offset:768
    s_waitcnt lgkmcnt(6)
    v_mfma_f32_16x16x32_bf16 v[176:179], v[216:219], v[0:3], 0
    v_mfma_f32_16x16x32_bf16 v[184:187], v[216:219], v[4:7], 0
    ds_read_b64_tr_b16 v[216:217], v229 offset:8192
    ds_read_b64_tr_b16 v[218:219], v229 offset:8448
    s_waitcnt lgkmcnt(6)
    v_mfma_f32_16x16x32_bf16 v[192:195], v[220:223], v[0:3], 0
    v_mfma_f32_16x16x32_bf16 v[200:203], v[220:223], v[4:7], 0
    buffer_load_dwordx4 v[52:55], v240, s[44:47], s29 offen offset:256
    ds_read_b64_tr_b16 v[220:221], v229 offset:8704
    ds_read_b64_tr_b16 v[222:223], v229 offset:8960
    s_waitcnt lgkmcnt(6)
    v_mfma_f32_16x16x32_bf16 v[148:151], v[208:211], v[0:3], 0
    v_mfma_f32_16x16x32_bf16 v[156:159], v[208:211], v[4:7], 0
    buffer_load_dwordx4 v[56:59], v240, s[44:47], s29 offen offset:2048
    ds_read_b64_tr_b16 v[208:209], v228 offset:4096
    ds_read_b64_tr_b16 v[210:211], v228 offset:4352
    s_waitcnt lgkmcnt(6)
    v_mfma_f32_16x16x32_bf16 v[164:167], v[212:215], v[0:3], 0
    v_mfma_f32_16x16x32_bf16 v[172:175], v[212:215], v[4:7], 0
    ds_read_b64_tr_b16 v[212:213], v228 offset:4608
    ds_read_b64_tr_b16 v[214:215], v228 offset:4864
    s_waitcnt lgkmcnt(6)
    v_mfma_f32_16x16x32_bf16 v[180:183], v[216:219], v[0:3], 0
    v_mfma_f32_16x16x32_bf16 v[188:191], v[216:219], v[4:7], 0
    buffer_load_dwordx4 v[60:63], v240, s[44:47], s29 offen offset:2304
    s_add_u32 s29, s29, 4096
    ds_read_b64_tr_b16 v[216:217], v228 offset:12288
    ds_read_b64_tr_b16 v[218:219], v228 offset:12544
    s_waitcnt lgkmcnt(6)
    v_mfma_f32_16x16x32_bf16 v[196:199], v[220:223], v[0:3], 0
    v_mfma_f32_16x16x32_bf16 v[204:207], v[220:223], v[4:7], 0
    s_barrier
    ds_read_b64_tr_b16 v[220:221], v228 offset:12800
    ds_read_b64_tr_b16 v[222:223], v228 offset:13056
    s_waitcnt lgkmcnt(6)
    v_mfma_f32_16x16x32_bf16 v[144:147], v[208:211], v[8:11], v[144:147]
    v_mfma_f32_16x16x32_bf16 v[152:155], v[208:211], v[12:15], v[152:155]
    ds_read_b64_tr_b16 v[208:209], v229 offset:4096
    ds_read_b64_tr_b16 v[210:211], v229 offset:4352
    s_waitcnt lgkmcnt(6)
    v_mfma_f32_16x16x32_bf16 v[160:163], v[212:215], v[8:11], v[160:163]
    v_mfma_f32_16x16x32_bf16 v[168:171], v[212:215], v[12:15], v[168:171]
    ds_read_b64_tr_b16 v[212:213], v229 offset:4608
    ds_read_b64_tr_b16 v[214:215], v229 offset:4864
    s_waitcnt lgkmcnt(6)
    v_mfma_f32_16x16x32_bf16 v[176:179], v[216:219], v[8:11], v[176:179]
    v_mfma_f32_16x16x32_bf16 v[184:187], v[216:219], v[12:15], v[184:187]
    buffer_load_dwordx4 v[64:67], v240, s[44:47], s29 offen offset:0
    ds_read_b64_tr_b16 v[216:217], v229 offset:12288
    ds_read_b64_tr_b16 v[218:219], v229 offset:12544
    s_waitcnt lgkmcnt(6)
    v_mfma_f32_16x16x32_bf16 v[192:195], v[220:223], v[8:11], v[192:195]
    v_mfma_f32_16x16x32_bf16 v[200:203], v[220:223], v[12:15], v[200:203]
    ds_read_b64_tr_b16 v[220:221], v229 offset:12800
    ds_read_b64_tr_b16 v[222:223], v229 offset:13056
    s_waitcnt lgkmcnt(6)
    v_mfma_f32_16x16x32_bf16 v[148:151], v[208:211], v[8:11], v[148:151]
    v_mfma_f32_16x16x32_bf16 v[156:159], v[208:211], v[12:15], v[156:159]
    ds_read_b64_tr_b16 v[208:209], v228 offset:16384
    ds_read_b64_tr_b16 v[210:211], v228 offset:16640
    s_waitcnt lgkmcnt(6)
    v_mfma_f32_16x16x32_bf16 v[164:167], v[212:215], v[8:11], v[164:167]
    v_mfma_f32_16x16x32_bf16 v[172:175], v[212:215], v[12:15], v[172:175]
    ds_read_b64_tr_b16 v[212:213], v228 offset:16896
    ds_read_b64_tr_b16 v[214:215], v228 offset:17152
    s_waitcnt lgkmcnt(6)
    v_mfma_f32_16x16x32_bf16 v[180:183], v[216:219], v[8:11], v[180:183]
    v_mfma_f32_16x16x32_bf16 v[188:191], v[216:219], v[12:15], v[188:191]
    buffer_load_dwordx4 v[68:71], v240, s[44:47], s29 offen offset:256
    ds_read_b64_tr_b16 v[216:217], v228 offset:24576
    ds_read_b64_tr_b16 v[218:219], v228 offset:24832
    s_waitcnt lgkmcnt(6)
    v_mfma_f32_16x16x32_bf16 v[196:199], v[220:223], v[8:11], v[196:199]
    v_mfma_f32_16x16x32_bf16 v[204:207], v[220:223], v[12:15], v[204:207]
    s_waitcnt vmcnt(10)
    ds_read_b64_tr_b16 v[220:221], v228 offset:25088
    ds_read_b64_tr_b16 v[222:223], v228 offset:25344
    s_waitcnt lgkmcnt(6)
    v_mfma_f32_16x16x32_bf16 v[144:147], v[208:211], v[16:19], v[144:147]
    v_mfma_f32_16x16x32_bf16 v[152:155], v[208:211], v[20:23], v[152:155]
    ds_read_b64_tr_b16 v[208:209], v229 offset:16384
    ds_read_b64_tr_b16 v[210:211], v229 offset:16640
    s_waitcnt lgkmcnt(6)
    v_mfma_f32_16x16x32_bf16 v[160:163], v[212:215], v[16:19], v[160:163]
    v_mfma_f32_16x16x32_bf16 v[168:171], v[212:215], v[20:23], v[168:171]
    ds_read_b64_tr_b16 v[212:213], v229 offset:16896
    ds_read_b64_tr_b16 v[214:215], v229 offset:17152
    s_waitcnt lgkmcnt(6)
    v_mfma_f32_16x16x32_bf16 v[176:179], v[216:219], v[16:19], v[176:179]
    v_mfma_f32_16x16x32_bf16 v[184:187], v[216:219], v[20:23], v[184:187]
    buffer_load_dwordx4 v[72:75], v240, s[44:47], s29 offen offset:2048
    ds_read_b64_tr_b16 v[216:217], v229 offset:24576
    ds_read_b64_tr_b16 v[218:219], v229 offset:24832
    s_waitcnt lgkmcnt(6)
    v_mfma_f32_16x16x32_bf16 v[192:195], v[220:223], v[16:19], v[192:195]
    v_mfma_f32_16x16x32_bf16 v[200:203], v[220:223], v[20:23], v[200:203]
    ds_read_b64_tr_b16 v[220:221], v229 offset:25088
    ds_read_b64_tr_b16 v[222:223], v229 offset:25344
    s_waitcnt lgkmcnt(6)
    v_mfma_f32_16x16x32_bf16 v[148:151], v[208:211], v[16:19], v[148:151]
    v_mfma_f32_16x16x32_bf16 v[156:159], v[208:211], v[20:23], v[156:159]
    ds_read_b64_tr_b16 v[208:209], v228 offset:20480
    ds_read_b64_tr_b16 v[210:211], v228 offset:20736
    s_waitcnt lgkmcnt(6)
    v_mfma_f32_16x16x32_bf16 v[164:167], v[212:215], v[16:19], v[164:167]
    v_mfma_f32_16x16x32_bf16 v[172:175], v[212:215], v[20:23], v[172:175]
    ds_read_b64_tr_b16 v[212:213], v228 offset:20992
    ds_read_b64_tr_b16 v[214:215], v228 offset:21248
    s_waitcnt lgkmcnt(6)
    v_mfma_f32_16x16x32_bf16 v[180:183], v[216:219], v[16:19], v[180:183]
    v_mfma_f32_16x16x32_bf16 v[188:191], v[216:219], v[20:23], v[188:191]
    buffer_load_dwordx4 v[76:79], v240, s[44:47], s29 offen offset:2304
    s_add_u32 s29, s29, 4096
    ds_read_b64_tr_b16 v[216:217], v228 offset:28672
    ds_read_b64_tr_b16 v[218:219], v228 offset:28928
    s_waitcnt lgkmcnt(6)
    v_mfma_f32_16x16x32_bf16 v[196:199], v[220:223], v[16:19], v[196:199]
    v_mfma_f32_16x16x32_bf16 v[204:207], v[220:223], v[20:23], v[204:207]
    s_barrier
    ds_read_b64_tr_b16 v[220:221], v228 offset:29184
    ds_read_b64_tr_b16 v[222:223], v228 offset:29440
    s_waitcnt lgkmcnt(6)
    v_mfma_f32_16x16x32_bf16 v[144:147], v[208:211], v[24:27], v[144:147]
    v_mfma_f32_16x16x32_bf16 v[152:155], v[208:211], v[28:31], v[152:155]
    ds_read_b64_tr_b16 v[208:209], v229 offset:20480
    ds_read_b64_tr_b16 v[210:211], v229 offset:20736
    s_waitcnt lgkmcnt(6)
    v_mfma_f32_16x16x32_bf16 v[160:163], v[212:215], v[24:27], v[160:163]
    v_mfma_f32_16x16x32_bf16 v[168:171], v[212:215], v[28:31], v[168:171]
    buffer_load_dwordx4 v[80:83], v240, s[44:47], s29 offen offset:0
    ds_read_b64_tr_b16 v[212:213], v229 offset:20992
    ds_read_b64_tr_b16 v[214:215], v229 offset:21248
    s_waitcnt lgkmcnt(6)
    v_mfma_f32_16x16x32_bf16 v[176:179], v[216:219], v[24:27], v[176:179]
    v_mfma_f32_16x16x32_bf16 v[184:187], v[216:219], v[28:31], v[184:187]
    ds_read_b64_tr_b16 v[216:217], v229 offset:28672
    ds_read_b64_tr_b16 v[218:219], v229 offset:28928
    s_waitcnt lgkmcnt(6)
    v_mfma_f32_16x16x32_bf16 v[192:195], v[220:223], v[24:27], v[192:195]
    v_mfma_f32_16x16x32_bf16 v[200:203], v[220:223], v[28:31], v[200:203]
    ds_read_b64_tr_b16 v[220:221], v229 offset:29184
    ds_read_b64_tr_b16 v[222:223], v229 offset:29440
    s_waitcnt lgkmcnt(6)
    v_mfma_f32_16x16x32_bf16 v[148:151], v[208:211], v[24:27], v[148:151]
    v_mfma_f32_16x16x32_bf16 v[156:159], v[208:211], v[28:31], v[156:159]
    buffer_load_dwordx4 v[84:87], v240, s[44:47], s29 offen offset:256
    ds_read_b64_tr_b16 v[208:209], v228 offset:32768
    ds_read_b64_tr_b16 v[210:211], v228 offset:33024
    s_waitcnt lgkmcnt(6)
    v_mfma_f32_16x16x32_bf16 v[164:167], v[212:215], v[24:27], v[164:167]
    v_mfma_f32_16x16x32_bf16 v[172:175], v[212:215], v[28:31], v[172:175]
    ds_read_b64_tr_b16 v[212:213], v228 offset:33280
    ds_read_b64_tr_b16 v[214:215], v228 offset:33536
    s_waitcnt lgkmcnt(6)
    v_mfma_f32_16x16x32_bf16 v[180:183], v[216:219], v[24:27], v[180:183]
    v_mfma_f32_16x16x32_bf16 v[188:191], v[216:219], v[28:31], v[188:191]
    buffer_load_dwordx4 v[88:91], v240, s[44:47], s29 offen offset:2048
    ds_read_b64_tr_b16 v[216:217], v228 offset:40960
    ds_read_b64_tr_b16 v[218:219], v228 offset:41216
    s_waitcnt lgkmcnt(6)
    v_mfma_f32_16x16x32_bf16 v[196:199], v[220:223], v[24:27], v[196:199]
    v_mfma_f32_16x16x32_bf16 v[204:207], v[220:223], v[28:31], v[204:207]
    s_waitcnt vmcnt(11)
    ds_read_b64_tr_b16 v[220:221], v228 offset:41472
    ds_read_b64_tr_b16 v[222:223], v228 offset:41728
    s_waitcnt lgkmcnt(6)
    v_mfma_f32_16x16x32_bf16 v[144:147], v[208:211], v[32:35], v[144:147]
    v_mfma_f32_16x16x32_bf16 v[152:155], v[208:211], v[36:39], v[152:155]
    ds_read_b64_tr_b16 v[208:209], v229 offset:32768
    ds_read_b64_tr_b16 v[210:211], v229 offset:33024
    s_waitcnt lgkmcnt(6)
    v_mfma_f32_16x16x32_bf16 v[160:163], v[212:215], v[32:35], v[160:163]
    v_mfma_f32_16x16x32_bf16 v[168:171], v[212:215], v[36:39], v[168:171]
    buffer_load_dwordx4 v[92:95], v240, s[44:47], s29 offen offset:2304
    s_add_u32 s29, s29, 4096
    ds_read_b64_tr_b16 v[212:213], v229 offset:33280
    ds_read_b64_tr_b16 v[214:215], v229 offset:33536
    s_waitcnt lgkmcnt(6)
    v_mfma_f32_16x16x32_bf16 v[176:179], v[216:219], v[32:35], v[176:179]
    v_mfma_f32_16x16x32_bf16 v[184:187], v[216:219], v[36:39], v[184:187]
    ds_read_b64_tr_b16 v[216:217], v229 offset:40960
    ds_read_b64_tr_b16 v[218:219], v229 offset:41216
    s_waitcnt lgkmcnt(6)
    v_mfma_f32_16x16x32_bf16 v[192:195], v[220:223], v[32:35], v[192:195]
    v_mfma_f32_16x16x32_bf16 v[200:203], v[220:223], v[36:39], v[200:203]
    s_add_u32 s25, s65, 0x2d0000
    s_add_u32 m0, s24, 81920
    s_nop 0
    buffer_load_dwordx4 v232, s[32:35], s25 offen lds
    ds_read_b64_tr_b16 v[220:221], v229 offset:41472
    ds_read_b64_tr_b16 v[222:223], v229 offset:41728
    s_waitcnt lgkmcnt(6)
    v_mfma_f32_16x16x32_bf16 v[148:151], v[208:211], v[32:35], v[148:151]
    v_mfma_f32_16x16x32_bf16 v[156:159], v[208:211], v[36:39], v[156:159]
    ds_read_b64_tr_b16 v[208:209], v228 offset:36864
    ds_read_b64_tr_b16 v[210:211], v228 offset:37120
    s_waitcnt lgkmcnt(6)
    v_mfma_f32_16x16x32_bf16 v[164:167], v[212:215], v[32:35], v[164:167]
    v_mfma_f32_16x16x32_bf16 v[172:175], v[212:215], v[36:39], v[172:175]
    ds_read_b64_tr_b16 v[212:213], v228 offset:37376
    ds_read_b64_tr_b16 v[214:215], v228 offset:37632
    s_waitcnt lgkmcnt(6)
    v_mfma_f32_16x16x32_bf16 v[180:183], v[216:219], v[32:35], v[180:183]
    v_mfma_f32_16x16x32_bf16 v[188:191], v[216:219], v[36:39], v[188:191]
    s_add_u32 s25, s65, 0x2d0000
    s_add_u32 m0, s24, 90112
    s_nop 0
    buffer_load_dwordx4 v232, s[36:39], s25 offen lds
    ds_read_b64_tr_b16 v[216:217], v228 offset:45056
    ds_read_b64_tr_b16 v[218:219], v228 offset:45312
    s_waitcnt lgkmcnt(6)
    v_mfma_f32_16x16x32_bf16 v[196:199], v[220:223], v[32:35], v[196:199]
    v_mfma_f32_16x16x32_bf16 v[204:207], v[220:223], v[36:39], v[204:207]
    s_barrier
    ds_read_b64_tr_b16 v[220:221], v228 offset:45568
    ds_read_b64_tr_b16 v[222:223], v228 offset:45824
    s_waitcnt lgkmcnt(6)
    v_mfma_f32_16x16x32_bf16 v[144:147], v[208:211], v[40:43], v[144:147]
    v_mfma_f32_16x16x32_bf16 v[152:155], v[208:211], v[44:47], v[152:155]
    ds_read_b64_tr_b16 v[208:209], v229 offset:36864
    ds_read_b64_tr_b16 v[210:211], v229 offset:37120
    s_waitcnt lgkmcnt(6)
    v_mfma_f32_16x16x32_bf16 v[160:163], v[212:215], v[40:43], v[160:163]
    v_mfma_f32_16x16x32_bf16 v[168:171], v[212:215], v[44:47], v[168:171]
    buffer_load_dwordx4 v[96:99], v240, s[44:47], s29 offen offset:0
    ds_read_b64_tr_b16 v[212:213], v229 offset:37376
    ds_read_b64_tr_b16 v[214:215], v229 offset:37632
    s_waitcnt lgkmcnt(6)
    v_mfma_f32_16x16x32_bf16 v[176:179], v[216:219], v[40:43], v[176:179]
    v_mfma_f32_16x16x32_bf16 v[184:187], v[216:219], v[44:47], v[184:187]
    ds_read_b64_tr_b16 v[216:217], v229 offset:45056
    ds_read_b64_tr_b16 v[218:219], v229 offset:45312
    s_waitcnt lgkmcnt(6)
    v_mfma_f32_16x16x32_bf16 v[192:195], v[220:223], v[40:43], v[192:195]
    v_mfma_f32_16x16x32_bf16 v[200:203], v[220:223], v[44:47], v[200:203]
    buffer_load_dwordx4 v[100:103], v240, s[44:47], s29 offen offset:256
    ds_read_b64_tr_b16 v[220:221], v229 offset:45568
    ds_read_b64_tr_b16 v[222:223], v229 offset:45824
    s_waitcnt lgkmcnt(6)
    v_mfma_f32_16x16x32_bf16 v[148:151], v[208:211], v[40:43], v[148:151]
    v_mfma_f32_16x16x32_bf16 v[156:159], v[208:211], v[44:47], v[156:159]
    ds_read_b64_tr_b16 v[208:209], v228 offset:49152
    ds_read_b64_tr_b16 v[210:211], v228 offset:49408
    s_waitcnt lgkmcnt(6)
    v_mfma_f32_16x16x32_bf16 v[164:167], v[212:215], v[40:43], v[164:167]
    v_mfma_f32_16x16x32_bf16 v[172:175], v[212:215], v[44:47], v[172:175]
    buffer_load_dwordx4 v[104:107], v240, s[44:47], s29 offen offset:2048
    ds_read_b64_tr_b16 v[212:213], v228 offset:49664
    ds_read_b64_tr_b16 v[214:215], v228 offset:49920
    s_waitcnt lgkmcnt(6)
    v_mfma_f32_16x16x32_bf16 v[180:183], v[216:219], v[40:43], v[180:183]
    v_mfma_f32_16x16x32_bf16 v[188:191], v[216:219], v[44:47], v[188:191]
    ds_read_b64_tr_b16 v[216:217], v228 offset:57344
    ds_read_b64_tr_b16 v[218:219], v228 offset:57600
    s_waitcnt lgkmcnt(6)
    v_mfma_f32_16x16x32_bf16 v[196:199], v[220:223], v[40:43], v[196:199]
    v_mfma_f32_16x16x32_bf16 v[204:207], v[220:223], v[44:47], v[204:207]
    buffer_load_dwordx4 v[108:111], v240, s[44:47], s29 offen offset:2304
    s_add_u32 s29, s29, 4096
    s_waitcnt vmcnt(14)
    ds_read_b64_tr_b16 v[220:221], v228 offset:57856
    ds_read_b64_tr_b16 v[222:223], v228 offset:58112
    s_waitcnt lgkmcnt(6)
    v_mfma_f32_16x16x32_bf16 v[144:147], v[208:211], v[48:51], v[144:147]
    v_mfma_f32_16x16x32_bf16 v[152:155], v[208:211], v[52:55], v[152:155]
    s_add_u32 s25, s65, 0x360000
    s_add_u32 m0, s24, 98304
    s_nop 0
    buffer_load_dwordx4 v232, s[32:35], s25 offen lds
    ds_read_b64_tr_b16 v[208:209], v229 offset:49152
    ds_read_b64_tr_b16 v[210:211], v229 offset:49408
    s_waitcnt lgkmcnt(6)
    v_mfma_f32_16x16x32_bf16 v[160:163], v[212:215], v[48:51], v[160:163]
    v_mfma_f32_16x16x32_bf16 v[168:171], v[212:215], v[52:55], v[168:171]
    ds_read_b64_tr_b16 v[212:213], v229 offset:49664
    ds_read_b64_tr_b16 v[214:215], v229 offset:49920
    s_waitcnt lgkmcnt(6)
    v_mfma_f32_16x16x32_bf16 v[176:179], v[216:219], v[48:51], v[176:179]
    v_mfma_f32_16x16x32_bf16 v[184:187], v[216:219], v[52:55], v[184:187]
    s_add_u32 s25, s65, 0x360000
    s_add_u32 m0, s24, 106496
    s_nop 0
    buffer_load_dwordx4 v232, s[36:39], s25 offen lds
    ds_read_b64_tr_b16 v[216:217], v229 offset:57344
    ds_read_b64_tr_b16 v[218:219], v229 offset:57600
    s_waitcnt lgkmcnt(6)
    v_mfma_f32_16x16x32_bf16 v[192:195], v[220:223], v[48:51], v[192:195]
    v_mfma_f32_16x16x32_bf16 v[200:203], v[220:223], v[52:55], v[200:203]
    ds_read_b64_tr_b16 v[220:221], v229 offset:57856
    ds_read_b64_tr_b16 v[222:223], v229 offset:58112
    s_waitcnt lgkmcnt(6)
    v_mfma_f32_16x16x32_bf16 v[148:151], v[208:211], v[48:51], v[148:151]
    v_mfma_f32_16x16x32_bf16 v[156:159], v[208:211], v[52:55], v[156:159]
    s_add_u32 s25, s65, 0x3f0000
    s_add_u32 m0, s24, 0
    s_nop 0
    buffer_load_dwordx4 v232, s[32:35], s25 offen lds
    ds_read_b64_tr_b16 v[208:209], v228 offset:53248
    ds_read_b64_tr_b16 v[210:211], v228 offset:53504
    s_waitcnt lgkmcnt(6)
    v_mfma_f32_16x16x32_bf16 v[164:167], v[212:215], v[48:51], v[164:167]
    v_mfma_f32_16x16x32_bf16 v[172:175], v[212:215], v[52:55], v[172:175]
    ds_read_b64_tr_b16 v[212:213], v228 offset:53760
    ds_read_b64_tr_b16 v[214:215], v228 offset:54016
    s_waitcnt lgkmcnt(6)
    v_mfma_f32_16x16x32_bf16 v[180:183], v[216:219], v[48:51], v[180:183]
    v_mfma_f32_16x16x32_bf16 v[188:191], v[216:219], v[52:55], v[188:191]
    s_add_u32 s25, s65, 0x3f0000
    s_add_u32 m0, s24, 8192
    s_nop 0
    buffer_load_dwordx4 v232, s[36:39], s25 offen lds
    ds_read_b64_tr_b16 v[216:217], v228 offset:61440
    ds_read_b64_tr_b16 v[218:219], v228 offset:61696
    s_waitcnt lgkmcnt(6)
    v_mfma_f32_16x16x32_bf16 v[196:199], v[220:223], v[48:51], v[196:199]
    v_mfma_f32_16x16x32_bf16 v[204:207], v[220:223], v[52:55], v[204:207]
    s_barrier
    ds_read_b64_tr_b16 v[220:221], v228 offset:61952
    ds_read_b64_tr_b16 v[222:223], v228 offset:62208
    s_waitcnt lgkmcnt(6)
    v_mfma_f32_16x16x32_bf16 v[144:147], v[208:211], v[56:59], v[144:147]
    v_mfma_f32_16x16x32_bf16 v[152:155], v[208:211], v[60:63], v[152:155]
    ds_read_b64_tr_b16 v[208:209], v229 offset:53248
    ds_read_b64_tr_b16 v[210:211], v229 offset:53504
    s_waitcnt lgkmcnt(6)
    v_mfma_f32_16x16x32_bf16 v[160:163], v[212:215], v[56:59], v[160:163]
    v_mfma_f32_16x16x32_bf16 v[168:171], v[212:215], v[60:63], v[168:171]
    buffer_load_dwordx4 v[112:115], v240, s[44:47], s29 offen offset:0
    ds_read_b64_tr_b16 v[212:213], v229 offset:53760
    ds_read_b64_tr_b16 v[214:215], v229 offset:54016
    s_waitcnt lgkmcnt(6)
    v_mfma_f32_16x16x32_bf16 v[176:179], v[216:219], v[56:59], v[176:179]
    v_mfma_f32_16x16x32_bf16 v[184:187], v[216:219], v[60:63], v[184:187]
    ds_read_b64_tr_b16 v[216:217], v229 offset:61440
    ds_read_b64_tr_b16 v[218:219], v229 offset:61696
    s_waitcnt lgkmcnt(6)
    v_mfma_f32_16x16x32_bf16 v[192:195], v[220:223], v[56:59], v[192:195]
    v_mfma_f32_16x16x32_bf16 v[200:203], v[220:223], v[60:63], v[200:203]
    ds_read_b64_tr_b16 v[220:221], v229 offset:61952
    ds_read_b64_tr_b16 v[222:223], v229 offset:62208
    s_waitcnt lgkmcnt(6)
    v_mfma_f32_16x16x32_bf16 v[148:151], v[208:211], v[56:59], v[148:151]
    v_mfma_f32_16x16x32_bf16 v[156:159], v[208:211], v[60:63], v[156:159]
    buffer_load_dwordx4 v[116:119], v240, s[44:47], s29 offen offset:256
    v_xor_b32 v228, 0x10000, v228
    v_xor_b32 v229, 0x10000, v229
    v_xor_b32 v230, 0x10000, v230
    v_xor_b32 v231, 0x10000, v231
    v_xor_b32 v249, 0x10000, v249
    ds_read_b64_tr_b16 v[208:209], v228 offset:0
    ds_read_b64_tr_b16 v[210:211], v228 offset:256
    s_waitcnt lgkmcnt(6)
    v_mfma_f32_16x16x32_bf16 v[164:167], v[212:215], v[56:59], v[164:167]
    v_mfma_f32_16x16x32_bf16 v[172:175], v[212:215], v[60:63], v[172:175]
    ds_read_b64_tr_b16 v[212:213], v228 offset:512
    ds_read_b64_tr_b16 v[214:215], v228 offset:768
    s_waitcnt lgkmcnt(6)
    v_mfma_f32_16x16x32_bf16 v[180:183], v[216:219], v[56:59], v[180:183]
    v_mfma_f32_16x16x32_bf16 v[188:191], v[216:219], v[60:63], v[188:191]
    buffer_load_dwordx4 v[120:123], v240, s[44:47], s29 offen offset:2048
    ds_read_b64_tr_b16 v[216:217], v228 offset:8192
    ds_read_b64_tr_b16 v[218:219], v228 offset:8448
    s_waitcnt lgkmcnt(6)
    v_mfma_f32_16x16x32_bf16 v[196:199], v[220:223], v[56:59], v[196:199]
    v_mfma_f32_16x16x32_bf16 v[204:207], v[220:223], v[60:63], v[204:207]
    s_waitcnt vmcnt(17)
    ds_read_b64_tr_b16 v[220:221], v228 offset:8704
    ds_read_b64_tr_b16 v[222:223], v228 offset:8960
    s_waitcnt lgkmcnt(6)
    v_mfma_f32_16x16x32_bf16 v[144:147], v[208:211], v[64:67], v[144:147]
    v_mfma_f32_16x16x32_bf16 v[152:155], v[208:211], v[68:71], v[152:155]
    ds_read_b64_tr_b16 v[208:209], v229 offset:0
    ds_read_b64_tr_b16 v[210:211], v229 offset:256
    s_waitcnt lgkmcnt(6)
    v_mfma_f32_16x16x32_bf16 v[160:163], v[212:215], v[64:67], v[160:163]
    v_mfma_f32_16x16x32_bf16 v[168:171], v[212:215], v[68:71], v[168:171]
    buffer_load_dwordx4 v[124:127], v240, s[44:47], s29 offen offset:2304
    s_add_u32 s29, s29, 4096
    ds_read_b64_tr_b16 v[212:213], v229 offset:512
    ds_read_b64_tr_b16 v[214:215], v229 offset:768
    s_waitcnt lgkmcnt(6)
    v_mfma_f32_16x16x32_bf16 v[176:179], v[216:219], v[64:67], v[176:179]
    v_mfma_f32_16x16x32_bf16 v[184:187], v[216:219], v[68:71], v[184:187]
    ds_read_b64_tr_b16 v[216:217], v229 offset:8192
    ds_read_b64_tr_b16 v[218:219], v229 offset:8448
    s_waitcnt lgkmcnt(6)
    v_mfma_f32_16x16x32_bf16 v[192:195], v[220:223], v[64:67], v[192:195]
    v_mfma_f32_16x16x32_bf16 v[200:203], v[220:223], v[68:71], v[200:203]
    s_add_u32 s25, s65, 0x480000
    s_add_u32 m0, s24, 16384
    s_nop 0
    buffer_load_dwordx4 v232, s[32:35], s25 offen lds
    ds_read_b64_tr_b16 v[220:221], v229 offset:8704
    ds_read_b64_tr_b16 v[222:223], v229 offset:8960
    s_waitcnt lgkmcnt(6)
    v_mfma_f32_16x16x32_bf16 v[148:151], v[208:211], v[64:67], v[148:151]
    v_mfma_f32_16x16x32_bf16 v[156:159], v[208:211], v[68:71], v[156:159]
    ds_read_b64_tr_b16 v[208:209], v228 offset:4096
    ds_read_b64_tr_b16 v[210:211], v228 offset:4352
    s_waitcnt lgkmcnt(6)
    v_mfma_f32_16x16x32_bf16 v[164:167], v[212:215], v[64:67], v[164:167]
    v_mfma_f32_16x16x32_bf16 v[172:175], v[212:215], v[68:71], v[172:175]
    ds_read_b64_tr_b16 v[212:213], v228 offset:4608
    ds_read_b64_tr_b16 v[214:215], v228 offset:4864
    s_waitcnt lgkmcnt(6)
    v_mfma_f32_16x16x32_bf16 v[180:183], v[216:219], v[64:67], v[180:183]
    v_mfma_f32_16x16x32_bf16 v[188:191], v[216:219], v[68:71], v[188:191]
    s_add_u32 s25, s65, 0x480000
    s_add_u32 m0, s24, 24576
    s_nop 0
    buffer_load_dwordx4 v232, s[36:39], s25 offen lds
    ds_read_b64_tr_b16 v[216:217], v228 offset:12288
    ds_read_b64_tr_b16 v[218:219], v228 offset:12544
    s_waitcnt lgkmcnt(6)
    v_mfma_f32_16x16x32_bf16 v[196:199], v[220:223], v[64:67], v[196:199]
    v_mfma_f32_16x16x32_bf16 v[204:207], v[220:223], v[68:71], v[204:207]
    s_waitcnt vmcnt(14)
    s_barrier
    ds_read_b64_tr_b16 v[220:221], v228 offset:12800
    ds_read_b64_tr_b16 v[222:223], v228 offset:13056
    s_waitcnt lgkmcnt(6)
    v_mfma_f32_16x16x32_bf16 v[144:147], v[208:211], v[72:75], v[144:147]
    v_mfma_f32_16x16x32_bf16 v[152:155], v[208:211], v[76:79], v[152:155]
    ds_read_b64_tr_b16 v[208:209], v229 offset:4096
    ds_read_b64_tr_b16 v[210:211], v229 offset:4352
    s_waitcnt lgkmcnt(6)
    v_mfma_f32_16x16x32_bf16 v[160:163], v[212:215], v[72:75], v[160:163]
    v_mfma_f32_16x16x32_bf16 v[168:171], v[212:215], v[76:79], v[168:171]
    ds_read_b64_tr_b16 v[212:213], v229 offset:4608
    ds_read_b64_tr_b16 v[214:215], v229 offset:4864
    s_waitcnt lgkmcnt(6)
    v_mfma_f32_16x16x32_bf16 v[176:179], v[216:219], v[72:75], v[176:179]
    v_mfma_f32_16x16x32_bf16 v[184:187], v[216:219], v[76:79], v[184:187]
    buffer_load_dwordx4 v[128:131], v240, s[44:47], s29 offen offset:0
    ds_read_b64_tr_b16 v[216:217], v229 offset:12288
    ds_read_b64_tr_b16 v[218:219], v229 offset:12544
    s_waitcnt lgkmcnt(6)
    v_mfma_f32_16x16x32_bf16 v[192:195], v[220:223], v[72:75], v[192:195]
    v_mfma_f32_16x16x32_bf16 v[200:203], v[220:223], v[76:79], v[200:203]
    ds_read_b64_tr_b16 v[220:221], v229 offset:12800
    ds_read_b64_tr_b16 v[222:223], v229 offset:13056
    s_waitcnt lgkmcnt(6)
    v_mfma_f32_16x16x32_bf16 v[148:151], v[208:211], v[72:75], v[148:151]
    v_mfma_f32_16x16x32_bf16 v[156:159], v[208:211], v[76:79], v[156:159]
    ds_read_b64_tr_b16 v[208:209], v228 offset:16384
    ds_read_b64_tr_b16 v[210:211], v228 offset:16640
    s_waitcnt lgkmcnt(6)
    v_mfma_f32_16x16x32_bf16 v[164:167], v[212:215], v[72:75], v[164:167]
    v_mfma_f32_16x16x32_bf16 v[172:175], v[212:215], v[76:79], v[172:175]
    ds_read_b64_tr_b16 v[212:213], v228 offset:16896
    ds_read_b64_tr_b16 v[214:215], v228 offset:17152
    s_waitcnt lgkmcnt(6)
    v_mfma_f32_16x16x32_bf16 v[180:183], v[216:219], v[72:75], v[180:183]
    v_mfma_f32_16x16x32_bf16 v[188:191], v[216:219], v[76:79], v[188:191]
    buffer_load_dwordx4 v[132:135], v240, s[44:47], s29 offen offset:256
    ds_read_b64_tr_b16 v[216:217], v228 offset:24576
    ds_read_b64_tr_b16 v[218:219], v228 offset:24832
    s_waitcnt lgkmcnt(6)
    v_mfma_f32_16x16x32_bf16 v[196:199], v[220:223], v[72:75], v[196:199]
    v_mfma_f32_16x16x32_bf16 v[204:207], v[220:223], v[76:79], v[204:207]
    ds_read_b64_tr_b16 v[220:221], v228 offset:25088
    ds_read_b64_tr_b16 v[222:223], v228 offset:25344
    s_waitcnt lgkmcnt(6)
    v_mfma_f32_16x16x32_bf16 v[144:147], v[208:211], v[80:83], v[144:147]
    v_mfma_f32_16x16x32_bf16 v[152:155], v[208:211], v[84:87], v[152:155]
    ds_read_b64_tr_b16 v[208:209], v229 offset:16384
    ds_read_b64_tr_b16 v[210:211], v229 offset:16640
    s_waitcnt lgkmcnt(6)
    v_mfma_f32_16x16x32_bf16 v[160:163], v[212:215], v[80:83], v[160:163]
    v_mfma_f32_16x16x32_bf16 v[168:171], v[212:215], v[84:87], v[168:171]
    ds_read_b64_tr_b16 v[212:213], v229 offset:16896
    ds_read_b64_tr_b16 v[214:215], v229 offset:17152
    s_waitcnt lgkmcnt(6)
    v_mfma_f32_16x16x32_bf16 v[176:179], v[216:219], v[80:83], v[176:179]
    v_mfma_f32_16x16x32_bf16 v[184:187], v[216:219], v[84:87], v[184:187]
    buffer_load_dwordx4 v[136:139], v240, s[44:47], s29 offen offset:2048
    ds_read_b64_tr_b16 v[216:217], v229 offset:24576
    ds_read_b64_tr_b16 v[218:219], v229 offset:24832
    s_waitcnt lgkmcnt(6)
    v_mfma_f32_16x16x32_bf16 v[192:195], v[220:223], v[80:83], v[192:195]
    v_mfma_f32_16x16x32_bf16 v[200:203], v[220:223], v[84:87], v[200:203]
    ds_read_b64_tr_b16 v[220:221], v229 offset:25088
    ds_read_b64_tr_b16 v[222:223], v229 offset:25344
    s_waitcnt lgkmcnt(6)
    v_mfma_f32_16x16x32_bf16 v[148:151], v[208:211], v[80:83], v[148:151]
    v_mfma_f32_16x16x32_bf16 v[156:159], v[208:211], v[84:87], v[156:159]
    ds_read_b64_tr_b16 v[208:209], v228 offset:20480
    ds_read_b64_tr_b16 v[210:211], v228 offset:20736
    s_waitcnt lgkmcnt(6)
    v_mfma_f32_16x16x32_bf16 v[164:167], v[212:215], v[80:83], v[164:167]
    v_mfma_f32_16x16x32_bf16 v[172:175], v[212:215], v[84:87], v[172:175]
    ds_read_b64_tr_b16 v[212:213], v228 offset:20992
    ds_read_b64_tr_b16 v[214:215], v228 offset:21248
    s_waitcnt lgkmcnt(6)
    v_mfma_f32_16x16x32_bf16 v[180:183], v[216:219], v[80:83], v[180:183]
    v_mfma_f32_16x16x32_bf16 v[188:191], v[216:219], v[84:87], v[188:191]
    buffer_load_dwordx4 v[140:143], v240, s[44:47], s29 offen offset:2304
    s_add_u32 s29, s29, 4096
    ds_read_b64_tr_b16 v[216:217], v228 offset:28672
    ds_read_b64_tr_b16 v[218:219], v228 offset:28928
    s_waitcnt lgkmcnt(6)
    v_mfma_f32_16x16x32_bf16 v[196:199], v[220:223], v[80:83], v[196:199]
    v_mfma_f32_16x16x32_bf16 v[204:207], v[220:223], v[84:87], v[204:207]
    s_waitcnt vmcnt(10)
    s_barrier
    ds_read_b64_tr_b16 v[220:221], v228 offset:29184
    ds_read_b64_tr_b16 v[222:223], v228 offset:29440
    s_waitcnt lgkmcnt(6)
    v_mfma_f32_16x16x32_bf16 v[144:147], v[208:211], v[88:91], v[144:147]
    v_mfma_f32_16x16x32_bf16 v[152:155], v[208:211], v[92:95], v[152:155]
    ds_read_b64_tr_b16 v[208:209], v229 offset:20480
    ds_read_b64_tr_b16 v[210:211], v229 offset:20736
    s_waitcnt lgkmcnt(6)
    v_mfma_f32_16x16x32_bf16 v[160:163], v[212:215], v[88:91], v[160:163]
    v_mfma_f32_16x16x32_bf16 v[168:171], v[212:215], v[92:95], v[168:171]
    ds_read_b64_tr_b16 v[212:213], v229 offset:20992
    ds_read_b64_tr_b16 v[214:215], v229 offset:21248
    s_waitcnt lgkmcnt(6)
    v_mfma_f32_16x16x32_bf16 v[176:179], v[216:219], v[88:91], v[176:179]
    v_mfma_f32_16x16x32_bf16 v[184:187], v[216:219], v[92:95], v[184:187]
    s_add_u32 s25, s65, 0x80
    s_add_u32 m0, s24, 32768
    s_nop 0
    buffer_load_dwordx4 v232, s[32:35], s25 offen lds
    ds_read_b64_tr_b16 v[216:217], v229 offset:28672
    ds_read_b64_tr_b16 v[218:219], v229 offset:28928
    s_waitcnt lgkmcnt(6)
    v_mfma_f32_16x16x32_bf16 v[192:195], v[220:223], v[88:91], v[192:195]
    v_mfma_f32_16x16x32_bf16 v[200:203], v[220:223], v[92:95], v[200:203]
    ds_read_b64_tr_b16 v[220:221], v229 offset:29184
    ds_read_b64_tr_b16 v[222:223], v229 offset:29440
    s_waitcnt lgkmcnt(6)
    v_mfma_f32_16x16x32_bf16 v[148:151], v[208:211], v[88:91], v[148:151]
    v_mfma_f32_16x16x32_bf16 v[156:159], v[208:211], v[92:95], v[156:159]
    ds_read_b64_tr_b16 v[208:209], v228 offset:32768
    ds_read_b64_tr_b16 v[210:211], v228 offset:33024
    s_waitcnt lgkmcnt(6)
    v_mfma_f32_16x16x32_bf16 v[164:167], v[212:215], v[88:91], v[164:167]
    v_mfma_f32_16x16x32_bf16 v[172:175], v[212:215], v[92:95], v[172:175]
    s_add_u32 s25, s65, 0x80
    s_add_u32 m0, s24, 40960
    s_nop 0
    buffer_load_dwordx4 v232, s[36:39], s25 offen lds
    ds_read_b64_tr_b16 v[212:213], v228 offset:40960
    ds_read_b64_tr_b16 v[214:215], v228 offset:41216
    s_waitcnt lgkmcnt(6)
    v_mfma_f32_16x16x32_bf16 v[180:183], v[216:219], v[88:91], v[180:183]
    v_mfma_f32_16x16x32_bf16 v[188:191], v[216:219], v[92:95], v[188:191]
    ds_read_b64_tr_b16 v[216:217], v229 offset:32768
    ds_read_b64_tr_b16 v[218:219], v229 offset:33024
    s_waitcnt lgkmcnt(6)
    v_mfma_f32_16x16x32_bf16 v[196:199], v[220:223], v[88:91], v[196:199]
    v_mfma_f32_16x16x32_bf16 v[204:207], v[220:223], v[92:95], v[204:207]
    ds_read_b64_tr_b16 v[220:221], v229 offset:40960
    ds_read_b64_tr_b16 v[222:223], v229 offset:41216
    s_waitcnt lgkmcnt(6)
    v_mfma_f32_16x16x32_bf16 v[144:147], v[208:211], v[96:99], v[144:147]
    v_mfma_f32_16x16x32_bf16 v[152:155], v[208:211], v[100:103], v[152:155]
    s_add_u32 s25, s65, 0x90080
    s_add_u32 m0, s24, 49152
    s_nop 0
    buffer_load_dwordx4 v232, s[32:35], s25 offen lds
    ds_read_b64_tr_b16 v[208:209], v228 offset:36864
    ds_read_b64_tr_b16 v[210:211], v228 offset:37120
    s_waitcnt lgkmcnt(6)
    v_mfma_f32_16x16x32_bf16 v[176:179], v[212:215], v[96:99], v[176:179]
    v_mfma_f32_16x16x32_bf16 v[184:187], v[212:215], v[100:103], v[184:187]
    ds_read_b64_tr_b16 v[212:213], v228 offset:45056
    ds_read_b64_tr_b16 v[214:215], v228 offset:45312
    s_waitcnt lgkmcnt(6)
    v_mfma_f32_16x16x32_bf16 v[148:151], v[216:219], v[96:99], v[148:151]
    v_mfma_f32_16x16x32_bf16 v[156:159], v[216:219], v[100:103], v[156:159]
    ds_read_b64_tr_b16 v[216:217], v229 offset:36864
    ds_read_b64_tr_b16 v[218:219], v229 offset:37120
    s_waitcnt lgkmcnt(6)
    v_mfma_f32_16x16x32_bf16 v[180:183], v[220:223], v[96:99], v[180:183]
    v_mfma_f32_16x16x32_bf16 v[188:191], v[220:223], v[100:103], v[188:191]
    s_add_u32 s25, s65, 0x90080
    s_add_u32 m0, s24, 57344
    s_nop 0
    buffer_load_dwordx4 v232, s[36:39], s25 offen lds
    ds_read_b64_tr_b16 v[220:221], v229 offset:45056
    ds_read_b64_tr_b16 v[222:223], v229 offset:45312
    s_waitcnt lgkmcnt(6)
    v_mfma_f32_16x16x32_bf16 v[144:147], v[208:211], v[104:107], v[144:147]
    v_mfma_f32_16x16x32_bf16 v[152:155], v[208:211], v[108:111], v[152:155]
    v_xor_b32 v228, 0x10000, v228
    v_xor_b32 v229, 0x10000, v229
    v_xor_b32 v230, 0x10000, v230
    v_xor_b32 v231, 0x10000, v231
    v_xor_b32 v249, 0x10000, v249
    ds_read_b64_tr_b16 v[208:209], v228 offset:0
    ds_read_b64_tr_b16 v[210:211], v228 offset:256
    s_waitcnt lgkmcnt(6)
    v_mfma_f32_16x16x32_bf16 v[176:179], v[212:215], v[104:107], v[176:179]
    v_mfma_f32_16x16x32_bf16 v[184:187], v[212:215], v[108:111], v[184:187]
    ds_read_b64_tr_b16 v[212:213], v228 offset:8192
    ds_read_b64_tr_b16 v[214:215], v228 offset:8448
    s_waitcnt lgkmcnt(6)
    v_mfma_f32_16x16x32_bf16 v[148:151], v[216:219], v[104:107], v[148:151]
    v_mfma_f32_16x16x32_bf16 v[156:159], v[216:219], v[108:111], v[156:159]
    s_lshl_b32 s74, s22, 3
    s_add_u32 s74, s74, s3
    s_mul_i32 s74, s74, 82944
    s_add_u32 s74, s74, s65
    v_mul_u32_u24 v237, 0x240, v238
    s_mov_b64 exec, 0x1ff
    buffer_load_dword v224, v237, s[32:35], s74 offen offset:128
    buffer_load_dword v224, v237, s[36:39], s74 offen offset:128
    s_mov_b64 exec, -1
    ds_read_b64_tr_b16 v[216:217], v229 offset:0
    ds_read_b64_tr_b16 v[218:219], v229 offset:256
    s_waitcnt lgkmcnt(6)
    v_mfma_f32_16x16x32_bf16 v[180:183], v[220:223], v[104:107], v[180:183]
    v_mfma_f32_16x16x32_bf16 v[188:191], v[220:223], v[108:111], v[188:191]
    s_waitcnt vmcnt(10)
    s_barrier
    ds_read_b64_tr_b16 v[220:221], v229 offset:8192
    ds_read_b64_tr_b16 v[222:223], v229 offset:8448
    s_waitcnt lgkmcnt(6)
    v_mfma_f32_16x16x32_bf16 v[144:147], v[208:211], v[112:115], v[144:147]
    v_mfma_f32_16x16x32_bf16 v[152:155], v[208:211], v[116:119], v[152:155]
    ds_read_b64_tr_b16 v[208:209], v228 offset:4096
    ds_read_b64_tr_b16 v[210:211], v228 offset:4352
    s_waitcnt lgkmcnt(6)
    v_mfma_f32_16x16x32_bf16 v[176:179], v[212:215], v[112:115], v[176:179]
    v_mfma_f32_16x16x32_bf16 v[184:187], v[212:215], v[116:119], v[184:187]
    ds_read_b64_tr_b16 v[212:213], v228 offset:12288
    ds_read_b64_tr_b16 v[214:215], v228 offset:12544
    s_waitcnt lgkmcnt(6)
    v_mfma_f32_16x16x32_bf16 v[148:151], v[216:219], v[112:115], v[148:151]
    v_mfma_f32_16x16x32_bf16 v[156:159], v[216:219], v[116:119], v[156:159]
    s_add_u32 s25, s65, 0x120080
    s_add_u32 m0, s24, 65536
    s_nop 0
    buffer_load_dwordx4 v232, s[32:35], s25 offen lds
    ds_read_b64_tr_b16 v[216:217], v229 offset:4096
    ds_read_b64_tr_b16 v[218:219], v229 offset:4352
    s_waitcnt lgkmcnt(6)
    v_mfma_f32_16x16x32_bf16 v[180:183], v[220:223], v[112:115], v[180:183]
    v_mfma_f32_16x16x32_bf16 v[188:191], v[220:223], v[116:119], v[188:191]
    ds_read_b64_tr_b16 v[220:221], v229 offset:12288
    ds_read_b64_tr_b16 v[222:223], v229 offset:12544
    s_waitcnt lgkmcnt(6)
    v_mfma_f32_16x16x32_bf16 v[144:147], v[208:211], v[120:123], v[144:147]
    v_mfma_f32_16x16x32_bf16 v[152:155], v[208:211], v[124:127], v[152:155]
    ds_read_b64_tr_b16 v[208:209], v228 offset:16384
    ds_read_b64_tr_b16 v[210:211], v228 offset:16640
    s_waitcnt lgkmcnt(6)
    v_mfma_f32_16x16x32_bf16 v[176:179], v[212:215], v[120:123], v[176:179]
    v_mfma_f32_16x16x32_bf16 v[184:187], v[212:215], v[124:127], v[184:187]
    ds_read_b64_tr_b16 v[212:213], v228 offset:24576
    ds_read_b64_tr_b16 v[214:215], v228 offset:24832
    s_waitcnt lgkmcnt(6)
    v_mfma_f32_16x16x32_bf16 v[148:151], v[216:219], v[120:123], v[148:151]
    v_mfma_f32_16x16x32_bf16 v[156:159], v[216:219], v[124:127], v[156:159]
    s_add_u32 s25, s65, 0x120080
    s_add_u32 m0, s24, 73728
    s_nop 0
    buffer_load_dwordx4 v232, s[36:39], s25 offen lds
    ds_read_b64_tr_b16 v[216:217], v229 offset:16384
    ds_read_b64_tr_b16 v[218:219], v229 offset:16640
    s_waitcnt lgkmcnt(6)
    v_mfma_f32_16x16x32_bf16 v[180:183], v[220:223], v[120:123], v[180:183]
    v_mfma_f32_16x16x32_bf16 v[188:191], v[220:223], v[124:127], v[188:191]
    s_waitcnt vmcnt(8)
    ds_read_b64_tr_b16 v[220:221], v229 offset:24576
    ds_read_b64_tr_b16 v[222:223], v229 offset:24832
    s_waitcnt lgkmcnt(6)
    v_mfma_f32_16x16x32_bf16 v[144:147], v[208:211], v[128:131], v[144:147]
    v_mfma_f32_16x16x32_bf16 v[152:155], v[208:211], v[132:135], v[152:155]
    ds_read_b64_tr_b16 v[208:209], v228 offset:20480
    ds_read_b64_tr_b16 v[210:211], v228 offset:20736
    s_waitcnt lgkmcnt(6)
    v_mfma_f32_16x16x32_bf16 v[176:179], v[212:215], v[128:131], v[176:179]
    v_mfma_f32_16x16x32_bf16 v[184:187], v[212:215], v[132:135], v[184:187]
    ds_read_b64_tr_b16 v[212:213], v228 offset:28672
    ds_read_b64_tr_b16 v[214:215], v228 offset:28928
    s_waitcnt lgkmcnt(6)
    v_mfma_f32_16x16x32_bf16 v[148:151], v[216:219], v[128:131], v[148:151]
    v_mfma_f32_16x16x32_bf16 v[156:159], v[216:219], v[132:135], v[156:159]
    s_add_u32 s25, s65, 0x1b0080
    s_add_u32 m0, s24, 81920
    s_nop 0
    buffer_load_dwordx4 v232, s[32:35], s25 offen lds
    ds_read_b64_tr_b16 v[216:217], v229 offset:20480
    ds_read_b64_tr_b16 v[218:219], v229 offset:20736
    s_waitcnt lgkmcnt(6)
    v_mfma_f32_16x16x32_bf16 v[180:183], v[220:223], v[128:131], v[180:183]
    v_mfma_f32_16x16x32_bf16 v[188:191], v[220:223], v[132:135], v[188:191]
    ds_read_b64_tr_b16 v[220:221], v229 offset:28672
    ds_read_b64_tr_b16 v[222:223], v229 offset:28928
    s_waitcnt lgkmcnt(6)
    v_mfma_f32_16x16x32_bf16 v[144:147], v[208:211], v[136:139], v[144:147]
    v_mfma_f32_16x16x32_bf16 v[152:155], v[208:211], v[140:143], v[152:155]
    v_xor_b32 v228, 0x10000, v228
    v_xor_b32 v229, 0x10000, v229
    v_xor_b32 v230, 0x10000, v230
    v_xor_b32 v231, 0x10000, v231
    v_xor_b32 v249, 0x10000, v249
    ds_read_b64_tr_b16 v[208:209], v228 offset:33280
    ds_read_b64_tr_b16 v[210:211], v228 offset:33536
    s_waitcnt lgkmcnt(6)
    v_mfma_f32_16x16x32_bf16 v[176:179], v[212:215], v[136:139], v[176:179]
    v_mfma_f32_16x16x32_bf16 v[184:187], v[212:215], v[140:143], v[184:187]
    ds_read_b64_tr_b16 v[212:213], v228 offset:41472
    ds_read_b64_tr_b16 v[214:215], v228 offset:41728
    s_waitcnt lgkmcnt(6)
    v_mfma_f32_16x16x32_bf16 v[148:151], v[216:219], v[136:139], v[148:151]
    v_mfma_f32_16x16x32_bf16 v[156:159], v[216:219], v[140:143], v[156:159]
    s_add_u32 s25, s65, 0x1b0080
    s_add_u32 m0, s24, 90112
    s_nop 0
    buffer_load_dwordx4 v232, s[36:39], s25 offen lds
    ds_read_b64_tr_b16 v[216:217], v229 offset:33280
    ds_read_b64_tr_b16 v[218:219], v229 offset:33536
    s_waitcnt lgkmcnt(6)
    v_mfma_f32_16x16x32_bf16 v[180:183], v[220:223], v[136:139], v[180:183]
    v_mfma_f32_16x16x32_bf16 v[188:191], v[220:223], v[140:143], v[188:191]
    s_barrier
    ds_read_b64_tr_b16 v[220:221], v229 offset:41472
    ds_read_b64_tr_b16 v[222:223], v229 offset:41728
    s_waitcnt lgkmcnt(6)
    v_mfma_f32_16x16x32_bf16 v[160:163], v[208:211], v[96:99], v[160:163]
    v_mfma_f32_16x16x32_bf16 v[168:171], v[208:211], v[100:103], v[168:171]
    ds_read_b64_tr_b16 v[208:209], v228 offset:37376
    ds_read_b64_tr_b16 v[210:211], v228 offset:37632
    s_waitcnt lgkmcnt(6)
    v_mfma_f32_16x16x32_bf16 v[192:195], v[212:215], v[96:99], v[192:195]
    s_and_b32 s67, s23, 7
    s_lshl_b32 s67, s67, 11
    s_lshr_b32 s26, s23, 3
    s_mul_i32 s26, s26, 36864
    s_add_u32 s67, s67, s26
    s_mul_i32 s26, s28, 165888
    s_add_u32 s67, s67, s26
    s_add_u32 s98, s67, 165888
    v_mul_f32 v176, v144, v176
    v_mfma_f32_16x16x32_bf16 v[200:203], v[212:215], v[100:103], v[200:203]
    v_mul_f32 v144, s64, v144
    v_mul_f32 v177, v145, v177
    v_mul_f32 v145, s64, v145
    v_mul_f32 v178, v146, v178
    v_mul_f32 v146, s64, v146
    ds_read_b64_tr_b16 v[212:213], v228 offset:45568
    ds_read_b64_tr_b16 v[214:215], v228 offset:45824
    s_waitcnt lgkmcnt(6)
    v_mfma_f32_16x16x32_bf16 v[164:167], v[216:219], v[96:99], v[164:167]
    v_mul_f32 v179, v147, v179
    v_mul_f32 v147, s64, v147
    v_mfma_f32_16x16x32_bf16 v[172:175], v[216:219], v[100:103], v[172:175]
    v_mul_f32 v180, v148, v180
    v_mul_f32 v148, s64, v148
    v_mul_f32 v181, v149, v181
    v_mul_f32 v149, s64, v149
    v_mul_f32 v182, v150, v182
    ds_read_b64_tr_b16 v[216:217], v229 offset:37376
    ds_read_b64_tr_b16 v[218:219], v229 offset:37632
    s_waitcnt lgkmcnt(6)
    v_mfma_f32_16x16x32_bf16 v[196:199], v[220:223], v[96:99], v[196:199]
    v_mul_f32 v150, s64, v150
    v_mul_f32 v183, v151, v183
    v_mfma_f32_16x16x32_bf16 v[204:207], v[220:223], v[100:103], v[204:207]
    v_mul_f32 v151, s64, v151
    v_exp_f32 v144, v144
    v_exp_f32 v145, v145
    v_add_f32 v144, 1.0, v144
    v_exp_f32 v146, v146
    ds_read_b64_tr_b16 v[220:221], v229 offset:45568
    ds_read_b64_tr_b16 v[222:223], v229 offset:45824
    s_waitcnt lgkmcnt(6)
    v_mfma_f32_16x16x32_bf16 v[160:163], v[208:211], v[104:107], v[160:163]
    v_add_f32 v145, 1.0, v145
    v_exp_f32 v147, v147
    v_mfma_f32_16x16x32_bf16 v[168:171], v[208:211], v[108:111], v[168:171]
    v_add_f32 v146, 1.0, v146
    v_exp_f32 v148, v148
    v_add_f32 v147, 1.0, v147
    v_exp_f32 v149, v149
    v_add_f32 v148, 1.0, v148
    v_xor_b32 v228, 0x10000, v228
    v_xor_b32 v229, 0x10000, v229
    v_xor_b32 v230, 0x10000, v230
    v_xor_b32 v231, 0x10000, v231
    v_xor_b32 v249, 0x10000, v249
    ds_read_b64_tr_b16 v[208:209], v228 offset:512
    ds_read_b64_tr_b16 v[210:211], v228 offset:768
    s_waitcnt lgkmcnt(6)
    v_mfma_f32_16x16x32_bf16 v[192:195], v[212:215], v[104:107], v[192:195]
    v_exp_f32 v150, v150
    v_add_f32 v149, 1.0, v149
    v_mfma_f32_16x16x32_bf16 v[200:203], v[212:215], v[108:111], v[200:203]
    s_cmp_ge_u32 s3, 6
    s_cbranch_scc1 RLD_0_0
    s_lshl_b32 s25, s3, 12
    s_add_u32 m0, s25, 114688
    s_nop 0
    buffer_load_dwordx4 v255, s[92:95], s79 offen lds
RLD_0_0:
    s_add_u32 s79, s79, s96
    v_exp_f32 v151, v151
    v_add_f32 v150, 1.0, v150
    v_add_f32 v151, 1.0, v151
    v_rcp_f32 v144, v144
    v_rcp_f32 v145, v145
    ds_read_b64_tr_b16 v[212:213], v228 offset:8704
    ds_read_b64_tr_b16 v[214:215], v228 offset:8960
    s_waitcnt lgkmcnt(6)
    v_mfma_f32_16x16x32_bf16 v[164:167], v[216:219], v[104:107], v[164:167]
    v_mul_f32 v176, v176, v144
    v_rcp_f32 v146, v146
    v_mfma_f32_16x16x32_bf16 v[172:175], v[216:219], v[108:111], v[172:175]
    v_mul_f32 v177, v177, v145
    v_rcp_f32 v147, v147
    v_mul_f32 v178, v178, v146
    v_rcp_f32 v148, v148
    v_mul_f32 v179, v179, v147
    ds_read_b64_tr_b16 v[216:217], v229 offset:512
    ds_read_b64_tr_b16 v[218:219], v229 offset:768
    s_waitcnt lgkmcnt(6)
    v_mfma_f32_16x16x32_bf16 v[196:199], v[220:223], v[104:107], v[196:199]
    v_rcp_f32 v149, v149
    v_mul_f32 v180, v180, v148
    v_mfma_f32_16x16x32_bf16 v[204:207], v[220:223], v[108:111], v[204:207]
    v_rcp_f32 v150, v150
    v_mul_f32 v181, v181, v149
    v_rcp_f32 v151, v151
    v_mul_f32 v182, v182, v150
    ds_read_b64_tr_b16 v[220:221], v229 offset:8704
    ds_read_b64_tr_b16 v[222:223], v229 offset:8960
    s_waitcnt lgkmcnt(6)
    v_mfma_f32_16x16x32_bf16 v[160:163], v[208:211], v[112:115], v[160:163]
    v_mul_f32 v183, v183, v151
    v_cvt_pk_bf16_f32 v144, v176, v177
    v_mfma_f32_16x16x32_bf16 v[168:171], v[208:211], v[116:119], v[168:171]
    v_cvt_pk_bf16_f32 v145, v178, v179
    v_cvt_pk_bf16_f32 v146, v180, v181
    v_cvt_pk_bf16_f32 v147, v182, v183
    buffer_store_dwordx4 v[144:147], v238, s[48:51], s67 offen offset:0 sc1
    ds_read_b64_tr_b16 v[208:209], v228 offset:4608
    ds_read_b64_tr_b16 v[210:211], v228 offset:4864
    s_waitcnt lgkmcnt(6)
    v_mfma_f32_16x16x32_bf16 v[192:195], v[212:215], v[112:115], v[192:195]
    v_mul_f32 v184, v152, v184
    v_mul_f32 v152, s64, v152
    v_mfma_f32_16x16x32_bf16 v[200:203], v[212:215], v[116:119], v[200:203]
    v_mul_f32 v185, v153, v185
    v_mul_f32 v153, s64, v153
    v_mul_f32 v186, v154, v186
    v_mul_f32 v154, s64, v154
    ds_read_b64_tr_b16 v[212:213], v228 offset:12800
    ds_read_b64_tr_b16 v[214:215], v228 offset:13056
    s_waitcnt lgkmcnt(6)
    v_mfma_f32_16x16x32_bf16 v[164:167], v[216:219], v[112:115], v[164:167]
    v_mul_f32 v187, v155, v187
    v_mul_f32 v155, s64, v155
    v_mfma_f32_16x16x32_bf16 v[172:175], v[216:219], v[116:119], v[172:175]
    v_mul_f32 v188, v156, v188
    v_mul_f32 v156, s64, v156
    v_mul_f32 v189, v157, v189
    v_mul_f32 v157, s64, v157
    ds_read_b64_tr_b16 v[216:217], v229 offset:4608
    ds_read_b64_tr_b16 v[218:219], v229 offset:4864
    s_waitcnt lgkmcnt(6)
    v_mfma_f32_16x16x32_bf16 v[196:199], v[220:223], v[112:115], v[196:199]
    v_mul_f32 v190, v158, v190
    v_mul_f32 v158, s64, v158
    v_mfma_f32_16x16x32_bf16 v[204:207], v[220:223], v[116:119], v[204:207]
    v_mul_f32 v191, v159, v191
    v_mul_f32 v159, s64, v159
    v_exp_f32 v152, v152
    v_exp_f32 v153, v153
    ds_read_b64_tr_b16 v[220:221], v229 offset:12800
    ds_read_b64_tr_b16 v[222:223], v229 offset:13056
    s_waitcnt lgkmcnt(6)
    v_mfma_f32_16x16x32_bf16 v[160:163], v[208:211], v[120:123], v[160:163]
    v_add_f32 v152, 1.0, v152
    v_exp_f32 v154, v154
    v_mfma_f32_16x16x32_bf16 v[168:171], v[208:211], v[124:127], v[168:171]
    v_add_f32 v153, 1.0, v153
    v_exp_f32 v155, v155
    v_add_f32 v154, 1.0, v154
    ds_read_b64_tr_b16 v[208:209], v228 offset:16896
    ds_read_b64_tr_b16 v[210:211], v228 offset:17152
    s_waitcnt lgkmcnt(6)
    v_mfma_f32_16x16x32_bf16 v[192:195], v[212:215], v[120:123], v[192:195]
    v_exp_f32 v156, v156
    v_add_f32 v155, 1.0, v155
    v_mfma_f32_16x16x32_bf16 v[200:203], v[212:215], v[124:127], v[200:203]
    s_cmp_ge_u32 s3, 6
    s_cbranch_scc1 RLD_0_1
    s_lshl_b32 s25, s3, 12
    s_add_u32 m0, s25, 115712
    s_nop 0
    buffer_load_dwordx4 v255, s[92:95], s79 offen lds
RLD_0_1:
    s_add_u32 s79, s79, s97
    v_exp_f32 v157, v157
    v_add_f32 v156, 1.0, v156
    v_exp_f32 v158, v158
    ds_read_b64_tr_b16 v[212:213], v228 offset:25088
    ds_read_b64_tr_b16 v[214:215], v228 offset:25344
    s_waitcnt lgkmcnt(6)
    v_mfma_f32_16x16x32_bf16 v[164:167], v[216:219], v[120:123], v[164:167]
    v_add_f32 v157, 1.0, v157
    v_exp_f32 v159, v159
    v_mfma_f32_16x16x32_bf16 v[172:175], v[216:219], v[124:127], v[172:175]
    v_add_f32 v158, 1.0, v158
    v_add_f32 v159, 1.0, v159
    v_rcp_f32 v152, v152
    ds_read_b64_tr_b16 v[216:217], v229 offset:16896
    ds_read_b64_tr_b16 v[218:219], v229 offset:17152
    s_waitcnt lgkmcnt(6)
    v_mfma_f32_16x16x32_bf16 v[196:199], v[220:223], v[120:123], v[196:199]
    v_rcp_f32 v153, v153
    v_mul_f32 v184, v184, v152
    v_mfma_f32_16x16x32_bf16 v[204:207], v[220:223], v[124:127], v[204:207]
    v_rcp_f32 v154, v154
    v_mul_f32 v185, v185, v153
    v_rcp_f32 v155, v155
    s_waitcnt vmcnt(7)
    s_barrier
    ds_read_b64_tr_b16 v[220:221], v229 offset:25088
    ds_read_b64_tr_b16 v[222:223], v229 offset:25344
    s_waitcnt lgkmcnt(6)
    v_mfma_f32_16x16x32_bf16 v[160:163], v[208:211], v[128:131], v[160:163]
    v_mul_f32 v186, v186, v154
    v_rcp_f32 v156, v156
    v_mfma_f32_16x16x32_bf16 v[168:171], v[208:211], v[132:135], v[168:171]
    v_mul_f32 v187, v187, v155
    v_rcp_f32 v157, v157
    ds_read_b64_tr_b16 v[208:209], v228 offset:20992
    ds_read_b64_tr_b16 v[210:211], v228 offset:21248
    s_waitcnt lgkmcnt(6)
    v_mfma_f32_16x16x32_bf16 v[192:195], v[212:215], v[128:131], v[192:195]
    v_mul_f32 v188, v188, v156
    v_rcp_f32 v158, v158
    v_mfma_f32_16x16x32_bf16 v[200:203], v[212:215], v[132:135], v[200:203]
    s_add_u32 s25, s65, 0x240080
    s_add_u32 m0, s24, 98304
    s_nop 0
    buffer_load_dwordx4 v232, s[32:35], s25 offen lds
    v_mul_f32 v189, v189, v157
    v_rcp_f32 v159, v159
    ds_read_b64_tr_b16 v[212:213], v228 offset:29184
    ds_read_b64_tr_b16 v[214:215], v228 offset:29440
    s_waitcnt lgkmcnt(6)
    v_mfma_f32_16x16x32_bf16 v[164:167], v[216:219], v[128:131], v[164:167]
    v_mul_f32 v190, v190, v158
    v_mul_f32 v191, v191, v159
    v_mfma_f32_16x16x32_bf16 v[172:175], v[216:219], v[132:135], v[172:175]
    v_cvt_pk_bf16_f32 v152, v184, v185
    ds_read_b64_tr_b16 v[216:217], v229 offset:20992
    ds_read_b64_tr_b16 v[218:219], v229 offset:21248
    s_waitcnt lgkmcnt(6)
    v_mfma_f32_16x16x32_bf16 v[196:199], v[220:223], v[128:131], v[196:199]
    v_cvt_pk_bf16_f32 v153, v186, v187
    v_cvt_pk_bf16_f32 v154, v188, v189
    v_mfma_f32_16x16x32_bf16 v[204:207], v[220:223], v[132:135], v[204:207]
    v_cvt_pk_bf16_f32 v155, v190, v191
    ds_read_b64_tr_b16 v[220:221], v229 offset:29184
    ds_read_b64_tr_b16 v[222:223], v229 offset:29440
    s_waitcnt lgkmcnt(6)
    v_mfma_f32_16x16x32_bf16 v[160:163], v[208:211], v[136:139], v[160:163]
    buffer_store_dwordx4 v[152:155], v238, s[48:51], s98 offen offset:0 sc1
    v_mfma_f32_16x16x32_bf16 v[168:171], v[208:211], v[140:143], v[168:171]
    s_add_u32 s25, s65, 0x240080
    s_add_u32 m0, s24, 106496
    s_nop 0
    buffer_load_dwordx4 v232, s[36:39], s25 offen lds
    ds_read_b64_tr_b16 v[208:209], v228 offset:32768
    ds_read_b64_tr_b16 v[210:211], v228 offset:33024
    s_waitcnt lgkmcnt(6)
    v_mfma_f32_16x16x32_bf16 v[192:195], v[212:215], v[136:139], v[192:195]
    v_mfma_f32_16x16x32_bf16 v[200:203], v[212:215], v[140:143], v[200:203]
    ds_read_b64_tr_b16 v[212:213], v228 offset:40960
    ds_read_b64_tr_b16 v[214:215], v228 offset:41216
    s_waitcnt lgkmcnt(6)
    v_mfma_f32_16x16x32_bf16 v[164:167], v[216:219], v[136:139], v[164:167]
    v_mfma_f32_16x16x32_bf16 v[172:175], v[216:219], v[140:143], v[172:175]
    s_add_u32 s25, s65, 0x2d0080
    s_add_u32 m0, s24, 0
    s_nop 0
    buffer_load_dwordx4 v232, s[32:35], s25 offen lds
    ds_read_b64_tr_b16 v[216:217], v229 offset:32768
    ds_read_b64_tr_b16 v[218:219], v229 offset:33024
    s_waitcnt lgkmcnt(6)
    v_mfma_f32_16x16x32_bf16 v[196:199], v[220:223], v[136:139], v[196:199]
    v_mfma_f32_16x16x32_bf16 v[204:207], v[220:223], v[140:143], v[204:207]
    ds_read_b64_tr_b16 v[220:221], v229 offset:40960
    ds_read_b64_tr_b16 v[222:223], v229 offset:41216
    s_waitcnt lgkmcnt(6)
    v_mfma_f32_16x16x32_bf16 v[144:147], v[208:211], v[0:3], 0
    v_mfma_f32_16x16x32_bf16 v[152:155], v[208:211], v[4:7], 0
    ds_read_b64_tr_b16 v[208:209], v228 offset:36864
    ds_read_b64_tr_b16 v[210:211], v228 offset:37120
    s_waitcnt lgkmcnt(6)
    v_mfma_f32_16x16x32_bf16 v[176:179], v[212:215], v[0:3], 0
    v_mul_f32 v192, v160, v192
    v_mul_f32 v160, s64, v160
    v_mfma_f32_16x16x32_bf16 v[184:187], v[212:215], v[4:7], 0
    s_add_u32 s25, s65, 0x2d0080
    s_add_u32 m0, s24, 8192
    s_nop 0
    buffer_load_dwordx4 v232, s[36:39], s25 offen lds
    v_mul_f32 v193, v161, v193
    v_mul_f32 v161, s64, v161
    v_mul_f32 v194, v162, v194
    v_mul_f32 v162, s64, v162
    v_mul_f32 v195, v163, v195
    ds_read_b64_tr_b16 v[212:213], v228 offset:45056
    ds_read_b64_tr_b16 v[214:215], v228 offset:45312
    s_waitcnt lgkmcnt(6)
    v_mfma_f32_16x16x32_bf16 v[148:151], v[216:219], v[0:3], 0
    v_mul_f32 v163, s64, v163
    v_mul_f32 v196, v164, v196
    v_mfma_f32_16x16x32_bf16 v[156:159], v[216:219], v[4:7], 0
    v_mul_f32 v164, s64, v164
    v_mul_f32 v197, v165, v197
    v_mul_f32 v165, s64, v165
    v_mul_f32 v198, v166, v198
    v_mul_f32 v166, s64, v166
    ds_read_b64_tr_b16 v[216:217], v229 offset:36864
    ds_read_b64_tr_b16 v[218:219], v229 offset:37120
    s_waitcnt lgkmcnt(6)
    v_mfma_f32_16x16x32_bf16 v[180:183], v[220:223], v[0:3], 0
    v_mul_f32 v199, v167, v199
    v_mul_f32 v167, s64, v167
    v_mfma_f32_16x16x32_bf16 v[188:191], v[220:223], v[4:7], 0
    s_cmp_ge_u32 s3, 6
    s_cbranch_scc1 RLD_1_0
    s_lshl_b32 s25, s3, 12
    s_add_u32 m0, s25, 116736
    s_nop 0
    buffer_load_dwordx4 v255, s[92:95], s79 offen lds
RLD_1_0:
    s_add_u32 s79, s79, s96
    v_exp_f32 v160, v160
    v_exp_f32 v161, v161
    v_add_f32 v160, 1.0, v160
    v_exp_f32 v162, v162
    v_add_f32 v161, 1.0, v161
    ds_read_b64_tr_b16 v[220:221], v229 offset:45056
    ds_read_b64_tr_b16 v[222:223], v229 offset:45312
    s_waitcnt lgkmcnt(6)
    v_mfma_f32_16x16x32_bf16 v[144:147], v[208:211], v[8:11], v[144:147]
    v_exp_f32 v163, v163
    v_add_f32 v162, 1.0, v162
    v_mfma_f32_16x16x32_bf16 v[152:155], v[208:211], v[12:15], v[152:155]
    v_exp_f32 v164, v164
    v_add_f32 v163, 1.0, v163
    v_exp_f32 v165, v165
    v_add_f32 v164, 1.0, v164
    v_exp_f32 v166, v166
    ds_read_b64_tr_b16 v[208:209], v228 offset:49152
    ds_read_b64_tr_b16 v[210:211], v228 offset:49408
    s_waitcnt lgkmcnt(6)
    v_mfma_f32_16x16x32_bf16 v[176:179], v[212:215], v[8:11], v[176:179]
    v_add_f32 v165, 1.0, v165
    v_exp_f32 v167, v167
    v_mfma_f32_16x16x32_bf16 v[184:187], v[212:215], v[12:15], v[184:187]
    v_add_f32 v166, 1.0, v166
    v_add_f32 v167, 1.0, v167
    v_rcp_f32 v160, v160
    v_rcp_f32 v161, v161
    v_mul_f32 v192, v192, v160
    ds_read_b64_tr_b16 v[212:213], v228 offset:57344
    ds_read_b64_tr_b16 v[214:215], v228 offset:57600
    s_waitcnt lgkmcnt(6)
    v_mfma_f32_16x16x32_bf16 v[148:151], v[216:219], v[8:11], v[148:151]
    v_rcp_f32 v162, v162
    v_mul_f32 v193, v193, v161
    v_mfma_f32_16x16x32_bf16 v[156:159], v[216:219], v[12:15], v[156:159]
    s_cmp_ge_u32 s3, 6
    s_cbranch_scc1 RLD_1_1
    s_lshl_b32 s25, s3, 12
    s_add_u32 m0, s25, 117760
    s_nop 0
    buffer_load_dwordx4 v255, s[92:95], s79 offen lds
RLD_1_1:
    s_add_u32 s79, s79, s97
    v_rcp_f32 v163, v163
    v_mul_f32 v194, v194, v162
    v_rcp_f32 v164, v164
    v_mul_f32 v195, v195, v163
    v_rcp_f32 v165, v165
    ds_read_b64_tr_b16 v[216:217], v229 offset:49152
    ds_read_b64_tr_b16 v[218:219], v229 offset:49408
    s_waitcnt lgkmcnt(6)
    v_mfma_f32_16x16x32_bf16 v[180:183], v[220:223], v[8:11], v[180:183]
    v_mul_f32 v196, v196, v164
    v_rcp_f32 v166, v166
    v_mfma_f32_16x16x32_bf16 v[188:191], v[220:223], v[12:15], v[188:191]
    v_mul_f32 v197, v197, v165
    v_rcp_f32 v167, v167
    v_mul_f32 v198, v198, v166
    v_mul_f32 v199, v199, v167
    s_waitcnt vmcnt(8)
    s_barrier
    ds_read_b64_tr_b16 v[220:221], v229 offset:57344
    ds_read_b64_tr_b16 v[222:223], v229 offset:57600
    s_waitcnt lgkmcnt(6)
    v_mfma_f32_16x16x32_bf16 v[144:147], v[208:211], v[16:19], v[144:147]
    v_cvt_pk_bf16_f32 v160, v192, v193
    v_cvt_pk_bf16_f32 v161, v194, v195
    v_mfma_f32_16x16x32_bf16 v[152:155], v[208:211], v[20:23], v[152:155]
    v_cvt_pk_bf16_f32 v162, v196, v197
    v_cvt_pk_bf16_f32 v163, v198, v199
    buffer_store_dwordx4 v[160:163], v238, s[48:51], s67 offen offset:1024 sc1
    v_mul_f32 v200, v168, v200
    ds_read_b64_tr_b16 v[208:209], v228 offset:53248
    ds_read_b64_tr_b16 v[210:211], v228 offset:53504
    s_waitcnt lgkmcnt(6)
    v_mfma_f32_16x16x32_bf16 v[176:179], v[212:215], v[16:19], v[176:179]
    v_mul_f32 v168, s64, v168
    v_mul_f32 v201, v169, v201
    v_mfma_f32_16x16x32_bf16 v[184:187], v[212:215], v[20:23], v[184:187]
    v_mul_f32 v169, s64, v169
    v_mul_f32 v202, v170, v202
    v_mul_f32 v170, s64, v170
    v_mul_f32 v203, v171, v203
    ds_read_b64_tr_b16 v[212:213], v228 offset:61440
    ds_read_b64_tr_b16 v[214:215], v228 offset:61696
    s_waitcnt lgkmcnt(6)
    v_mfma_f32_16x16x32_bf16 v[148:151], v[216:219], v[16:19], v[148:151]
    v_mul_f32 v171, s64, v171
    v_mul_f32 v204, v172, v204
    v_mfma_f32_16x16x32_bf16 v[156:159], v[216:219], v[20:23], v[156:159]
    v_mul_f32 v172, s64, v172
    v_mul_f32 v205, v173, v205
    v_mul_f32 v173, s64, v173
    v_mul_f32 v206, v174, v206
    ds_read_b64_tr_b16 v[216:217], v229 offset:53248
    ds_read_b64_tr_b16 v[218:219], v229 offset:53504
    s_waitcnt lgkmcnt(6)
    v_mfma_f32_16x16x32_bf16 v[180:183], v[220:223], v[16:19], v[180:183]
    v_mul_f32 v174, s64, v174
    v_mul_f32 v207, v175, v207
    v_mfma_f32_16x16x32_bf16 v[188:191], v[220:223], v[20:23], v[188:191]
    v_mul_f32 v175, s64, v175
    v_exp_f32 v168, v168
    v_exp_f32 v169, v169
    v_add_f32 v168, 1.0, v168
    ds_read_b64_tr_b16 v[220:221], v229 offset:61440
    ds_read_b64_tr_b16 v[222:223], v229 offset:61696
    s_waitcnt lgkmcnt(6)
    v_mfma_f32_16x16x32_bf16 v[144:147], v[208:211], v[24:27], v[144:147]
    v_exp_f32 v170, v170
    v_add_f32 v169, 1.0, v169
    v_mfma_f32_16x16x32_bf16 v[152:155], v[208:211], v[28:31], v[152:155]
    v_exp_f32 v171, v171
    v_add_f32 v170, 1.0, v170
    v_exp_f32 v172, v172
    v_xor_b32 v228, 0x10000, v228
    v_xor_b32 v229, 0x10000, v229
    v_xor_b32 v230, 0x10000, v230
    v_xor_b32 v231, 0x10000, v231
    v_xor_b32 v249, 0x10000, v249
    ds_read_b64_tr_b16 v[208:209], v228 offset:0
    ds_read_b64_tr_b16 v[210:211], v228 offset:256
    s_waitcnt lgkmcnt(6)
    v_mfma_f32_16x16x32_bf16 v[176:179], v[212:215], v[24:27], v[176:179]
    v_add_f32 v171, 1.0, v171
    v_exp_f32 v173, v173
    v_mfma_f32_16x16x32_bf16 v[184:187], v[212:215], v[28:31], v[184:187]
    s_add_u32 s25, s65, 0x360080
    s_add_u32 m0, s24, 16384
    s_nop 0
    buffer_load_dwordx4 v232, s[32:35], s25 offen lds
    v_add_f32 v172, 1.0, v172
    v_exp_f32 v174, v174
    v_add_f32 v173, 1.0, v173
    ds_read_b64_tr_b16 v[212:213], v228 offset:8192
    ds_read_b64_tr_b16 v[214:215], v228 offset:8448
    s_waitcnt lgkmcnt(6)
    v_mfma_f32_16x16x32_bf16 v[148:151], v[216:219], v[24:27], v[148:151]
    v_exp_f32 v175, v175
    v_add_f32 v174, 1.0, v174
    v_mfma_f32_16x16x32_bf16 v[156:159], v[216:219], v[28:31], v[156:159]
    v_add_f32 v175, 1.0, v175
    v_rcp_f32 v168, v168
    v_rcp_f32 v169, v169
    ds_read_b64_tr_b16 v[216:217], v229 offset:0
    ds_read_b64_tr_b16 v[218:219], v229 offset:256
    s_waitcnt lgkmcnt(6)
    v_mfma_f32_16x16x32_bf16 v[180:183], v[220:223], v[24:27], v[180:183]
    v_mul_f32 v200, v200, v168
    v_rcp_f32 v170, v170
    v_mfma_f32_16x16x32_bf16 v[188:191], v[220:223], v[28:31], v[188:191]
    v_mul_f32 v201, v201, v169
    v_rcp_f32 v171, v171
    v_mul_f32 v202, v202, v170
    ds_read_b64_tr_b16 v[220:221], v229 offset:8192
    ds_read_b64_tr_b16 v[222:223], v229 offset:8448
    s_waitcnt lgkmcnt(6)
    v_mfma_f32_16x16x32_bf16 v[144:147], v[208:211], v[32:35], v[144:147]
    v_rcp_f32 v172, v172
    v_mul_f32 v203, v203, v171
    v_mfma_f32_16x16x32_bf16 v[152:155], v[208:211], v[36:39], v[152:155]
    v_rcp_f32 v173, v173
    v_mul_f32 v204, v204, v172
    ds_read_b64_tr_b16 v[208:209], v228 offset:4096
    ds_read_b64_tr_b16 v[210:211], v228 offset:4352
    s_waitcnt lgkmcnt(6)
    v_mfma_f32_16x16x32_bf16 v[176:179], v[212:215], v[32:35], v[176:179]
    v_rcp_f32 v174, v174
    v_mul_f32 v205, v205, v173
    v_mfma_f32_16x16x32_bf16 v[184:187], v[212:215], v[36:39], v[184:187]
    v_rcp_f32 v175, v175
    v_mul_f32 v206, v206, v174
    ds_read_b64_tr_b16 v[212:213], v228 offset:12288
    ds_read_b64_tr_b16 v[214:215], v228 offset:12544
    s_waitcnt lgkmcnt(6)
    v_mfma_f32_16x16x32_bf16 v[148:151], v[216:219], v[32:35], v[148:151]
    v_mul_f32 v207, v207, v175
    v_cvt_pk_bf16_f32 v168, v200, v201
    v_mfma_f32_16x16x32_bf16 v[156:159], v[216:219], v[36:39], v[156:159]
    v_cvt_pk_bf16_f32 v169, v202, v203
    ds_read_b64_tr_b16 v[216:217], v229 offset:4096
    ds_read_b64_tr_b16 v[218:219], v229 offset:4352
    s_waitcnt lgkmcnt(6)
    v_mfma_f32_16x16x32_bf16 v[180:183], v[220:223], v[32:35], v[180:183]
    v_cvt_pk_bf16_f32 v170, v204, v205
    v_cvt_pk_bf16_f32 v171, v206, v207
    v_mfma_f32_16x16x32_bf16 v[188:191], v[220:223], v[36:39], v[188:191]
    buffer_store_dwordx4 v[168:171], v238, s[48:51], s98 offen offset:1024 sc1
    ds_read_b64_tr_b16 v[220:221], v229 offset:12288
    ds_read_b64_tr_b16 v[222:223], v229 offset:12544
    s_waitcnt lgkmcnt(6)
    v_mfma_f32_16x16x32_bf16 v[144:147], v[208:211], v[40:43], v[144:147]
    v_mfma_f32_16x16x32_bf16 v[152:155], v[208:211], v[44:47], v[152:155]
    v_xor_b32 v228, 0x10000, v228
    v_xor_b32 v229, 0x10000, v229
    v_xor_b32 v230, 0x10000, v230
    v_xor_b32 v231, 0x10000, v231
    v_xor_b32 v249, 0x10000, v249
    ds_read_b64_tr_b16 v[208:209], v228 offset:33280
    ds_read_b64_tr_b16 v[210:211], v228 offset:33536
    s_waitcnt lgkmcnt(6)
    v_mfma_f32_16x16x32_bf16 v[176:179], v[212:215], v[40:43], v[176:179]
    v_mfma_f32_16x16x32_bf16 v[184:187], v[212:215], v[44:47], v[184:187]
    s_add_u32 s25, s65, 0x360080
    s_add_u32 m0, s24, 24576
    s_nop 0
    buffer_load_dwordx4 v232, s[36:39], s25 offen lds
    ds_read_b64_tr_b16 v[212:213], v228 offset:41472
    ds_read_b64_tr_b16 v[214:215], v228 offset:41728
    s_waitcnt lgkmcnt(6)
    v_mfma_f32_16x16x32_bf16 v[148:151], v[216:219], v[40:43], v[148:151]
    v_mfma_f32_16x16x32_bf16 v[156:159], v[216:219], v[44:47], v[156:159]
    ds_read_b64_tr_b16 v[216:217], v229 offset:33280
    ds_read_b64_tr_b16 v[218:219], v229 offset:33536
    s_waitcnt lgkmcnt(6)
    v_mfma_f32_16x16x32_bf16 v[180:183], v[220:223], v[40:43], v[180:183]
    v_mfma_f32_16x16x32_bf16 v[188:191], v[220:223], v[44:47], v[188:191]
    s_barrier
    ds_read_b64_tr_b16 v[220:221], v229 offset:41472
    ds_read_b64_tr_b16 v[222:223], v229 offset:41728
    s_waitcnt lgkmcnt(6)
    v_mfma_f32_16x16x32_bf16 v[160:163], v[208:211], v[0:3], 0
    v_mfma_f32_16x16x32_bf16 v[168:171], v[208:211], v[4:7], 0
    ds_read_b64_tr_b16 v[208:209], v228 offset:37376
    ds_read_b64_tr_b16 v[210:211], v228 offset:37632
    s_waitcnt lgkmcnt(6)
    v_mfma_f32_16x16x32_bf16 v[192:195], v[212:215], v[0:3], 0
    v_mfma_f32_16x16x32_bf16 v[200:203], v[212:215], v[4:7], 0
    ds_read_b64_tr_b16 v[212:213], v228 offset:45568
    ds_read_b64_tr_b16 v[214:215], v228 offset:45824
    s_waitcnt lgkmcnt(6)
    v_mfma_f32_16x16x32_bf16 v[164:167], v[216:219], v[0:3], 0
    v_mfma_f32_16x16x32_bf16 v[172:175], v[216:219], v[4:7], 0
    ds_read_b64_tr_b16 v[216:217], v229 offset:37376
    ds_read_b64_tr_b16 v[218:219], v229 offset:37632
    s_waitcnt lgkmcnt(6)
    v_mfma_f32_16x16x32_bf16 v[196:199], v[220:223], v[0:3], 0
    v_mfma_f32_16x16x32_bf16 v[204:207], v[220:223], v[4:7], 0
    ds_read_b64_tr_b16 v[220:221], v229 offset:45568
    ds_read_b64_tr_b16 v[222:223], v229 offset:45824
    s_waitcnt lgkmcnt(6)
    v_mfma_f32_16x16x32_bf16 v[160:163], v[208:211], v[8:11], v[160:163]
    v_permlane16_swap_b32 v0, v4
    v_mfma_f32_16x16x32_bf16 v[168:171], v[208:211], v[12:15], v[168:171]
    ds_read_b64_tr_b16 v[208:209], v228 offset:49664
    ds_read_b64_tr_b16 v[210:211], v228 offset:49920
    s_waitcnt lgkmcnt(6)
    v_mfma_f32_16x16x32_bf16 v[192:195], v[212:215], v[8:11], v[192:195]
    v_permlane16_swap_b32 v1, v5
    v_mfma_f32_16x16x32_bf16 v[200:203], v[212:215], v[12:15], v[200:203]
    s_lshr_b32 s74, s2, 3
    s_lshl_b32 s74, s74, 3
    s_add_u32 s74, s74, s3
    s_mul_i32 s74, s74, 3
    v_mul_u32_u24 v237, 0x240, v238
    s_mul_i32 s75, s20, 1152
    s_mul_i32 s25, s74, 9216
    s_add_u32 s25, s25, s75
    s_mov_b64 exec, 7
    buffer_load_dword v224, v237, s[32:35], s25 offen offset:1024
    buffer_load_dword v224, v237, s[36:39], s25 offen offset:1024
    s_mov_b64 exec, -1
    ds_read_b64_tr_b16 v[212:213], v228 offset:57856
    ds_read_b64_tr_b16 v[214:215], v228 offset:58112
    s_waitcnt lgkmcnt(6)
    v_mfma_f32_16x16x32_bf16 v[164:167], v[216:219], v[8:11], v[164:167]
    v_permlane16_swap_b32 v2, v6
    v_mfma_f32_16x16x32_bf16 v[172:175], v[216:219], v[12:15], v[172:175]
    ds_read_b64_tr_b16 v[216:217], v229 offset:49664
    ds_read_b64_tr_b16 v[218:219], v229 offset:49920
    s_waitcnt lgkmcnt(6)
    v_mfma_f32_16x16x32_bf16 v[196:199], v[220:223], v[8:11], v[196:199]
    v_permlane16_swap_b32 v3, v7
    v_mfma_f32_16x16x32_bf16 v[204:207], v[220:223], v[12:15], v[204:207]
    ds_read_b64_tr_b16 v[220:221], v229 offset:57856
    ds_read_b64_tr_b16 v[222:223], v229 offset:58112
    s_waitcnt lgkmcnt(6)
    v_mfma_f32_16x16x32_bf16 v[160:163], v[208:211], v[16:19], v[160:163]
    v_permlane16_swap_b32 v8, v12
    v_mfma_f32_16x16x32_bf16 v[168:171], v[208:211], v[20:23], v[168:171]
    ds_read_b64_tr_b16 v[208:209], v228 offset:53760
    ds_read_b64_tr_b16 v[210:211], v228 offset:54016
    s_waitcnt lgkmcnt(6)
    v_mfma_f32_16x16x32_bf16 v[192:195], v[212:215], v[16:19], v[192:195]
    v_permlane16_swap_b32 v9, v13
    v_mfma_f32_16x16x32_bf16 v[200:203], v[212:215], v[20:23], v[200:203]
    ds_read_b64_tr_b16 v[212:213], v228 offset:61952
    ds_read_b64_tr_b16 v[214:215], v228 offset:62208
    s_waitcnt lgkmcnt(6)
    v_mfma_f32_16x16x32_bf16 v[164:167], v[216:219], v[16:19], v[164:167]
    v_permlane16_swap_b32 v10, v14
    v_mfma_f32_16x16x32_bf16 v[172:175], v[216:219], v[20:23], v[172:175]
    ds_read_b64_tr_b16 v[216:217], v229 offset:53760
    ds_read_b64_tr_b16 v[218:219], v229 offset:54016
    s_waitcnt lgkmcnt(6)
    v_mfma_f32_16x16x32_bf16 v[196:199], v[220:223], v[16:19], v[196:199]
    v_permlane16_swap_b32 v11, v15
    v_mfma_f32_16x16x32_bf16 v[204:207], v[220:223], v[20:23], v[204:207]
    ds_read_b64_tr_b16 v[220:221], v229 offset:61952
    ds_read_b64_tr_b16 v[222:223], v229 offset:62208
    s_waitcnt lgkmcnt(6)
    v_mfma_f32_16x16x32_bf16 v[160:163], v[208:211], v[24:27], v[160:163]
    v_permlane16_swap_b32 v16, v20
    v_mfma_f32_16x16x32_bf16 v[168:171], v[208:211], v[28:31], v[168:171]
    v_xor_b32 v228, 0x10000, v228
    v_xor_b32 v229, 0x10000, v229
    v_xor_b32 v230, 0x10000, v230
    v_xor_b32 v231, 0x10000, v231
    v_xor_b32 v249, 0x10000, v249
    ds_read_b64_tr_b16 v[208:209], v228 offset:512
    ds_read_b64_tr_b16 v[210:211], v228 offset:768
    s_waitcnt lgkmcnt(6)
    v_mfma_f32_16x16x32_bf16 v[192:195], v[212:215], v[24:27], v[192:195]
    v_permlane16_swap_b32 v17, v21
    v_mfma_f32_16x16x32_bf16 v[200:203], v[212:215], v[28:31], v[200:203]
    v_lshrrev_b32 v237, 5, v238
    v_mul_u32_u24 v237, 0x480, v237
    s_movk_i32 s75, 16
    s_mul_i32 s25, s74, 3456
    s_mul_i32 s75, s20, 144
    s_add_u32 s25, s25, s75
    s_mov_b64 exec, 0x15555
    buffer_load_dword v224, v237, s[40:43], s25 offen
    buffer_load_dword v224, v237, s[40:43], s25 offen offset:128
    s_mov_b64 exec, -1
    ds_read_b64_tr_b16 v[212:213], v228 offset:8704
    ds_read_b64_tr_b16 v[214:215], v228 offset:8960
    s_waitcnt lgkmcnt(6)
    v_mfma_f32_16x16x32_bf16 v[164:167], v[216:219], v[24:27], v[164:167]
    v_permlane16_swap_b32 v18, v22
    v_mfma_f32_16x16x32_bf16 v[172:175], v[216:219], v[28:31], v[172:175]
    ds_read_b64_tr_b16 v[216:217], v229 offset:512
    ds_read_b64_tr_b16 v[218:219], v229 offset:768
    s_waitcnt lgkmcnt(6)
    v_mfma_f32_16x16x32_bf16 v[196:199], v[220:223], v[24:27], v[196:199]
    v_permlane16_swap_b32 v19, v23
    v_mfma_f32_16x16x32_bf16 v[204:207], v[220:223], v[28:31], v[204:207]
    s_waitcnt vmcnt(14)
    s_barrier
    ds_read_b64_tr_b16 v[220:221], v229 offset:8704
    ds_read_b64_tr_b16 v[222:223], v229 offset:8960
    s_waitcnt lgkmcnt(6)
    v_mfma_f32_16x16x32_bf16 v[160:163], v[208:211], v[32:35], v[160:163]
    v_permlane16_swap_b32 v24, v28
    v_mfma_f32_16x16x32_bf16 v[168:171], v[208:211], v[36:39], v[168:171]
    ds_read_b64_tr_b16 v[208:209], v228 offset:4608
    ds_read_b64_tr_b16 v[210:211], v228 offset:4864
    s_waitcnt lgkmcnt(6)
    v_mfma_f32_16x16x32_bf16 v[192:195], v[212:215], v[32:35], v[192:195]
    v_permlane16_swap_b32 v25, v29
    v_mfma_f32_16x16x32_bf16 v[200:203], v[212:215], v[36:39], v[200:203]
    ds_read_b64_tr_b16 v[212:213], v228 offset:12800
    ds_read_b64_tr_b16 v[214:215], v228 offset:13056
    s_waitcnt lgkmcnt(6)
    v_mfma_f32_16x16x32_bf16 v[164:167], v[216:219], v[32:35], v[164:167]
    v_permlane16_swap_b32 v26, v30
    v_mfma_f32_16x16x32_bf16 v[172:175], v[216:219], v[36:39], v[172:175]
    s_add_u32 s25, s65, 0x3f0080
    s_add_u32 m0, s24, 32768
    s_nop 0
    buffer_load_dwordx4 v232, s[32:35], s25 offen lds
    ds_read_b64_tr_b16 v[216:217], v229 offset:4608
    ds_read_b64_tr_b16 v[218:219], v229 offset:4864
    s_waitcnt lgkmcnt(6)
    v_mfma_f32_16x16x32_bf16 v[196:199], v[220:223], v[32:35], v[196:199]
    v_permlane16_swap_b32 v27, v31
    v_mfma_f32_16x16x32_bf16 v[204:207], v[220:223], v[36:39], v[204:207]
    ds_read_b64_tr_b16 v[220:221], v229 offset:12800
    ds_read_b64_tr_b16 v[222:223], v229 offset:13056
    s_waitcnt lgkmcnt(6)
    v_mfma_f32_16x16x32_bf16 v[160:163], v[208:211], v[40:43], v[160:163]
    v_permlane16_swap_b32 v32, v36
    v_mfma_f32_16x16x32_bf16 v[168:171], v[208:211], v[44:47], v[168:171]
    ds_read_b64_tr_b16 v[208:209], v228 offset:16384
    ds_read_b64_tr_b16 v[210:211], v228 offset:16640
    s_waitcnt lgkmcnt(6)
    v_mfma_f32_16x16x32_bf16 v[192:195], v[212:215], v[40:43], v[192:195]
    v_permlane16_swap_b32 v33, v37
    v_mfma_f32_16x16x32_bf16 v[200:203], v[212:215], v[44:47], v[200:203]
    ds_read_b64_tr_b16 v[212:213], v228 offset:16896
    ds_read_b64_tr_b16 v[214:215], v228 offset:17152
    s_waitcnt lgkmcnt(6)
    v_mfma_f32_16x16x32_bf16 v[164:167], v[216:219], v[40:43], v[164:167]
    v_permlane16_swap_b32 v34, v38
    v_mfma_f32_16x16x32_bf16 v[172:175], v[216:219], v[44:47], v[172:175]
    s_add_u32 s25, s65, 0x3f0080
    s_add_u32 m0, s24, 40960
    s_nop 0
    buffer_load_dwordx4 v232, s[36:39], s25 offen lds
    ds_read_b64_tr_b16 v[216:217], v228 offset:24576
    ds_read_b64_tr_b16 v[218:219], v228 offset:24832
    s_waitcnt lgkmcnt(6)
    v_mfma_f32_16x16x32_bf16 v[196:199], v[220:223], v[40:43], v[196:199]
    v_permlane16_swap_b32 v35, v39
    v_mfma_f32_16x16x32_bf16 v[204:207], v[220:223], v[44:47], v[204:207]
    ds_read_b64_tr_b16 v[220:221], v228 offset:25088
    ds_read_b64_tr_b16 v[222:223], v228 offset:25344
    s_waitcnt lgkmcnt(6)
    v_mfma_f32_16x16x32_bf16 v[144:147], v[208:211], v[48:51], v[144:147]
    v_permlane16_swap_b32 v40, v44
    v_mfma_f32_16x16x32_bf16 v[152:155], v[208:211], v[52:55], v[152:155]
    ds_read_b64_tr_b16 v[208:209], v229 offset:16384
    ds_read_b64_tr_b16 v[210:211], v229 offset:16640
    s_waitcnt lgkmcnt(6)
    v_mfma_f32_16x16x32_bf16 v[160:163], v[212:215], v[48:51], v[160:163]
    v_permlane16_swap_b32 v41, v45
    v_mfma_f32_16x16x32_bf16 v[168:171], v[212:215], v[52:55], v[168:171]
    ds_read_b64_tr_b16 v[212:213], v229 offset:16896
    ds_read_b64_tr_b16 v[214:215], v229 offset:17152
    s_waitcnt lgkmcnt(6)
    v_mfma_f32_16x16x32_bf16 v[176:179], v[216:219], v[48:51], v[176:179]
    v_permlane16_swap_b32 v42, v46
    v_mfma_f32_16x16x32_bf16 v[184:187], v[216:219], v[52:55], v[184:187]
    s_add_u32 s25, s65, 0x480080
    s_add_u32 m0, s24, 49152
    s_nop 0
    buffer_load_dwordx4 v232, s[32:35], s25 offen lds
    ds_read_b64_tr_b16 v[216:217], v229 offset:24576
    ds_read_b64_tr_b16 v[218:219], v229 offset:24832
    s_waitcnt lgkmcnt(6)
    v_mfma_f32_16x16x32_bf16 v[192:195], v[220:223], v[48:51], v[192:195]
    v_permlane16_swap_b32 v43, v47
    v_mfma_f32_16x16x32_bf16 v[200:203], v[220:223], v[52:55], v[200:203]
    ds_read_b64_tr_b16 v[220:221], v229 offset:25088
    ds_read_b64_tr_b16 v[222:223], v229 offset:25344
    s_waitcnt lgkmcnt(6)
    v_mfma_f32_16x16x32_bf16 v[148:151], v[208:211], v[48:51], v[148:151]
    v_mfma_f32_16x16x32_bf16 v[156:159], v[208:211], v[52:55], v[156:159]
    ds_read_b64_tr_b16 v[208:209], v228 offset:20480
    ds_read_b64_tr_b16 v[210:211], v228 offset:20736
    s_waitcnt lgkmcnt(6)
    v_mfma_f32_16x16x32_bf16 v[164:167], v[212:215], v[48:51], v[164:167]
    v_mfma_f32_16x16x32_bf16 v[172:175], v[212:215], v[52:55], v[172:175]
    ds_read_b64_tr_b16 v[212:213], v228 offset:20992
    ds_read_b64_tr_b16 v[214:215], v228 offset:21248
    s_waitcnt lgkmcnt(6)
    v_mfma_f32_16x16x32_bf16 v[180:183], v[216:219], v[48:51], v[180:183]
    v_mfma_f32_16x16x32_bf16 v[188:191], v[216:219], v[52:55], v[188:191]
    s_add_u32 s25, s65, 0x480080
    s_add_u32 m0, s24, 57344
    s_nop 0
    buffer_load_dwordx4 v232, s[36:39], s25 offen lds
    ds_read_b64_tr_b16 v[216:217], v228 offset:28672
    ds_read_b64_tr_b16 v[218:219], v228 offset:28928
    s_waitcnt lgkmcnt(6)
    v_mfma_f32_16x16x32_bf16 v[196:199], v[220:223], v[48:51], v[196:199]
    v_mfma_f32_16x16x32_bf16 v[204:207], v[220:223], v[52:55], v[204:207]
    s_waitcnt vmcnt(14)
    s_barrier
    ds_read_b64_tr_b16 v[220:221], v228 offset:29184
    ds_read_b64_tr_b16 v[222:223], v228 offset:29440
    s_waitcnt lgkmcnt(6)
    v_mfma_f32_16x16x32_bf16 v[144:147], v[208:211], v[56:59], v[144:147]
    v_permlane16_swap_b32 v48, v52
    v_mfma_f32_16x16x32_bf16 v[152:155], v[208:211], v[60:63], v[152:155]
    s_waitcnt vmcnt(12)
    ds_read_b64_tr_b16 v[240:241], v254
    ds_read_b64_tr_b16 v[242:243], v254 offset:1024
    ds_read_b64_tr_b16 v[208:209], v229 offset:20480
    ds_read_b64_tr_b16 v[210:211], v229 offset:20736
    s_waitcnt lgkmcnt(8)
    v_mfma_f32_16x16x32_bf16 v[160:163], v[212:215], v[56:59], v[160:163]
    v_permlane16_swap_b32 v49, v53
    v_mfma_f32_16x16x32_bf16 v[168:171], v[212:215], v[60:63], v[168:171]
    ds_read_b64_tr_b16 v[212:213], v229 offset:20992
    ds_read_b64_tr_b16 v[214:215], v229 offset:21248
    s_waitcnt lgkmcnt(8)
    v_mfma_f32_16x16x32_bf16 v[176:179], v[216:219], v[56:59], v[176:179]
    v_permlane16_swap_b32 v50, v54
    v_mfma_f32_16x16x32_bf16 v[184:187], v[216:219], v[60:63], v[184:187]
    v_xor_b32 v237, 32, v254
    ds_read_b64_tr_b16 v[244:245], v237
    ds_read_b64_tr_b16 v[246:247], v237 offset:1024
    ds_read_b64_tr_b16 v[216:217], v229 offset:28672
    ds_read_b64_tr_b16 v[218:219], v229 offset:28928
    s_waitcnt lgkmcnt(10)
    v_mfma_f32_16x16x32_bf16 v[192:195], v[220:223], v[56:59], v[192:195]
    v_permlane16_swap_b32 v51, v55
    v_mfma_f32_16x16x32_bf16 v[200:203], v[220:223], v[60:63], v[200:203]
    ds_read_b64_tr_b16 v[220:221], v229 offset:29184
    ds_read_b64_tr_b16 v[222:223], v229 offset:29440
    s_waitcnt lgkmcnt(8)
    v_mfma_f32_16x16x32_bf16 v[148:151], v[208:211], v[56:59], v[148:151]
    v_mfma_f32_16x16x32_bf16 v[156:159], v[208:211], v[60:63], v[156:159]
    ds_read_b64_tr_b16 v[208:209], v228 offset:32768
    ds_read_b64_tr_b16 v[210:211], v228 offset:33024
    s_waitcnt lgkmcnt(8)
    v_mfma_f32_16x16x32_bf16 v[164:167], v[212:215], v[56:59], v[164:167]
    v_mfma_f32_16x16x32_bf16 v[172:175], v[212:215], v[60:63], v[172:175]
    s_add_u32 s25, s66, 0x0
    s_add_u32 m0, s24, 65536
    s_mov_b64 exec, s[68:69]
    buffer_load_dwordx4 v233, s[40:43], s25 offen lds
    s_mov_b64 exec, -1
    ds_read_b64_tr_b16 v[212:213], v228 offset:33280
    ds_read_b64_tr_b16 v[214:215], v228 offset:33536
    s_waitcnt lgkmcnt(6)
    v_mfma_f32_16x16x32_bf16 v[180:183], v[216:219], v[56:59], v[180:183]
    v_mfma_f32_16x16x32_bf16 v[188:191], v[216:219], v[60:63], v[188:191]
    buffer_store_dwordx4 v[240:243], v250, s[60:63], s78 offen sc1
    ds_read_b64_tr_b16 v[216:217], v228 offset:40960
    ds_read_b64_tr_b16 v[218:219], v228 offset:41216
    s_waitcnt lgkmcnt(6)
    v_mfma_f32_16x16x32_bf16 v[196:199], v[220:223], v[56:59], v[196:199]
    v_mfma_f32_16x16x32_bf16 v[204:207], v[220:223], v[60:63], v[204:207]
    ds_read_b64_tr_b16 v[220:221], v228 offset:41472
    ds_read_b64_tr_b16 v[222:223], v228 offset:41728
    s_waitcnt lgkmcnt(6)
    v_mfma_f32_16x16x32_bf16 v[144:147], v[208:211], v[64:67], v[144:147]
    v_permlane16_swap_b32 v56, v60
    v_mfma_f32_16x16x32_bf16 v[152:155], v[208:211], v[68:71], v[152:155]
    ds_read_b64_tr_b16 v[208:209], v229 offset:32768
    ds_read_b64_tr_b16 v[210:211], v229 offset:33024
    s_waitcnt lgkmcnt(6)
    v_mfma_f32_16x16x32_bf16 v[160:163], v[212:215], v[64:67], v[160:163]
    v_permlane16_swap_b32 v57, v61
    v_mfma_f32_16x16x32_bf16 v[168:171], v[212:215], v[68:71], v[168:171]
    ds_read_b64_tr_b16 v[212:213], v229 offset:33280
    ds_read_b64_tr_b16 v[214:215], v229 offset:33536
    s_waitcnt lgkmcnt(6)
    v_mfma_f32_16x16x32_bf16 v[176:179], v[216:219], v[64:67], v[176:179]
    v_permlane16_swap_b32 v58, v62
    v_mfma_f32_16x16x32_bf16 v[184:187], v[216:219], v[68:71], v[184:187]
    v_xor_b32 v237, 64, v254
    ds_read_b64_tr_b16 v[240:241], v237
    ds_read_b64_tr_b16 v[242:243], v237 offset:1024
    ds_read_b64_tr_b16 v[216:217], v229 offset:40960
    ds_read_b64_tr_b16 v[218:219], v229 offset:41216
    s_waitcnt lgkmcnt(8)
    v_mfma_f32_16x16x32_bf16 v[192:195], v[220:223], v[64:67], v[192:195]
    v_permlane16_swap_b32 v59, v63
    v_mfma_f32_16x16x32_bf16 v[200:203], v[220:223], v[68:71], v[200:203]
    ds_read_b64_tr_b16 v[220:221], v229 offset:41472
    ds_read_b64_tr_b16 v[222:223], v229 offset:41728
    s_waitcnt lgkmcnt(8)
    v_mfma_f32_16x16x32_bf16 v[148:151], v[208:211], v[64:67], v[148:151]
    v_mfma_f32_16x16x32_bf16 v[156:159], v[208:211], v[68:71], v[156:159]
    buffer_store_dwordx4 v[244:247], v251, s[60:63], s78 offen sc1
    ds_read_b64_tr_b16 v[208:209], v228 offset:36864
    ds_read_b64_tr_b16 v[210:211], v228 offset:37120
    s_waitcnt lgkmcnt(8)
    v_mfma_f32_16x16x32_bf16 v[164:167], v[212:215], v[64:67], v[164:167]
    v_mfma_f32_16x16x32_bf16 v[172:175], v[212:215], v[68:71], v[172:175]
    s_add_u32 m0, s24, 73728
    s_mov_b64 exec, s[30:31]
    global_load_lds_dwordx4 v[234:235], off
    s_mov_b64 exec, -1
    v_add_co_u32 v234, s[70:71], v234, v236
    s_nop 1
    v_addc_co_u32 v235, s[70:71], 0, v235, s[70:71]
    ds_read_b64_tr_b16 v[212:213], v228 offset:37376
    ds_read_b64_tr_b16 v[214:215], v228 offset:37632
    s_waitcnt lgkmcnt(6)
    v_mfma_f32_16x16x32_bf16 v[180:183], v[216:219], v[64:67], v[180:183]
    v_mfma_f32_16x16x32_bf16 v[188:191], v[216:219], v[68:71], v[188:191]
    ds_read_b64_tr_b16 v[216:217], v228 offset:45056
    ds_read_b64_tr_b16 v[218:219], v228 offset:45312
    s_waitcnt lgkmcnt(6)
    v_mfma_f32_16x16x32_bf16 v[196:199], v[220:223], v[64:67], v[196:199]
    v_mfma_f32_16x16x32_bf16 v[204:207], v[220:223], v[68:71], v[204:207]
    s_barrier
    ds_read_b64_tr_b16 v[220:221], v228 offset:45568
    ds_read_b64_tr_b16 v[222:223], v228 offset:45824
    s_waitcnt lgkmcnt(6)
    v_mfma_f32_16x16x32_bf16 v[144:147], v[208:211], v[72:75], v[144:147]
    v_permlane16_swap_b32 v64, v68
    v_mfma_f32_16x16x32_bf16 v[152:155], v[208:211], v[76:79], v[152:155]
    v_xor_b32 v237, 96, v254
    ds_read_b64_tr_b16 v[244:245], v237
    ds_read_b64_tr_b16 v[246:247], v237 offset:1024
    ds_read_b64_tr_b16 v[208:209], v229 offset:36864
    ds_read_b64_tr_b16 v[210:211], v229 offset:37120
    s_waitcnt lgkmcnt(8)
    v_mfma_f32_16x16x32_bf16 v[160:163], v[212:215], v[72:75], v[160:163]
    v_permlane16_swap_b32 v65, v69
    v_mfma_f32_16x16x32_bf16 v[168:171], v[212:215], v[76:79], v[168:171]
    ds_read_b64_tr_b16 v[212:213], v229 offset:37376
    ds_read_b64_tr_b16 v[214:215], v229 offset:37632
    s_waitcnt lgkmcnt(8)
    v_mfma_f32_16x16x32_bf16 v[176:179], v[216:219], v[72:75], v[176:179]
    v_permlane16_swap_b32 v66, v70
    v_mfma_f32_16x16x32_bf16 v[184:187], v[216:219], v[76:79], v[184:187]
    buffer_store_dwordx4 v[240:243], v252, s[60:63], s78 offen sc1
    ds_read_b64_tr_b16 v[216:217], v229 offset:45056
    ds_read_b64_tr_b16 v[218:219], v229 offset:45312
    s_waitcnt lgkmcnt(8)
    v_mfma_f32_16x16x32_bf16 v[192:195], v[220:223], v[72:75], v[192:195]
    v_permlane16_swap_b32 v67, v71
    v_mfma_f32_16x16x32_bf16 v[200:203], v[220:223], v[76:79], v[200:203]
    ds_read_b64_tr_b16 v[220:221], v229 offset:45568
    ds_read_b64_tr_b16 v[222:223], v229 offset:45824
    s_waitcnt lgkmcnt(6)
    v_mfma_f32_16x16x32_bf16 v[148:151], v[208:211], v[72:75], v[148:151]
    v_mfma_f32_16x16x32_bf16 v[156:159], v[208:211], v[76:79], v[156:159]
    v_xor_b32 v228, 0x10000, v228
    v_xor_b32 v229, 0x10000, v229
    v_xor_b32 v230, 0x10000, v230
    v_xor_b32 v231, 0x10000, v231
    v_xor_b32 v249, 0x10000, v249
    ds_read_b64_tr_b16 v[208:209], v228 offset:0
    ds_read_b64_tr_b16 v[210:211], v228 offset:256
    s_waitcnt lgkmcnt(6)
    v_mfma_f32_16x16x32_bf16 v[164:167], v[212:215], v[72:75], v[164:167]
    v_mfma_f32_16x16x32_bf16 v[172:175], v[212:215], v[76:79], v[172:175]
    s_add_u32 s25, s66, 0x36000
    s_add_u32 m0, s24, 81920
    s_mov_b64 exec, s[68:69]
    buffer_load_dwordx4 v233, s[40:43], s25 offen lds
    s_mov_b64 exec, -1
    ds_read_b64_tr_b16 v[212:213], v228 offset:512
    ds_read_b64_tr_b16 v[214:215], v228 offset:768
    s_waitcnt lgkmcnt(6)
    v_mfma_f32_16x16x32_bf16 v[180:183], v[216:219], v[72:75], v[180:183]
    v_mfma_f32_16x16x32_bf16 v[188:191], v[216:219], v[76:79], v[188:191]
    buffer_store_dwordx4 v[244:247], v253, s[60:63], s78 offen sc1
    ds_read_b64_tr_b16 v[216:217], v228 offset:8192
    ds_read_b64_tr_b16 v[218:219], v228 offset:8448
    s_waitcnt lgkmcnt(6)
    v_mfma_f32_16x16x32_bf16 v[196:199], v[220:223], v[72:75], v[196:199]
    v_mfma_f32_16x16x32_bf16 v[204:207], v[220:223], v[76:79], v[204:207]
    ds_read_b64_tr_b16 v[220:221], v228 offset:8704
    ds_read_b64_tr_b16 v[222:223], v228 offset:8960
    s_waitcnt lgkmcnt(6)
    v_mfma_f32_16x16x32_bf16 v[144:147], v[208:211], v[80:83], v[144:147]
    v_permlane16_swap_b32 v72, v76
    v_mfma_f32_16x16x32_bf16 v[152:155], v[208:211], v[84:87], v[152:155]
    ds_read_b64_tr_b16 v[208:209], v229 offset:0
    ds_read_b64_tr_b16 v[210:211], v229 offset:256
    s_waitcnt lgkmcnt(6)
    v_mfma_f32_16x16x32_bf16 v[160:163], v[212:215], v[80:83], v[160:163]
    v_permlane16_swap_b32 v73, v77
    v_mfma_f32_16x16x32_bf16 v[168:171], v[212:215], v[84:87], v[168:171]
    ds_read_b64_tr_b16 v[212:213], v229 offset:512
    ds_read_b64_tr_b16 v[214:215], v229 offset:768
    s_waitcnt lgkmcnt(6)
    v_mfma_f32_16x16x32_bf16 v[176:179], v[216:219], v[80:83], v[176:179]
    v_permlane16_swap_b32 v74, v78
    v_mfma_f32_16x16x32_bf16 v[184:187], v[216:219], v[84:87], v[184:187]
    v_mov_b32 v240, 0
    v_mov_b32 v241, 0
    v_mov_b32 v242, 0
    v_mov_b32 v243, 0
    ds_read_b64_tr_b16 v[216:217], v229 offset:8192
    ds_read_b64_tr_b16 v[218:219], v229 offset:8448
    s_waitcnt lgkmcnt(6)
    v_mfma_f32_16x16x32_bf16 v[192:195], v[220:223], v[80:83], v[192:195]
    v_permlane16_swap_b32 v75, v79
    v_mfma_f32_16x16x32_bf16 v[200:203], v[220:223], v[84:87], v[200:203]
    ds_read_b64_tr_b16 v[220:221], v229 offset:8704
    ds_read_b64_tr_b16 v[222:223], v229 offset:8960
    s_waitcnt lgkmcnt(6)
    v_mfma_f32_16x16x32_bf16 v[148:151], v[208:211], v[80:83], v[148:151]
    v_mfma_f32_16x16x32_bf16 v[156:159], v[208:211], v[84:87], v[156:159]
    v_mov_b32 v244, 0
    v_mov_b32 v245, 0
    v_mov_b32 v246, 0
    v_mov_b32 v247, 0
    ds_read_b64_tr_b16 v[208:209], v228 offset:4096
    ds_read_b64_tr_b16 v[210:211], v228 offset:4352
    s_waitcnt lgkmcnt(6)
    v_mfma_f32_16x16x32_bf16 v[164:167], v[212:215], v[80:83], v[164:167]
    v_mfma_f32_16x16x32_bf16 v[172:175], v[212:215], v[84:87], v[172:175]
    s_add_u32 m0, s24, 90112
    s_mov_b64 exec, s[30:31]
    global_load_lds_dwordx4 v[234:235], off
    s_mov_b64 exec, -1
    v_add_co_u32 v234, s[70:71], v234, v236
    s_nop 1
    v_addc_co_u32 v235, s[70:71], 0, v235, s[70:71]
    ds_read_b64_tr_b16 v[212:213], v228 offset:4608
    ds_read_b64_tr_b16 v[214:215], v228 offset:4864
    s_waitcnt lgkmcnt(6)
    v_mfma_f32_16x16x32_bf16 v[180:183], v[216:219], v[80:83], v[180:183]
    v_mfma_f32_16x16x32_bf16 v[188:191], v[216:219], v[84:87], v[188:191]
    ds_read_b64_tr_b16 v[216:217], v228 offset:12288
    ds_read_b64_tr_b16 v[218:219], v228 offset:12544
    s_waitcnt lgkmcnt(6)
    v_mfma_f32_16x16x32_bf16 v[196:199], v[220:223], v[80:83], v[196:199]
    v_mfma_f32_16x16x32_bf16 v[204:207], v[220:223], v[84:87], v[204:207]
    s_waitcnt vmcnt(10)
    s_barrier
    ds_read_b64_tr_b16 v[220:221], v228 offset:12800
    ds_read_b64_tr_b16 v[222:223], v228 offset:13056
    s_waitcnt lgkmcnt(6)
    v_mfma_f32_16x16x32_bf16 v[144:147], v[208:211], v[88:91], v[144:147]
    v_permlane16_swap_b32 v80, v84
    v_mfma_f32_16x16x32_bf16 v[152:155], v[208:211], v[92:95], v[152:155]
    ds_read_b64_tr_b16 v[208:209], v229 offset:4096
    ds_read_b64_tr_b16 v[210:211], v229 offset:4352
    s_waitcnt lgkmcnt(6)
    v_mfma_f32_16x16x32_bf16 v[160:163], v[212:215], v[88:91], v[160:163]
    v_permlane16_swap_b32 v81, v85
    v_mfma_f32_16x16x32_bf16 v[168:171], v[212:215], v[92:95], v[168:171]
    ds_read_b64_tr_b16 v[212:213], v229 offset:4608
    ds_read_b64_tr_b16 v[214:215], v229 offset:4864
    s_waitcnt lgkmcnt(6)
    v_mfma_f32_16x16x32_bf16 v[176:179], v[216:219], v[88:91], v[176:179]
    v_permlane16_swap_b32 v82, v86
    v_mfma_f32_16x16x32_bf16 v[184:187], v[216:219], v[92:95], v[184:187]
    s_add_u32 s25, s66, 0x6c000
    s_add_u32 m0, s24, 98304
    s_mov_b64 exec, s[68:69]
    buffer_load_dwordx4 v233, s[40:43], s25 offen lds
    s_mov_b64 exec, -1
    ds_read_b64_tr_b16 v[216:217], v229 offset:12288
    ds_read_b64_tr_b16 v[218:219], v229 offset:12544
    s_waitcnt lgkmcnt(6)
    v_mfma_f32_16x16x32_bf16 v[192:195], v[220:223], v[88:91], v[192:195]
    v_permlane16_swap_b32 v83, v87
    v_mfma_f32_16x16x32_bf16 v[200:203], v[220:223], v[92:95], v[200:203]
    ds_read_b64_tr_b16 v[220:221], v229 offset:12800
    ds_read_b64_tr_b16 v[222:223], v229 offset:13056
    s_waitcnt lgkmcnt(6)
    v_mfma_f32_16x16x32_bf16 v[148:151], v[208:211], v[88:91], v[148:151]
    v_mfma_f32_16x16x32_bf16 v[156:159], v[208:211], v[92:95], v[156:159]
    ds_read_b64_tr_b16 v[208:209], v228 offset:16384
    ds_read_b64_tr_b16 v[210:211], v228 offset:16640
    s_waitcnt lgkmcnt(6)
    v_mfma_f32_16x16x32_bf16 v[164:167], v[212:215], v[88:91], v[164:167]
    v_mfma_f32_16x16x32_bf16 v[172:175], v[212:215], v[92:95], v[172:175]
    s_add_u32 m0, s24, 106496
    s_mov_b64 exec, s[30:31]
    global_load_lds_dwordx4 v[234:235], off
    s_mov_b64 exec, -1
    v_add_co_u32 v234, s[70:71], v234, v236
    s_nop 1
    v_addc_co_u32 v235, s[70:71], 0, v235, s[70:71]
    ds_read_b64_tr_b16 v[212:213], v228 offset:24576
    ds_read_b64_tr_b16 v[214:215], v228 offset:24832
    s_waitcnt lgkmcnt(6)
    v_mfma_f32_16x16x32_bf16 v[180:183], v[216:219], v[88:91], v[180:183]
    v_mfma_f32_16x16x32_bf16 v[188:191], v[216:219], v[92:95], v[188:191]
    ds_read_b64_tr_b16 v[216:217], v229 offset:16384
    ds_read_b64_tr_b16 v[218:219], v229 offset:16640
    s_waitcnt lgkmcnt(6)
    v_mfma_f32_16x16x32_bf16 v[196:199], v[220:223], v[88:91], v[196:199]
    v_mfma_f32_16x16x32_bf16 v[204:207], v[220:223], v[92:95], v[204:207]
    ds_read_b64_tr_b16 v[220:221], v229 offset:24576
    ds_read_b64_tr_b16 v[222:223], v229 offset:24832
    s_waitcnt lgkmcnt(6)
    v_mfma_f32_16x16x32_bf16 v[144:147], v[208:211], v[96:99], v[144:147]
    v_permlane16_swap_b32 v88, v92
    v_mfma_f32_16x16x32_bf16 v[152:155], v[208:211], v[100:103], v[152:155]
    v_lshrrev_b32 v237, 8, v238
    v_lshlrev_b32 v237, 9, v237
    s_movk_i32 s75, 0xf0
    v_and_or_b32 v237, v238, s75, v237
    s_lshl_b32 s74, s22, 3
    s_max_u32 s74, s74, 1
    s_sub_u32 s74, s74, 1
    s_mul_i32 s74, s74, 36864
    s_lshl_b32 s75, s3, 11
    s_add_u32 s74, s74, s75
    s_add_u32 s74, s74, 256
    s_add_u32 m0, s24, 139264
    s_nop 0
    buffer_load_dwordx4 v237, s[44:47], s74 offen lds
    s_add_u32 s74, s74, 16384
    ds_read_b64_tr_b16 v[208:209], v228 offset:20480
    ds_read_b64_tr_b16 v[210:211], v228 offset:20736
    s_waitcnt lgkmcnt(6)
    v_mfma_f32_16x16x32_bf16 v[176:179], v[212:215], v[96:99], v[176:179]
    v_permlane16_swap_b32 v89, v93
    v_mfma_f32_16x16x32_bf16 v[184:187], v[212:215], v[100:103], v[184:187]
    ds_read_b64_tr_b16 v[212:213], v228 offset:28672
    ds_read_b64_tr_b16 v[214:215], v228 offset:28928
    s_waitcnt lgkmcnt(6)
    v_mfma_f32_16x16x32_bf16 v[148:151], v[216:219], v[96:99], v[148:151]
    v_permlane16_swap_b32 v90, v94
    v_mfma_f32_16x16x32_bf16 v[156:159], v[216:219], v[100:103], v[156:159]
    ds_read_b64_tr_b16 v[216:217], v229 offset:20480
    ds_read_b64_tr_b16 v[218:219], v229 offset:20736
    s_waitcnt lgkmcnt(6)
    v_mfma_f32_16x16x32_bf16 v[180:183], v[220:223], v[96:99], v[180:183]
    v_permlane16_swap_b32 v91, v95
    v_mfma_f32_16x16x32_bf16 v[188:191], v[220:223], v[100:103], v[188:191]
    s_add_u32 m0, s24, 147456
    s_nop 0
    buffer_load_dwordx4 v237, s[44:47], s74 offen lds
    s_add_u32 s74, s74, 16384
    ds_read_b64_tr_b16 v[220:221], v229 offset:28672
    ds_read_b64_tr_b16 v[222:223], v229 offset:28928
    s_waitcnt lgkmcnt(6)
    v_mfma_f32_16x16x32_bf16 v[144:147], v[208:211], v[104:107], v[144:147]
    v_mfma_f32_16x16x32_bf16 v[152:155], v[208:211], v[108:111], v[152:155]
    ds_read_b64_tr_b16 v[208:209], v228 offset:32768
    ds_read_b64_tr_b16 v[210:211], v228 offset:33024
    s_waitcnt lgkmcnt(6)
    v_mfma_f32_16x16x32_bf16 v[176:179], v[212:215], v[104:107], v[176:179]
    v_mfma_f32_16x16x32_bf16 v[184:187], v[212:215], v[108:111], v[184:187]
    ds_read_b64_tr_b16 v[212:213], v228 offset:40960
    ds_read_b64_tr_b16 v[214:215], v228 offset:41216
    s_waitcnt lgkmcnt(6)
    v_mfma_f32_16x16x32_bf16 v[148:151], v[216:219], v[104:107], v[148:151]
    v_mfma_f32_16x16x32_bf16 v[156:159], v[216:219], v[108:111], v[156:159]
    ds_read_b64_tr_b16 v[216:217], v229 offset:32768
    ds_read_b64_tr_b16 v[218:219], v229 offset:33024
    s_waitcnt lgkmcnt(6)
    v_mfma_f32_16x16x32_bf16 v[180:183], v[220:223], v[104:107], v[180:183]
    v_mfma_f32_16x16x32_bf16 v[188:191], v[220:223], v[108:111], v[188:191]
    s_waitcnt vmcnt(12)
    s_barrier
    ds_read_b64_tr_b16 v[220:221], v229 offset:40960
    ds_read_b64_tr_b16 v[222:223], v229 offset:41216
    s_waitcnt lgkmcnt(6)
    v_mfma_f32_16x16x32_bf16 v[144:147], v[208:211], v[112:115], v[144:147]
    v_mfma_f32_16x16x32_bf16 v[152:155], v[208:211], v[116:119], v[152:155]
    ds_read_b64_tr_b16 v[208:209], v228 offset:36864
    ds_read_b64_tr_b16 v[210:211], v228 offset:37120
    s_waitcnt lgkmcnt(6)
    v_mfma_f32_16x16x32_bf16 v[176:179], v[212:215], v[112:115], v[176:179]
    v_mfma_f32_16x16x32_bf16 v[184:187], v[212:215], v[116:119], v[184:187]
    ds_read_b64_tr_b16 v[212:213], v228 offset:45056
    ds_read_b64_tr_b16 v[214:215], v228 offset:45312
    s_waitcnt lgkmcnt(6)
    v_mfma_f32_16x16x32_bf16 v[148:151], v[216:219], v[112:115], v[148:151]
    v_mfma_f32_16x16x32_bf16 v[156:159], v[216:219], v[116:119], v[156:159]
    ds_read_b64_tr_b16 v[216:217], v229 offset:36864
    ds_read_b64_tr_b16 v[218:219], v229 offset:37120
    s_waitcnt lgkmcnt(6)
    v_mfma_f32_16x16x32_bf16 v[180:183], v[220:223], v[112:115], v[180:183]
    v_mfma_f32_16x16x32_bf16 v[188:191], v[220:223], v[116:119], v[188:191]
    ds_read_b64_tr_b16 v[220:221], v229 offset:45056
    ds_read_b64_tr_b16 v[222:223], v229 offset:45312
    s_waitcnt lgkmcnt(6)
    v_mfma_f32_16x16x32_bf16 v[144:147], v[208:211], v[120:123], v[144:147]
    v_mfma_f32_16x16x32_bf16 v[152:155], v[208:211], v[124:127], v[152:155]
    ds_read_b64_tr_b16 v[208:209], v228 offset:49152
    ds_read_b64_tr_b16 v[210:211], v228 offset:49408
    s_waitcnt lgkmcnt(6)
    v_mfma_f32_16x16x32_bf16 v[176:179], v[212:215], v[120:123], v[176:179]
    v_mfma_f32_16x16x32_bf16 v[184:187], v[212:215], v[124:127], v[184:187]
    s_add_u32 s25, s66, 0xa2000
    s_add_u32 m0, s24, 0
    s_mov_b64 exec, s[68:69]
    buffer_load_dwordx4 v233, s[40:43], s25 offen lds
    s_mov_b64 exec, -1
    ds_read_b64_tr_b16 v[212:213], v228 offset:57344
    ds_read_b64_tr_b16 v[214:215], v228 offset:57600
    s_waitcnt lgkmcnt(6)
    v_mfma_f32_16x16x32_bf16 v[148:151], v[216:219], v[120:123], v[148:151]
    v_mfma_f32_16x16x32_bf16 v[156:159], v[216:219], v[124:127], v[156:159]
    ds_read_b64_tr_b16 v[216:217], v229 offset:49152
    ds_read_b64_tr_b16 v[218:219], v229 offset:49408
    s_waitcnt lgkmcnt(6)
    v_mfma_f32_16x16x32_bf16 v[180:183], v[220:223], v[120:123], v[180:183]
    v_mfma_f32_16x16x32_bf16 v[188:191], v[220:223], v[124:127], v[188:191]
    ds_read_b64_tr_b16 v[220:221], v229 offset:57344
    ds_read_b64_tr_b16 v[222:223], v229 offset:57600
    s_waitcnt lgkmcnt(6)
    v_mfma_f32_16x16x32_bf16 v[144:147], v[208:211], v[128:131], v[144:147]
    v_mfma_f32_16x16x32_bf16 v[152:155], v[208:211], v[132:135], v[152:155]
    ds_read_b64_tr_b16 v[208:209], v228 offset:53248
    ds_read_b64_tr_b16 v[210:211], v228 offset:53504
    s_waitcnt lgkmcnt(6)
    v_mfma_f32_16x16x32_bf16 v[176:179], v[212:215], v[128:131], v[176:179]
    v_mfma_f32_16x16x32_bf16 v[184:187], v[212:215], v[132:135], v[184:187]
    ds_read_b64_tr_b16 v[212:213], v228 offset:61440
    ds_read_b64_tr_b16 v[214:215], v228 offset:61696
    s_waitcnt lgkmcnt(6)
    v_mfma_f32_16x16x32_bf16 v[148:151], v[216:219], v[128:131], v[148:151]
    v_mfma_f32_16x16x32_bf16 v[156:159], v[216:219], v[132:135], v[156:159]
    ds_read_b64_tr_b16 v[216:217], v229 offset:53248
    ds_read_b64_tr_b16 v[218:219], v229 offset:53504
    s_waitcnt lgkmcnt(6)
    v_mfma_f32_16x16x32_bf16 v[180:183], v[220:223], v[128:131], v[180:183]
    v_mfma_f32_16x16x32_bf16 v[188:191], v[220:223], v[132:135], v[188:191]
    ds_read_b64_tr_b16 v[220:221], v229 offset:61440
    ds_read_b64_tr_b16 v[222:223], v229 offset:61696
    s_waitcnt lgkmcnt(6)
    v_mfma_f32_16x16x32_bf16 v[144:147], v[208:211], v[136:139], v[144:147]
    v_mfma_f32_16x16x32_bf16 v[152:155], v[208:211], v[140:143], v[152:155]
    ds_read_b64_tr_b16 v[208:209], v228 offset:16896
    ds_read_b64_tr_b16 v[210:211], v228 offset:17152
    s_waitcnt lgkmcnt(6)
    v_mfma_f32_16x16x32_bf16 v[176:179], v[212:215], v[136:139], v[176:179]
    v_mfma_f32_16x16x32_bf16 v[184:187], v[212:215], v[140:143], v[184:187]
    s_add_u32 m0, s24, 8192
    s_mov_b64 exec, s[30:31]
    global_load_lds_dwordx4 v[234:235], off
    s_mov_b64 exec, -1
    v_add_co_u32 v234, s[70:71], v234, v236
    s_nop 1
    v_addc_co_u32 v235, s[70:71], 0, v235, s[70:71]
    ds_read_b64_tr_b16 v[212:213], v228 offset:25088
    ds_read_b64_tr_b16 v[214:215], v228 offset:25344
    s_waitcnt lgkmcnt(6)
    v_mfma_f32_16x16x32_bf16 v[148:151], v[216:219], v[136:139], v[148:151]
    v_mfma_f32_16x16x32_bf16 v[156:159], v[216:219], v[140:143], v[156:159]
    ds_read_b64_tr_b16 v[216:217], v229 offset:16896
    ds_read_b64_tr_b16 v[218:219], v229 offset:17152
    s_waitcnt lgkmcnt(6)
    v_mfma_f32_16x16x32_bf16 v[180:183], v[220:223], v[136:139], v[180:183]
    v_mfma_f32_16x16x32_bf16 v[188:191], v[220:223], v[140:143], v[188:191]
    s_barrier
    ds_read_b64_tr_b16 v[220:221], v229 offset:25088
    ds_read_b64_tr_b16 v[222:223], v229 offset:25344
    s_waitcnt lgkmcnt(6)
    v_mfma_f32_16x16x32_bf16 v[160:163], v[208:211], v[96:99], v[160:163]
    v_mfma_f32_16x16x32_bf16 v[168:171], v[208:211], v[100:103], v[168:171]
    ds_read_b64_tr_b16 v[208:209], v228 offset:20992
    ds_read_b64_tr_b16 v[210:211], v228 offset:21248
    s_waitcnt lgkmcnt(6)
    v_mfma_f32_16x16x32_bf16 v[192:195], v[212:215], v[96:99], v[192:195]
    s_and_b32 s67, s23, 7
    s_lshl_b32 s67, s67, 11
    s_lshr_b32 s26, s23, 3
    s_mul_i32 s26, s26, 36864
    s_add_u32 s67, s67, s26
    s_add_u32 s67, s67, 16384
    s_mul_i32 s26, s28, 165888
    s_add_u32 s67, s67, s26
    s_add_u32 s98, s67, 165888
    v_mul_f32 v176, v144, v176
    v_mfma_f32_16x16x32_bf16 v[200:203], v[212:215], v[100:103], v[200:203]
    v_mul_f32 v144, s64, v144
    v_mul_f32 v177, v145, v177
    v_mul_f32 v145, s64, v145
    v_mul_f32 v178, v146, v178
    v_mul_f32 v146, s64, v146
    ds_read_b64_tr_b16 v[212:213], v228 offset:29184
    ds_read_b64_tr_b16 v[214:215], v228 offset:29440
    s_waitcnt lgkmcnt(6)
    v_mfma_f32_16x16x32_bf16 v[164:167], v[216:219], v[96:99], v[164:167]
    v_mul_f32 v179, v147, v179
    v_mul_f32 v147, s64, v147
    v_mfma_f32_16x16x32_bf16 v[172:175], v[216:219], v[100:103], v[172:175]
    v_mul_f32 v180, v148, v180
    v_mul_f32 v148, s64, v148
    v_mul_f32 v181, v149, v181
    v_mul_f32 v149, s64, v149
    v_mul_f32 v182, v150, v182
    ds_read_b64_tr_b16 v[216:217], v229 offset:20992
    ds_read_b64_tr_b16 v[218:219], v229 offset:21248
    s_waitcnt lgkmcnt(6)
    v_mfma_f32_16x16x32_bf16 v[196:199], v[220:223], v[96:99], v[196:199]
    v_mul_f32 v150, s64, v150
    v_mul_f32 v183, v151, v183
    v_mfma_f32_16x16x32_bf16 v[204:207], v[220:223], v[100:103], v[204:207]
    v_mul_f32 v151, s64, v151
    v_exp_f32 v144, v144
    v_exp_f32 v145, v145
    v_add_f32 v144, 1.0, v144
    v_exp_f32 v146, v146
    ds_read_b64_tr_b16 v[220:221], v229 offset:29184
    ds_read_b64_tr_b16 v[222:223], v229 offset:29440
    s_waitcnt lgkmcnt(6)
    v_mfma_f32_16x16x32_bf16 v[160:163], v[208:211], v[104:107], v[160:163]
    v_permlane16_swap_b32 v96, v100
    v_mfma_f32_16x16x32_bf16 v[168:171], v[208:211], v[108:111], v[168:171]
    v_add_f32 v145, 1.0, v145
    v_exp_f32 v147, v147
    v_add_f32 v146, 1.0, v146
    v_exp_f32 v148, v148
    v_add_f32 v147, 1.0, v147
    ds_read_b64_tr_b16 v[208:209], v228 offset:33280
    ds_read_b64_tr_b16 v[210:211], v228 offset:33536
    s_waitcnt lgkmcnt(6)
    v_mfma_f32_16x16x32_bf16 v[192:195], v[212:215], v[104:107], v[192:195]
    v_permlane16_swap_b32 v97, v101
    v_mfma_f32_16x16x32_bf16 v[200:203], v[212:215], v[108:111], v[200:203]
    v_exp_f32 v149, v149
    v_add_f32 v148, 1.0, v148
    v_exp_f32 v150, v150
    v_add_f32 v149, 1.0, v149
    v_exp_f32 v151, v151
    ds_read_b64_tr_b16 v[212:213], v228 offset:41472
    ds_read_b64_tr_b16 v[214:215], v228 offset:41728
    s_waitcnt lgkmcnt(6)
    v_mfma_f32_16x16x32_bf16 v[164:167], v[216:219], v[104:107], v[164:167]
    v_permlane16_swap_b32 v98, v102
    v_mfma_f32_16x16x32_bf16 v[172:175], v[216:219], v[108:111], v[172:175]
    v_add_f32 v150, 1.0, v150
    v_add_f32 v151, 1.0, v151
    v_rcp_f32 v144, v144
    v_rcp_f32 v145, v145
    v_mul_f32 v176, v176, v144
    ds_read_b64_tr_b16 v[216:217], v229 offset:33280
    ds_read_b64_tr_b16 v[218:219], v229 offset:33536
    s_waitcnt lgkmcnt(6)
    v_mfma_f32_16x16x32_bf16 v[196:199], v[220:223], v[104:107], v[196:199]
    v_permlane16_swap_b32 v99, v103
    v_mfma_f32_16x16x32_bf16 v[204:207], v[220:223], v[108:111], v[204:207]
    v_rcp_f32 v146, v146
    v_mul_f32 v177, v177, v145
    v_rcp_f32 v147, v147
    v_mul_f32 v178, v178, v146
    v_rcp_f32 v148, v148
    ds_read_b64_tr_b16 v[220:221], v229 offset:41472
    ds_read_b64_tr_b16 v[222:223], v229 offset:41728
    s_waitcnt lgkmcnt(6)
    v_mfma_f32_16x16x32_bf16 v[160:163], v[208:211], v[112:115], v[160:163]
    v_permlane16_swap_b32 v104, v108
    v_mfma_f32_16x16x32_bf16 v[168:171], v[208:211], v[116:119], v[168:171]
    v_mul_f32 v179, v179, v147
    v_rcp_f32 v149, v149
    v_mul_f32 v180, v180, v148
    v_rcp_f32 v150, v150
    v_mul_f32 v181, v181, v149
    ds_read_b64_tr_b16 v[208:209], v228 offset:37376
    ds_read_b64_tr_b16 v[210:211], v228 offset:37632
    s_waitcnt lgkmcnt(6)
    v_mfma_f32_16x16x32_bf16 v[192:195], v[212:215], v[112:115], v[192:195]
    v_permlane16_swap_b32 v105, v109
    v_mfma_f32_16x16x32_bf16 v[200:203], v[212:215], v[116:119], v[200:203]
    v_rcp_f32 v151, v151
    v_mul_f32 v182, v182, v150
    v_mul_f32 v183, v183, v151
    v_cvt_pk_bf16_f32 v144, v176, v177
    v_cvt_pk_bf16_f32 v145, v178, v179
    ds_read_b64_tr_b16 v[212:213], v228 offset:45568
    ds_read_b64_tr_b16 v[214:215], v228 offset:45824
    s_waitcnt lgkmcnt(6)
    v_mfma_f32_16x16x32_bf16 v[164:167], v[216:219], v[112:115], v[164:167]
    v_permlane16_swap_b32 v106, v110
    v_mfma_f32_16x16x32_bf16 v[172:175], v[216:219], v[116:119], v[172:175]
    v_cvt_pk_bf16_f32 v146, v180, v181
    v_cvt_pk_bf16_f32 v147, v182, v183
    buffer_store_dwordx4 v[144:147], v238, s[48:51], s67 offen offset:0 sc1
    v_mul_f32 v184, v152, v184
    v_mul_f32 v152, s64, v152
    ds_read_b64_tr_b16 v[216:217], v229 offset:37376
    ds_read_b64_tr_b16 v[218:219], v229 offset:37632
    s_waitcnt lgkmcnt(6)
    v_mfma_f32_16x16x32_bf16 v[196:199], v[220:223], v[112:115], v[196:199]
    v_permlane16_swap_b32 v107, v111
    v_mfma_f32_16x16x32_bf16 v[204:207], v[220:223], v[116:119], v[204:207]
    v_mul_f32 v185, v153, v185
    v_mul_f32 v153, s64, v153
    v_mul_f32 v186, v154, v186
    v_mul_f32 v154, s64, v154
    v_mul_f32 v187, v155, v187
    ds_read_b64_tr_b16 v[220:221], v229 offset:45568
    ds_read_b64_tr_b16 v[222:223], v229 offset:45824
    s_waitcnt lgkmcnt(6)
    v_mfma_f32_16x16x32_bf16 v[160:163], v[208:211], v[120:123], v[160:163]
    v_permlane16_swap_b32 v112, v116
    v_mfma_f32_16x16x32_bf16 v[168:171], v[208:211], v[124:127], v[168:171]
    v_mul_f32 v155, s64, v155
    v_mul_f32 v188, v156, v188
    v_mul_f32 v156, s64, v156
    v_mul_f32 v189, v157, v189
    v_mul_f32 v157, s64, v157
    ds_read_b64_tr_b16 v[208:209], v228 offset:49664
    ds_read_b64_tr_b16 v[210:211], v228 offset:49920
    s_waitcnt lgkmcnt(6)
    v_mfma_f32_16x16x32_bf16 v[192:195], v[212:215], v[120:123], v[192:195]
    v_permlane16_swap_b32 v113, v117
    v_mfma_f32_16x16x32_bf16 v[200:203], v[212:215], v[124:127], v[200:203]
    v_mul_f32 v190, v158, v190
    v_mul_f32 v158, s64, v158
    v_mul_f32 v191, v159, v191
    v_mul_f32 v159, s64, v159
    v_exp_f32 v152, v152
    ds_read_b64_tr_b16 v[212:213], v228 offset:57856
    ds_read_b64_tr_b16 v[214:215], v228 offset:58112
    s_waitcnt lgkmcnt(6)
    v_mfma_f32_16x16x32_bf16 v[164:167], v[216:219], v[120:123], v[164:167]
    v_permlane16_swap_b32 v114, v118
    v_mfma_f32_16x16x32_bf16 v[172:175], v[216:219], v[124:127], v[172:175]
    v_exp_f32 v153, v153
    v_add_f32 v152, 1.0, v152
    v_exp_f32 v154, v154
    v_add_f32 v153, 1.0, v153
    ds_read_b64_tr_b16 v[216:217], v229 offset:49664
    ds_read_b64_tr_b16 v[218:219], v229 offset:49920
    s_waitcnt lgkmcnt(6)
    v_mfma_f32_16x16x32_bf16 v[196:199], v[220:223], v[120:123], v[196:199]
    v_permlane16_swap_b32 v115, v119
    v_mfma_f32_16x16x32_bf16 v[204:207], v[220:223], v[124:127], v[204:207]
    v_exp_f32 v155, v155
    v_add_f32 v154, 1.0, v154
    v_exp_f32 v156, v156
    v_add_f32 v155, 1.0, v155
    s_waitcnt vmcnt(7)
    s_waitcnt vmcnt(3)
    s_barrier
    ds_read_b64_tr_b16 v[220:221], v229 offset:57856
    ds_read_b64_tr_b16 v[222:223], v229 offset:58112
    s_waitcnt lgkmcnt(6)
    v_mfma_f32_16x16x32_bf16 v[160:163], v[208:211], v[128:131], v[160:163]
    v_permlane16_swap_b32 v120, v124
    v_mfma_f32_16x16x32_bf16 v[168:171], v[208:211], v[132:135], v[168:171]
    v_exp_f32 v157, v157
    v_add_f32 v156, 1.0, v156
    v_exp_f32 v158, v158
    v_add_f32 v157, 1.0, v157
    ds_read_b64_tr_b16 v[208:209], v228 offset:53760
    ds_read_b64_tr_b16 v[210:211], v228 offset:54016
    s_waitcnt lgkmcnt(6)
    v_mfma_f32_16x16x32_bf16 v[192:195], v[212:215], v[128:131], v[192:195]
    v_permlane16_swap_b32 v121, v125
    v_mfma_f32_16x16x32_bf16 v[200:203], v[212:215], v[132:135], v[200:203]
    v_exp_f32 v159, v159
    v_add_f32 v158, 1.0, v158
    v_add_f32 v159, 1.0, v159
    v_rcp_f32 v152, v152
    ds_read_b64_tr_b16 v[212:213], v228 offset:61952
    ds_read_b64_tr_b16 v[214:215], v228 offset:62208
    s_waitcnt lgkmcnt(6)
    v_mfma_f32_16x16x32_bf16 v[164:167], v[216:219], v[128:131], v[164:167]
    v_permlane16_swap_b32 v122, v126
    v_mfma_f32_16x16x32_bf16 v[172:175], v[216:219], v[132:135], v[172:175]
    s_add_u32 s25, s66, 0xd8000
    s_add_u32 m0, s24, 16384
    s_mov_b64 exec, s[68:69]
    buffer_load_dwordx4 v233, s[40:43], s25 offen lds
    s_mov_b64 exec, -1
    v_rcp_f32 v153, v153
    v_mul_f32 v184, v184, v152
    v_rcp_f32 v154, v154
    v_mul_f32 v185, v185, v153
    ds_read_b64_tr_b16 v[216:217], v229 offset:53760
    ds_read_b64_tr_b16 v[218:219], v229 offset:54016
    s_waitcnt lgkmcnt(6)
    v_mfma_f32_16x16x32_bf16 v[196:199], v[220:223], v[128:131], v[196:199]
    v_permlane16_swap_b32 v123, v127
    v_mfma_f32_16x16x32_bf16 v[204:207], v[220:223], v[132:135], v[204:207]
    v_rcp_f32 v155, v155
    v_mul_f32 v186, v186, v154
    v_rcp_f32 v156, v156
    v_mul_f32 v187, v187, v155
    s_mov_b64 exec, s[72:73]
    ds_read_b128 v[240:243], v248 offset:0
    s_mov_b64 exec, -1
    s_mov_b64 exec, s[72:73]
    ds_read_b128 v[244:247], v248 offset:512
    s_mov_b64 exec, -1
    ds_read_b64_tr_b16 v[220:221], v229 offset:61952
    ds_read_b64_tr_b16 v[222:223], v229 offset:62208
    s_waitcnt lgkmcnt(8)
    v_mfma_f32_16x16x32_bf16 v[160:163], v[208:211], v[136:139], v[160:163]
    v_permlane16_swap_b32 v128, v132
    v_mfma_f32_16x16x32_bf16 v[168:171], v[208:211], v[140:143], v[168:171]
    v_rcp_f32 v157, v157
    v_mul_f32 v188, v188, v156
    v_rcp_f32 v158, v158
    v_mul_f32 v189, v189, v157
    v_xor_b32 v228, 0x10000, v228
    v_xor_b32 v229, 0x10000, v229
    v_xor_b32 v230, 0x10000, v230
    v_xor_b32 v231, 0x10000, v231
    v_xor_b32 v249, 0x10000, v249
    ds_read_b64_tr_b16 v[208:209], v249 offset:8192
    ds_read_b64_tr_b16 v[210:211], v249 offset:8704
    s_waitcnt lgkmcnt(8)
    v_mfma_f32_16x16x32_bf16 v[192:195], v[212:215], v[136:139], v[192:195]
    v_permlane16_swap_b32 v129, v133
    v_mfma_f32_16x16x32_bf16 v[200:203], v[212:215], v[140:143], v[200:203]
    s_add_u32 m0, s24, 24576
    s_mov_b64 exec, s[30:31]
    global_load_lds_dwordx4 v[234:235], off
    s_mov_b64 exec, -1
    v_add_co_u32 v234, s[70:71], v234, v236
    s_nop 1
    v_addc_co_u32 v235, s[70:71], 0, v235, s[70:71]
    v_rcp_f32 v159, v159
    v_mul_f32 v190, v190, v158
    v_mul_f32 v191, v191, v159
    v_cvt_pk_bf16_f32 v152, v184, v185
    ds_read_b64_tr_b16 v[212:213], v231 offset:0
    ds_read_b64_tr_b16 v[214:215], v231 offset:512
    s_waitcnt lgkmcnt(8)
    v_mfma_f32_16x16x32_bf16 v[164:167], v[216:219], v[136:139], v[164:167]
    v_permlane16_swap_b32 v130, v134
    v_mfma_f32_16x16x32_bf16 v[172:175], v[216:219], v[140:143], v[172:175]
    v_cvt_pk_bf16_f32 v153, v186, v187
    v_cvt_pk_bf16_f32 v154, v188, v189
    v_cvt_pk_bf16_f32 v155, v190, v191
    buffer_store_dwordx4 v[152:155], v238, s[48:51], s98 offen offset:0 sc1
    ds_read_b64_tr_b16 v[216:217], v249 offset:10240
    ds_read_b64_tr_b16 v[218:219], v249 offset:10752
    s_waitcnt lgkmcnt(6)
    v_mfma_f32_16x16x32_bf16 v[196:199], v[220:223], v[136:139], v[196:199]
    v_permlane16_swap_b32 v131, v135
    v_mfma_f32_16x16x32_bf16 v[204:207], v[220:223], v[140:143], v[204:207]
    ds_read_b64_tr_b16 v[220:221], v231 offset:2048
    ds_read_b64_tr_b16 v[222:223], v231 offset:2560
    s_waitcnt lgkmcnt(6)
    v_mfma_f32_32x32x16_bf16 v[144:159], v[208:211], v[0:3], 0
    v_permlane16_swap_b32 v136, v140
    v_permlane16_swap_b32 v137, v141
    s_add_u32 s25, s66, 0x10e000
    s_add_u32 m0, s24, 32768
    s_mov_b64 exec, s[68:69]
    buffer_load_dwordx4 v233, s[40:43], s25 offen lds
    s_mov_b64 exec, -1
    ds_read_b64_tr_b16 v[208:209], v249 offset:12288
    ds_read_b64_tr_b16 v[210:211], v249 offset:12800
    s_waitcnt lgkmcnt(6)
    v_mfma_f32_32x32x16_bf16 v[176:191], v[212:215], v[0:3], 0
    v_permlane16_swap_b32 v138, v142
    v_permlane16_swap_b32 v139, v143
    v_mul_f32 v192, v160, v192
    v_mul_f32 v160, s64, v160
    v_mul_f32 v193, v161, v193
    v_mul_f32 v161, s64, v161
    v_mul_f32 v194, v162, v194
    ds_read_b64_tr_b16 v[212:213], v231 offset:4096
    ds_read_b64_tr_b16 v[214:215], v231 offset:4608
    s_waitcnt lgkmcnt(6)
    v_mfma_f32_32x32x16_bf16 v[144:159], v[216:219], v[4:7], v[144:159]
    v_mul_f32 v162, s64, v162
    v_mul_f32 v195, v163, v195
    v_mul_f32 v163, s64, v163
    v_mul_f32 v196, v164, v196
    v_mul_f32 v164, s64, v164
    ds_read_b64_tr_b16 v[216:217], v249 offset:14336
    ds_read_b64_tr_b16 v[218:219], v249 offset:14848
    s_waitcnt lgkmcnt(6)
    v_mfma_f32_32x32x16_bf16 v[176:191], v[220:223], v[4:7], v[176:191]
    v_mul_f32 v197, v165, v197
    v_mul_f32 v165, s64, v165
    v_mul_f32 v198, v166, v198
    v_mul_f32 v166, s64, v166
    v_mul_f32 v199, v167, v199
    ds_read_b64_tr_b16 v[220:221], v231 offset:6144
    ds_read_b64_tr_b16 v[222:223], v231 offset:6656
    s_waitcnt lgkmcnt(6)
    v_mfma_f32_32x32x16_bf16 v[144:159], v[208:211], v[8:11], v[144:159]
    s_add_u32 m0, s24, 40960
    s_mov_b64 exec, s[30:31]
    global_load_lds_dwordx4 v[234:235], off
    s_mov_b64 exec, -1
    v_add_co_u32 v234, s[70:71], v234, v236
    s_nop 1
    v_addc_co_u32 v235, s[70:71], 0, v235, s[70:71]
    v_mul_f32 v167, s64, v167
    v_exp_f32 v160, v160
    v_exp_f32 v161, v161
    v_add_f32 v160, 1.0, v160
    v_exp_f32 v162, v162
    ds_read_b64_tr_b16 v[208:209], v249 offset:24576
    ds_read_b64_tr_b16 v[210:211], v249 offset:25088
    s_waitcnt lgkmcnt(6)
    v_mfma_f32_32x32x16_bf16 v[176:191], v[212:215], v[8:11], v[176:191]
    v_add_f32 v161, 1.0, v161
    v_exp_f32 v163, v163
    v_add_f32 v162, 1.0, v162
    v_exp_f32 v164, v164
    v_add_f32 v163, 1.0, v163
    s_barrier
    ds_read_b64_tr_b16 v[212:213], v231 offset:16384
    ds_read_b64_tr_b16 v[214:215], v231 offset:16896
    s_waitcnt lgkmcnt(6)
    v_mfma_f32_32x32x16_bf16 v[144:159], v[216:219], v[12:15], v[144:159]
    v_exp_f32 v165, v165
    v_add_f32 v164, 1.0, v164
    v_exp_f32 v166, v166
    v_add_f32 v165, 1.0, v165
    v_exp_f32 v167, v167
    ds_read_b64_tr_b16 v[216:217], v249 offset:26624
    ds_read_b64_tr_b16 v[218:219], v249 offset:27136
    s_waitcnt lgkmcnt(6)
    v_mfma_f32_32x32x16_bf16 v[176:191], v[220:223], v[12:15], v[176:191]
    v_add_f32 v166, 1.0, v166
    v_add_f32 v167, 1.0, v167
    v_rcp_f32 v160, v160
    v_rcp_f32 v161, v161
    v_mul_f32 v192, v192, v160
    ds_read_b64_tr_b16 v[220:221], v231 offset:18432
    ds_read_b64_tr_b16 v[222:223], v231 offset:18944
    s_waitcnt lgkmcnt(6)
    v_mfma_f32_32x32x16_bf16 v[144:159], v[208:211], v[16:19], v[144:159]
    v_rcp_f32 v162, v162
    v_mul_f32 v193, v193, v161
    v_rcp_f32 v163, v163
    v_mul_f32 v194, v194, v162
    v_rcp_f32 v164, v164
    ds_read_b64_tr_b16 v[208:209], v249 offset:28672
    ds_read_b64_tr_b16 v[210:211], v249 offset:29184
    s_waitcnt lgkmcnt(6)
    v_mfma_f32_32x32x16_bf16 v[176:191], v[212:215], v[16:19], v[176:191]
    v_mul_f32 v195, v195, v163
    v_rcp_f32 v165, v165
    v_mul_f32 v196, v196, v164
    v_rcp_f32 v166, v166
    v_mul_f32 v197, v197, v165
    ds_read_b64_tr_b16 v[212:213], v231 offset:20480
    ds_read_b64_tr_b16 v[214:215], v231 offset:20992
    s_waitcnt lgkmcnt(6)
    v_mfma_f32_32x32x16_bf16 v[144:159], v[216:219], v[20:23], v[144:159]
    s_add_u32 s25, s66, 0x144000
    s_add_u32 m0, s24, 49152
    s_mov_b64 exec, s[68:69]
    buffer_load_dwordx4 v233, s[40:43], s25 offen lds
    s_mov_b64 exec, -1
    v_rcp_f32 v167, v167
    v_mul_f32 v198, v198, v166
    v_mul_f32 v199, v199, v167
    v_cvt_pk_bf16_f32 v160, v192, v193
    v_cvt_pk_bf16_f32 v161, v194, v195
    ds_read_b64_tr_b16 v[216:217], v249 offset:30720
    ds_read_b64_tr_b16 v[218:219], v249 offset:31232
    s_waitcnt lgkmcnt(6)
    v_mfma_f32_32x32x16_bf16 v[176:191], v[220:223], v[20:23], v[176:191]
    v_cvt_pk_bf16_f32 v162, v196, v197
    v_cvt_pk_bf16_f32 v163, v198, v199
    buffer_store_dwordx4 v[160:163], v238, s[48:51], s67 offen offset:1024 sc1
    v_mul_f32 v200, v168, v200
    v_mul_f32 v168, s64, v168
    ds_read_b64_tr_b16 v[220:221], v231 offset:22528
    ds_read_b64_tr_b16 v[222:223], v231 offset:23040
    s_waitcnt lgkmcnt(6)
    v_mfma_f32_32x32x16_bf16 v[144:159], v[208:211], v[24:27], v[144:159]
    v_mul_f32 v201, v169, v201
    v_mul_f32 v169, s64, v169
    v_mul_f32 v202, v170, v202
    v_mul_f32 v170, s64, v170
    v_mul_f32 v203, v171, v203
    ds_read_b64_tr_b16 v[208:209], v249 offset:40960
    ds_read_b64_tr_b16 v[210:211], v249 offset:41472
    s_waitcnt lgkmcnt(6)
    v_mfma_f32_32x32x16_bf16 v[176:191], v[212:215], v[24:27], v[176:191]
    v_mul_f32 v171, s64, v171
    v_mul_f32 v204, v172, v204
    v_mul_f32 v172, s64, v172
    v_mul_f32 v205, v173, v205
    v_mul_f32 v173, s64, v173
    ds_read_b64_tr_b16 v[212:213], v231 offset:32768
    ds_read_b64_tr_b16 v[214:215], v231 offset:33280
    s_waitcnt lgkmcnt(6)
    v_mfma_f32_32x32x16_bf16 v[144:159], v[216:219], v[28:31], v[144:159]
    v_mul_f32 v206, v174, v206
    v_mul_f32 v174, s64, v174
    v_mul_f32 v207, v175, v207
    v_mul_f32 v175, s64, v175
    v_exp_f32 v168, v168
    ds_read_b64_tr_b16 v[216:217], v249 offset:43008
    ds_read_b64_tr_b16 v[218:219], v249 offset:43520
    s_waitcnt lgkmcnt(6)
    v_mfma_f32_32x32x16_bf16 v[176:191], v[220:223], v[28:31], v[176:191]
    s_add_u32 m0, s24, 57344
    s_mov_b64 exec, s[30:31]
    global_load_lds_dwordx4 v[234:235], off
    s_mov_b64 exec, -1
    v_add_co_u32 v234, s[70:71], v234, v236
    s_nop 1
    v_addc_co_u32 v235, s[70:71], 0, v235, s[70:71]
    v_exp_f32 v169, v169
    v_add_f32 v168, 1.0, v168
    v_exp_f32 v170, v170
    v_add_f32 v169, 1.0, v169
    v_exp_f32 v171, v171
    ds_read_b64_tr_b16 v[220:221], v231 offset:34816
    ds_read_b64_tr_b16 v[222:223], v231 offset:35328
    s_waitcnt lgkmcnt(6)
    v_mfma_f32_32x32x16_bf16 v[144:159], v[208:211], v[32:35], v[144:159]
    v_add_f32 v170, 1.0, v170
    v_exp_f32 v172, v172
    v_add_f32 v171, 1.0, v171
    v_exp_f32 v173, v173
    v_add_f32 v172, 1.0, v172
    ds_read_b64_tr_b16 v[208:209], v249 offset:45056
    ds_read_b64_tr_b16 v[210:211], v249 offset:45568
    s_waitcnt lgkmcnt(6)
    v_mfma_f32_32x32x16_bf16 v[176:191], v[212:215], v[32:35], v[176:191]
    v_exp_f32 v174, v174
    v_add_f32 v173, 1.0, v173
    v_exp_f32 v175, v175
    v_add_f32 v174, 1.0, v174
    v_add_f32 v175, 1.0, v175
    s_barrier
    ds_read_b64_tr_b16 v[212:213], v231 offset:36864
    ds_read_b64_tr_b16 v[214:215], v231 offset:37376
    s_waitcnt lgkmcnt(6)
    v_mfma_f32_32x32x16_bf16 v[144:159], v[216:219], v[36:39], v[144:159]
    v_rcp_f32 v168, v168
    v_rcp_f32 v169, v169
    v_mul_f32 v200, v200, v168
    v_rcp_f32 v170, v170
    v_mul_f32 v201, v201, v169
    ds_read_b64_tr_b16 v[216:217], v249 offset:47104
    ds_read_b64_tr_b16 v[218:219], v249 offset:47616
    s_waitcnt lgkmcnt(6)
    v_mfma_f32_32x32x16_bf16 v[176:191], v[220:223], v[36:39], v[176:191]
    v_rcp_f32 v171, v171
    v_mul_f32 v202, v202, v170
    v_rcp_f32 v172, v172
    v_mul_f32 v203, v203, v171
    ds_read_b64_tr_b16 v[220:221], v231 offset:38912
    ds_read_b64_tr_b16 v[222:223], v231 offset:39424
    s_waitcnt lgkmcnt(6)
    v_mfma_f32_32x32x16_bf16 v[144:159], v[208:211], v[40:43], v[144:159]
    v_rcp_f32 v173, v173
    v_mul_f32 v204, v204, v172
    v_rcp_f32 v174, v174
    v_mul_f32 v205, v205, v173
    ds_read_b64_tr_b16 v[208:209], v230 offset:0
    ds_read_b64_tr_b16 v[210:211], v230 offset:512
    s_waitcnt lgkmcnt(6)
    v_mfma_f32_32x32x16_bf16 v[176:191], v[212:215], v[40:43], v[176:191]
    v_rcp_f32 v175, v175
    v_mul_f32 v206, v206, v174
    v_mul_f32 v207, v207, v175
    v_cvt_pk_bf16_f32 v168, v200, v201
    ds_read_b64_tr_b16 v[212:213], v230 offset:2048
    ds_read_b64_tr_b16 v[214:215], v230 offset:2560
    s_waitcnt lgkmcnt(6)
    v_mfma_f32_32x32x16_bf16 v[144:159], v[216:219], v[44:47], v[144:159]
    v_cvt_pk_bf16_f32 v169, v202, v203
    v_cvt_pk_bf16_f32 v170, v204, v205
    v_cvt_pk_bf16_f32 v171, v206, v207
    buffer_store_dwordx4 v[168:171], v238, s[48:51], s98 offen offset:1024 sc1
    ds_read_b64_tr_b16 v[216:217], v230 offset:4096
    ds_read_b64_tr_b16 v[218:219], v230 offset:4608
    s_waitcnt lgkmcnt(6)
    v_mfma_f32_32x32x16_bf16 v[176:191], v[220:223], v[44:47], v[176:191]
    ds_read_b64_tr_b16 v[220:221], v230 offset:6144
    ds_read_b64_tr_b16 v[222:223], v230 offset:6656
    s_waitcnt lgkmcnt(6)
    v_mfma_f32_16x16x32_bf16 v[224:227], v[208:211], v[240:243], 0
    v_mfma_f32_32x32x16_bf16 v[160:175], v[208:211], v[0:3], 0
    s_mov_b64 exec, s[72:73]
    ds_read_b128 v[240:243], v248 offset:1024
    s_mov_b64 exec, -1
    ds_read_b64_tr_b16 v[208:209], v230 offset:16384
    ds_read_b64_tr_b16 v[210:211], v230 offset:16896
    s_waitcnt lgkmcnt(7)
    v_mfma_f32_16x16x32_bf16 v[224:227], v[212:215], v[244:247], v[224:227]
    v_mfma_f32_32x32x16_bf16 v[160:175], v[212:215], v[4:7], v[160:175]
    s_mov_b64 exec, s[72:73]
    ds_read_b128 v[244:247], v248 offset:1536
    s_mov_b64 exec, -1
    ds_read_b64_tr_b16 v[212:213], v230 offset:18432
    ds_read_b64_tr_b16 v[214:215], v230 offset:18944
    s_waitcnt lgkmcnt(8)
    s_waitcnt lgkmcnt(5)
    v_mfma_f32_16x16x32_bf16 v[224:227], v[216:219], v[240:243], v[224:227]
    v_mfma_f32_32x32x16_bf16 v[160:175], v[216:219], v[8:11], v[160:175]
    s_mov_b64 exec, s[72:73]
    ds_read_b128 v[240:243], v248 offset:2048
    s_mov_b64 exec, -1
    ds_read_b64_tr_b16 v[216:217], v230 offset:20480
    ds_read_b64_tr_b16 v[218:219], v230 offset:20992
    s_waitcnt lgkmcnt(5)
    v_mfma_f32_16x16x32_bf16 v[224:227], v[220:223], v[244:247], v[224:227]
    v_mfma_f32_32x32x16_bf16 v[160:175], v[220:223], v[12:15], v[160:175]
    s_mov_b64 exec, s[72:73]
    ds_read_b128 v[244:247], v248 offset:2560
    s_mov_b64 exec, -1
    ds_read_b64_tr_b16 v[220:221], v230 offset:22528
    ds_read_b64_tr_b16 v[222:223], v230 offset:23040
    s_waitcnt lgkmcnt(5)
    v_mfma_f32_16x16x32_bf16 v[224:227], v[208:211], v[240:243], v[224:227]
    v_mfma_f32_32x32x16_bf16 v[160:175], v[208:211], v[16:19], v[160:175]
    s_mov_b64 exec, s[72:73]
    ds_read_b128 v[240:243], v248 offset:3072
    s_mov_b64 exec, -1
    ds_read_b64_tr_b16 v[208:209], v230 offset:32768
    ds_read_b64_tr_b16 v[210:211], v230 offset:33280
    s_waitcnt lgkmcnt(5)
    v_mfma_f32_16x16x32_bf16 v[224:227], v[212:215], v[244:247], v[224:227]
    v_mfma_f32_32x32x16_bf16 v[160:175], v[212:215], v[20:23], v[160:175]
    s_mov_b64 exec, s[72:73]
    ds_read_b128 v[244:247], v248 offset:3584
    s_mov_b64 exec, -1
    s_waitcnt vmcnt(10)
    s_barrier
    ds_read_b64_tr_b16 v[212:213], v230 offset:34816
    ds_read_b64_tr_b16 v[214:215], v230 offset:35328
    s_waitcnt lgkmcnt(5)
    v_mfma_f32_16x16x32_bf16 v[224:227], v[216:219], v[240:243], v[224:227]
    v_mfma_f32_32x32x16_bf16 v[160:175], v[216:219], v[24:27], v[160:175]
    s_mov_b64 exec, s[72:73]
    ds_read_b128 v[240:243], v248 offset:4096
    s_mov_b64 exec, -1
    ds_read_b64_tr_b16 v[216:217], v230 offset:36864
    ds_read_b64_tr_b16 v[218:219], v230 offset:37376
    s_waitcnt lgkmcnt(5)
    v_mfma_f32_16x16x32_bf16 v[224:227], v[220:223], v[244:247], v[224:227]
    v_mfma_f32_32x32x16_bf16 v[160:175], v[220:223], v[28:31], v[160:175]
    s_mov_b64 exec, s[72:73]
    ds_read_b128 v[244:247], v248 offset:4608
    s_mov_b64 exec, -1
    ds_read_b64_tr_b16 v[220:221], v230 offset:38912
    ds_read_b64_tr_b16 v[222:223], v230 offset:39424
    s_waitcnt lgkmcnt(5)
    v_mfma_f32_16x16x32_bf16 v[224:227], v[208:211], v[240:243], v[224:227]
    v_mfma_f32_32x32x16_bf16 v[160:175], v[208:211], v[32:35], v[160:175]
    s_mov_b64 exec, s[72:73]
    ds_read_b128 v[240:243], v248 offset:5120
    s_mov_b64 exec, -1
    v_xor_b32 v228, 0x10000, v228
    v_xor_b32 v229, 0x10000, v229
    v_xor_b32 v230, 0x10000, v230
    v_xor_b32 v231, 0x10000, v231
    v_xor_b32 v249, 0x10000, v249
    ds_read_b64_tr_b16 v[208:209], v249 offset:8192
    ds_read_b64_tr_b16 v[210:211], v249 offset:8704
    s_waitcnt lgkmcnt(5)
    v_mfma_f32_16x16x32_bf16 v[224:227], v[212:215], v[244:247], v[224:227]
    v_mfma_f32_32x32x16_bf16 v[160:175], v[212:215], v[36:39], v[160:175]
    s_mov_b64 exec, s[72:73]
    ds_read_b128 v[244:247], v248 offset:5632
    s_mov_b64 exec, -1
    ds_read_b64_tr_b16 v[212:213], v230 offset:0
    ds_read_b64_tr_b16 v[214:215], v230 offset:512
    s_waitcnt lgkmcnt(5)
    v_mfma_f32_16x16x32_bf16 v[224:227], v[216:219], v[240:243], v[224:227]
    v_mfma_f32_32x32x16_bf16 v[160:175], v[216:219], v[40:43], v[160:175]
    s_mov_b64 exec, s[72:73]
    ds_read_b128 v[240:243], v248 offset:6144
    s_mov_b64 exec, -1
    s_add_u32 s25, s66, 0x17a000
    s_add_u32 m0, s24, 65536
    s_mov_b64 exec, s[68:69]
    buffer_load_dwordx4 v233, s[40:43], s25 offen lds
    s_mov_b64 exec, -1
    ds_read_b64_tr_b16 v[216:217], v231 offset:0
    ds_read_b64_tr_b16 v[218:219], v231 offset:512
    s_waitcnt lgkmcnt(5)
    v_mfma_f32_16x16x32_bf16 v[224:227], v[220:223], v[244:247], v[224:227]
    v_mfma_f32_32x32x16_bf16 v[160:175], v[220:223], v[44:47], v[160:175]
    s_mov_b64 exec, s[72:73]
    ds_read_b128 v[244:247], v248 offset:6656
    s_mov_b64 exec, -1
    ds_read_b64_tr_b16 v[220:221], v249 offset:10240
    ds_read_b64_tr_b16 v[222:223], v249 offset:10752
    v_mfma_f32_32x32x16_bf16 v[144:159], v[208:211], v[48:51], v[144:159]
    ds_read_b64_tr_b16 v[208:209], v230 offset:2048
    ds_read_b64_tr_b16 v[210:211], v230 offset:2560
    s_waitcnt lgkmcnt(8)
    s_waitcnt lgkmcnt(7)
    v_mfma_f32_16x16x32_bf16 v[224:227], v[212:215], v[240:243], v[224:227]
    v_mfma_f32_32x32x16_bf16 v[160:175], v[212:215], v[48:51], v[160:175]
    s_mov_b64 exec, s[72:73]
    ds_read_b128 v[240:243], v248 offset:7168
    s_mov_b64 exec, -1
    ds_read_b64_tr_b16 v[212:213], v231 offset:2048
    ds_read_b64_tr_b16 v[214:215], v231 offset:2560
    s_waitcnt lgkmcnt(8)
    v_mfma_f32_32x32x16_bf16 v[176:191], v[216:219], v[48:51], v[176:191]
    ds_read_b64_tr_b16 v[216:217], v249 offset:12288
    ds_read_b64_tr_b16 v[218:219], v249 offset:12800
    s_waitcnt lgkmcnt(7)
    v_mfma_f32_32x32x16_bf16 v[144:159], v[220:223], v[52:55], v[144:159]
    s_add_u32 m0, s24, 73728
    s_mov_b64 exec, s[30:31]
    global_load_lds_dwordx4 v[234:235], off
    s_mov_b64 exec, -1
    v_add_co_u32 v234, s[70:71], v234, v236
    s_nop 1
    v_addc_co_u32 v235, s[70:71], 0, v235, s[70:71]
    ds_read_b64_tr_b16 v[220:221], v230 offset:4096
    ds_read_b64_tr_b16 v[222:223], v230 offset:4608
    s_waitcnt lgkmcnt(7)
    v_mfma_f32_16x16x32_bf16 v[224:227], v[208:211], v[244:247], v[224:227]
    v_mfma_f32_32x32x16_bf16 v[160:175], v[208:211], v[52:55], v[160:175]
    s_mov_b64 exec, s[72:73]
    ds_read_b128 v[244:247], v248 offset:7680
    s_mov_b64 exec, -1
    ds_read_b64_tr_b16 v[208:209], v231 offset:4096
    ds_read_b64_tr_b16 v[210:211], v231 offset:4608
    s_waitcnt lgkmcnt(7)
    v_mfma_f32_32x32x16_bf16 v[176:191], v[212:215], v[52:55], v[176:191]
    s_waitcnt vmcnt(9)
    s_waitcnt vmcnt(2)
    s_barrier
    ds_read_b64_tr_b16 v[212:213], v249 offset:14336
    ds_read_b64_tr_b16 v[214:215], v249 offset:14848
    s_waitcnt lgkmcnt(7)
    v_mfma_f32_32x32x16_bf16 v[144:159], v[216:219], v[56:59], v[144:159]
    ds_read_b64_tr_b16 v[216:217], v230 offset:6144
    ds_read_b64_tr_b16 v[218:219], v230 offset:6656
    s_waitcnt lgkmcnt(7)
    v_mfma_f32_16x16x32_bf16 v[224:227], v[220:223], v[240:243], v[224:227]
    v_mfma_f32_32x32x16_bf16 v[160:175], v[220:223], v[56:59], v[160:175]
    s_mov_b64 exec, s[72:73]
    ds_read_b128 v[240:243], v248 offset:8192
    s_mov_b64 exec, -1
    ds_read_b64_tr_b16 v[220:221], v231 offset:6144
    ds_read_b64_tr_b16 v[222:223], v231 offset:6656
    s_waitcnt lgkmcnt(7)
    v_mfma_f32_32x32x16_bf16 v[176:191], v[208:211], v[56:59], v[176:191]
    ds_read_b64_tr_b16 v[208:209], v249 offset:24576
    ds_read_b64_tr_b16 v[210:211], v249 offset:25088
    s_waitcnt lgkmcnt(7)
    v_mfma_f32_32x32x16_bf16 v[144:159], v[212:215], v[60:63], v[144:159]
    ds_read_b64_tr_b16 v[212:213], v230 offset:16384
    ds_read_b64_tr_b16 v[214:215], v230 offset:16896
    s_waitcnt lgkmcnt(7)
    v_mfma_f32_16x16x32_bf16 v[224:227], v[216:219], v[244:247], v[224:227]
    v_mfma_f32_32x32x16_bf16 v[160:175], v[216:219], v[60:63], v[160:175]
    s_mov_b64 exec, s[72:73]
    ds_read_b128 v[244:247], v248 offset:8704
    s_mov_b64 exec, -1
    s_add_u32 s25, s66, 0x1b0000
    s_add_u32 m0, s24, 81920
    s_mov_b64 exec, s[68:69]
    buffer_load_dwordx4 v233, s[40:43], s25 offen lds
    s_mov_b64 exec, -1
    ds_read_b64_tr_b16 v[216:217], v231 offset:16384
    ds_read_b64_tr_b16 v[218:219], v231 offset:16896
    s_waitcnt lgkmcnt(7)
    v_mfma_f32_32x32x16_bf16 v[176:191], v[220:223], v[60:63], v[176:191]
    ds_read_b64_tr_b16 v[220:221], v249 offset:26624
    ds_read_b64_tr_b16 v[222:223], v249 offset:27136
    s_waitcnt lgkmcnt(7)
    v_mfma_f32_32x32x16_bf16 v[144:159], v[208:211], v[64:67], v[144:159]
    ds_read_b64_tr_b16 v[208:209], v230 offset:18432
    ds_read_b64_tr_b16 v[210:211], v230 offset:18944
    s_waitcnt lgkmcnt(7)
    v_mfma_f32_16x16x32_bf16 v[224:227], v[212:215], v[240:243], v[224:227]
    v_mfma_f32_32x32x16_bf16 v[160:175], v[212:215], v[64:67], v[160:175]
    s_mov_b64 exec, s[72:73]
    ds_read_b128 v[240:243], v248 offset:9216
    s_mov_b64 exec, -1
    ds_read_b64_tr_b16 v[212:213], v231 offset:18432
    ds_read_b64_tr_b16 v[214:215], v231 offset:18944
    s_waitcnt lgkmcnt(7)
    v_mfma_f32_32x32x16_bf16 v[176:191], v[216:219], v[64:67], v[176:191]
    ds_read_b64_tr_b16 v[216:217], v249 offset:28672
    ds_read_b64_tr_b16 v[218:219], v249 offset:29184
    s_waitcnt lgkmcnt(7)
    v_mfma_f32_32x32x16_bf16 v[144:159], v[220:223], v[68:71], v[144:159]
    s_add_u32 m0, s24, 90112
    s_mov_b64 exec, s[30:31]
    global_load_lds_dwordx4 v[234:235], off
    s_mov_b64 exec, -1
    ds_read_b64_tr_b16 v[220:221], v230 offset:20480
    ds_read_b64_tr_b16 v[222:223], v230 offset:20992
    s_waitcnt lgkmcnt(7)
    v_mfma_f32_16x16x32_bf16 v[224:227], v[208:211], v[244:247], v[224:227]
    v_mfma_f32_32x32x16_bf16 v[160:175], v[208:211], v[68:71], v[160:175]
    s_mov_b64 exec, s[72:73]
    ds_read_b128 v[244:247], v248 offset:9728
    s_mov_b64 exec, -1
    ds_read_b64_tr_b16 v[208:209], v231 offset:20480
    ds_read_b64_tr_b16 v[210:211], v231 offset:20992
    s_waitcnt lgkmcnt(7)
    v_mfma_f32_32x32x16_bf16 v[176:191], v[212:215], v[68:71], v[176:191]
    s_barrier
    ds_read_b64_tr_b16 v[212:213], v249 offset:30720
    ds_read_b64_tr_b16 v[214:215], v249 offset:31232
    s_waitcnt lgkmcnt(7)
    v_mfma_f32_32x32x16_bf16 v[144:159], v[216:219], v[72:75], v[144:159]
    ds_read_b64_tr_b16 v[216:217], v230 offset:22528
    ds_read_b64_tr_b16 v[218:219], v230 offset:23040
    s_waitcnt lgkmcnt(7)
    v_mfma_f32_16x16x32_bf16 v[224:227], v[220:223], v[240:243], v[224:227]
    v_mfma_f32_32x32x16_bf16 v[160:175], v[220:223], v[72:75], v[160:175]
    s_mov_b64 exec, s[72:73]
    ds_read_b128 v[240:243], v248 offset:10240
    s_mov_b64 exec, -1
    ds_read_b64_tr_b16 v[220:221], v231 offset:22528
    ds_read_b64_tr_b16 v[222:223], v231 offset:23040
    s_waitcnt lgkmcnt(7)
    v_mfma_f32_32x32x16_bf16 v[176:191], v[208:211], v[72:75], v[176:191]
    ds_read_b64_tr_b16 v[208:209], v249 offset:40960
    ds_read_b64_tr_b16 v[210:211], v249 offset:41472
    s_waitcnt lgkmcnt(7)
    v_mfma_f32_32x32x16_bf16 v[144:159], v[212:215], v[76:79], v[144:159]
    ds_read_b64_tr_b16 v[212:213], v230 offset:32768
    ds_read_b64_tr_b16 v[214:215], v230 offset:33280
    s_waitcnt lgkmcnt(7)
    v_mfma_f32_16x16x32_bf16 v[224:227], v[216:219], v[244:247], v[224:227]
    v_mfma_f32_32x32x16_bf16 v[160:175], v[216:219], v[76:79], v[160:175]
    s_mov_b64 exec, s[72:73]
    ds_read_b128 v[244:247], v248 offset:10752
    s_mov_b64 exec, -1
    ds_read_b64_tr_b16 v[216:217], v231 offset:32768
    ds_read_b64_tr_b16 v[218:219], v231 offset:33280
    s_waitcnt lgkmcnt(7)
    v_mfma_f32_32x32x16_bf16 v[176:191], v[220:223], v[76:79], v[176:191]
    ds_read_b64_tr_b16 v[220:221], v249 offset:43008
    ds_read_b64_tr_b16 v[222:223], v249 offset:43520
    s_waitcnt lgkmcnt(7)
    v_mfma_f32_32x32x16_bf16 v[144:159], v[208:211], v[80:83], v[144:159]
    ds_read_b64_tr_b16 v[208:209], v230 offset:34816
    ds_read_b64_tr_b16 v[210:211], v230 offset:35328
    s_waitcnt lgkmcnt(7)
    v_mfma_f32_16x16x32_bf16 v[224:227], v[212:215], v[240:243], v[224:227]
    v_mfma_f32_32x32x16_bf16 v[160:175], v[212:215], v[80:83], v[160:175]
    s_mov_b64 exec, s[72:73]
    ds_read_b128 v[240:243], v248 offset:11264
    s_mov_b64 exec, -1
    ds_read_b64_tr_b16 v[212:213], v231 offset:34816
    ds_read_b64_tr_b16 v[214:215], v231 offset:35328
    s_waitcnt lgkmcnt(7)
    v_mfma_f32_32x32x16_bf16 v[176:191], v[216:219], v[80:83], v[176:191]
    ds_read_b64_tr_b16 v[216:217], v249 offset:45056
    ds_read_b64_tr_b16 v[218:219], v249 offset:45568
    s_waitcnt lgkmcnt(7)
    v_mfma_f32_32x32x16_bf16 v[144:159], v[220:223], v[84:87], v[144:159]
    ds_read_b64_tr_b16 v[220:221], v230 offset:36864
    ds_read_b64_tr_b16 v[222:223], v230 offset:37376
    s_waitcnt lgkmcnt(7)
    v_mfma_f32_16x16x32_bf16 v[224:227], v[208:211], v[244:247], v[224:227]
    v_mfma_f32_32x32x16_bf16 v[160:175], v[208:211], v[84:87], v[160:175]
    s_mov_b64 exec, s[72:73]
    ds_read_b128 v[244:247], v248 offset:11776
    s_mov_b64 exec, -1
    ds_read_b64_tr_b16 v[208:209], v231 offset:36864
    ds_read_b64_tr_b16 v[210:211], v231 offset:37376
    s_waitcnt lgkmcnt(7)
    v_mfma_f32_32x32x16_bf16 v[176:191], v[212:215], v[84:87], v[176:191]
    s_barrier
    ds_read_b64_tr_b16 v[212:213], v249 offset:47104
    ds_read_b64_tr_b16 v[214:215], v249 offset:47616
    s_waitcnt lgkmcnt(7)
    v_mfma_f32_32x32x16_bf16 v[144:159], v[216:219], v[88:91], v[144:159]
    ds_read_b64_tr_b16 v[216:217], v230 offset:38912
    ds_read_b64_tr_b16 v[218:219], v230 offset:39424
    s_waitcnt lgkmcnt(7)
    v_mfma_f32_16x16x32_bf16 v[224:227], v[220:223], v[240:243], v[224:227]
    v_mfma_f32_32x32x16_bf16 v[160:175], v[220:223], v[88:91], v[160:175]
    s_mov_b64 exec, s[72:73]
    ds_read_b128 v[240:243], v248 offset:12288
    s_mov_b64 exec, -1
    ds_read_b64_tr_b16 v[220:221], v231 offset:38912
    ds_read_b64_tr_b16 v[222:223], v231 offset:39424
    s_waitcnt lgkmcnt(7)
    v_mfma_f32_32x32x16_bf16 v[176:191], v[208:211], v[88:91], v[176:191]
    ds_read_b64_tr_b16 v[208:209], v249 offset:57344
    ds_read_b64_tr_b16 v[210:211], v249 offset:57856
    s_waitcnt lgkmcnt(7)
    v_mfma_f32_32x32x16_bf16 v[144:159], v[212:215], v[92:95], v[144:159]
    ds_read_b64_tr_b16 v[212:213], v230 offset:49152
    ds_read_b64_tr_b16 v[214:215], v230 offset:49664
    s_waitcnt lgkmcnt(7)
    v_mfma_f32_16x16x32_bf16 v[224:227], v[216:219], v[244:247], v[224:227]
    v_mfma_f32_32x32x16_bf16 v[160:175], v[216:219], v[92:95], v[160:175]
    s_mov_b64 exec, s[72:73]
    ds_read_b128 v[244:247], v248 offset:12800
    s_mov_b64 exec, -1
    ds_read_b64_tr_b16 v[216:217], v231 offset:49152
    ds_read_b64_tr_b16 v[218:219], v231 offset:49664
    s_waitcnt lgkmcnt(7)
    v_mfma_f32_32x32x16_bf16 v[176:191], v[220:223], v[92:95], v[176:191]
    ds_read_b64_tr_b16 v[220:221], v249 offset:59392
    ds_read_b64_tr_b16 v[222:223], v249 offset:59904
    s_waitcnt lgkmcnt(7)
    v_mfma_f32_32x32x16_bf16 v[144:159], v[208:211], v[96:99], v[144:159]
    ds_read_b64_tr_b16 v[208:209], v230 offset:51200
    ds_read_b64_tr_b16 v[210:211], v230 offset:51712
    s_waitcnt lgkmcnt(7)
    v_mfma_f32_16x16x32_bf16 v[224:227], v[212:215], v[240:243], v[224:227]
    v_mfma_f32_32x32x16_bf16 v[160:175], v[212:215], v[96:99], v[160:175]
    s_mov_b64 exec, s[72:73]
    ds_read_b128 v[240:243], v248 offset:13312
    s_mov_b64 exec, -1
    ds_read_b64_tr_b16 v[212:213], v231 offset:51200
    ds_read_b64_tr_b16 v[214:215], v231 offset:51712
    s_waitcnt lgkmcnt(7)
    v_mfma_f32_32x32x16_bf16 v[176:191], v[216:219], v[96:99], v[176:191]
    ds_read_b64_tr_b16 v[216:217], v249 offset:61440
    ds_read_b64_tr_b16 v[218:219], v249 offset:61952
    s_waitcnt lgkmcnt(7)
    v_mfma_f32_32x32x16_bf16 v[144:159], v[220:223], v[100:103], v[144:159]
    ds_read_b64_tr_b16 v[220:221], v230 offset:53248
    ds_read_b64_tr_b16 v[222:223], v230 offset:53760
    s_waitcnt lgkmcnt(7)
    v_mfma_f32_16x16x32_bf16 v[224:227], v[208:211], v[244:247], v[224:227]
    v_mfma_f32_32x32x16_bf16 v[160:175], v[208:211], v[100:103], v[160:175]
    s_mov_b64 exec, s[72:73]
    ds_read_b128 v[244:247], v248 offset:13824
    s_mov_b64 exec, -1
    ds_read_b64_tr_b16 v[208:209], v231 offset:53248
    ds_read_b64_tr_b16 v[210:211], v231 offset:53760
    s_waitcnt lgkmcnt(7)
    v_mfma_f32_32x32x16_bf16 v[176:191], v[212:215], v[100:103], v[176:191]
    s_waitcnt vmcnt(2)
    s_barrier
    ds_read_b64_tr_b16 v[212:213], v249 offset:63488
    ds_read_b64_tr_b16 v[214:215], v249 offset:64000
    s_waitcnt lgkmcnt(7)
    v_mfma_f32_32x32x16_bf16 v[144:159], v[216:219], v[104:107], v[144:159]
    ds_read_b64_tr_b16 v[216:217], v230 offset:55296
    ds_read_b64_tr_b16 v[218:219], v230 offset:55808
    s_waitcnt lgkmcnt(7)
    v_mfma_f32_16x16x32_bf16 v[224:227], v[220:223], v[240:243], v[224:227]
    v_mfma_f32_32x32x16_bf16 v[160:175], v[220:223], v[104:107], v[160:175]
    s_mov_b64 exec, s[72:73]
    ds_read_b128 v[240:243], v248 offset:14336
    s_mov_b64 exec, -1
    ds_read_b64_tr_b16 v[220:221], v231 offset:55296
    ds_read_b64_tr_b16 v[222:223], v231 offset:55808
    s_waitcnt lgkmcnt(7)
    v_mfma_f32_32x32x16_bf16 v[176:191], v[208:211], v[104:107], v[176:191]
    v_xor_b32 v228, 0x10000, v228
    v_xor_b32 v229, 0x10000, v229
    v_xor_b32 v230, 0x10000, v230
    v_xor_b32 v231, 0x10000, v231
    v_xor_b32 v249, 0x10000, v249
    ds_read_b64_tr_b16 v[208:209], v249 offset:8192
    ds_read_b64_tr_b16 v[210:211], v249 offset:8704
    s_waitcnt lgkmcnt(7)
    v_mfma_f32_32x32x16_bf16 v[144:159], v[212:215], v[108:111], v[144:159]
    ds_read_b64_tr_b16 v[212:213], v230 offset:0
    ds_read_b64_tr_b16 v[214:215], v230 offset:512
    s_waitcnt lgkmcnt(7)
    v_mfma_f32_16x16x32_bf16 v[224:227], v[216:219], v[244:247], v[224:227]
    v_mfma_f32_32x32x16_bf16 v[160:175], v[216:219], v[108:111], v[160:175]
    s_mov_b64 exec, s[72:73]
    ds_read_b128 v[244:247], v248 offset:14848
    s_mov_b64 exec, -1
    ds_read_b64_tr_b16 v[216:217], v231 offset:0
    ds_read_b64_tr_b16 v[218:219], v231 offset:512
    s_waitcnt lgkmcnt(7)
    v_mfma_f32_32x32x16_bf16 v[176:191], v[220:223], v[108:111], v[176:191]
    ds_read_b64_tr_b16 v[220:221], v249 offset:10240
    ds_read_b64_tr_b16 v[222:223], v249 offset:10752
    s_waitcnt lgkmcnt(7)
    v_mfma_f32_32x32x16_bf16 v[144:159], v[208:211], v[112:115], v[144:159]
    ds_read_b64_tr_b16 v[208:209], v230 offset:2048
    ds_read_b64_tr_b16 v[210:211], v230 offset:2560
    s_waitcnt lgkmcnt(7)
    v_mfma_f32_16x16x32_bf16 v[224:227], v[212:215], v[240:243], v[224:227]
    v_mfma_f32_32x32x16_bf16 v[160:175], v[212:215], v[112:115], v[160:175]
    s_mov_b64 exec, s[72:73]
    ds_read_b128 v[240:243], v248 offset:15360
    s_mov_b64 exec, -1
    ds_read_b64_tr_b16 v[212:213], v231 offset:2048
    ds_read_b64_tr_b16 v[214:215], v231 offset:2560
    s_waitcnt lgkmcnt(7)
    v_mfma_f32_32x32x16_bf16 v[176:191], v[216:219], v[112:115], v[176:191]
    ds_read_b64_tr_b16 v[216:217], v249 offset:12288
    ds_read_b64_tr_b16 v[218:219], v249 offset:12800
    s_waitcnt lgkmcnt(7)
    v_mfma_f32_32x32x16_bf16 v[144:159], v[220:223], v[116:119], v[144:159]
    ds_read_b64_tr_b16 v[220:221], v230 offset:4096
    ds_read_b64_tr_b16 v[222:223], v230 offset:4608
    s_waitcnt lgkmcnt(7)
    v_mfma_f32_16x16x32_bf16 v[224:227], v[208:211], v[244:247], v[224:227]
    v_mfma_f32_32x32x16_bf16 v[160:175], v[208:211], v[116:119], v[160:175]
    s_mov_b64 exec, s[72:73]
    ds_read_b128 v[244:247], v248 offset:15872
    s_mov_b64 exec, -1
    ds_read_b64_tr_b16 v[208:209], v231 offset:4096
    ds_read_b64_tr_b16 v[210:211], v231 offset:4608
    s_waitcnt lgkmcnt(7)
    v_mfma_f32_32x32x16_bf16 v[176:191], v[212:215], v[116:119], v[176:191]
    s_waitcnt vmcnt(0)
    s_barrier
    s_cmp_ge_u32 s3, 6
    s_cbranch_scc0 K_NOMID
    s_and_b32 s25, s3, 1
    s_lshl_b32 s25, s25, 10
    buffer_load_dwordx4 v[250:253], v238, s[52:55], s25 offen offset:2048 sc1
K_NOMID:
    ds_read_b64_tr_b16 v[212:213], v249 offset:14336
    ds_read_b64_tr_b16 v[214:215], v249 offset:14848
    s_waitcnt lgkmcnt(7)
    v_mfma_f32_32x32x16_bf16 v[144:159], v[216:219], v[120:123], v[144:159]
    ds_read_b64_tr_b16 v[216:217], v230 offset:6144
    ds_read_b64_tr_b16 v[218:219], v230 offset:6656
    s_waitcnt lgkmcnt(7)
    v_mfma_f32_16x16x32_bf16 v[224:227], v[220:223], v[240:243], v[224:227]
    v_mfma_f32_32x32x16_bf16 v[160:175], v[220:223], v[120:123], v[160:175]
    s_mov_b64 exec, s[72:73]
    ds_read_b128 v[240:243], v248 offset:16384
    s_mov_b64 exec, -1
    ds_read_b64_tr_b16 v[220:221], v231 offset:6144
    ds_read_b64_tr_b16 v[222:223], v231 offset:6656
    s_waitcnt lgkmcnt(7)
    v_mfma_f32_32x32x16_bf16 v[176:191], v[208:211], v[120:123], v[176:191]
    ds_read_b64_tr_b16 v[208:209], v249 offset:24576
    ds_read_b64_tr_b16 v[210:211], v249 offset:25088
    s_waitcnt lgkmcnt(7)
    v_mfma_f32_32x32x16_bf16 v[144:159], v[212:215], v[124:127], v[144:159]
    ds_read_b64_tr_b16 v[212:213], v230 offset:16384
    ds_read_b64_tr_b16 v[214:215], v230 offset:16896
    s_waitcnt lgkmcnt(7)
    v_mfma_f32_16x16x32_bf16 v[224:227], v[216:219], v[244:247], v[224:227]
    v_mfma_f32_32x32x16_bf16 v[160:175], v[216:219], v[124:127], v[160:175]
    s_mov_b64 exec, s[72:73]
    ds_read_b128 v[244:247], v248 offset:16896
    s_mov_b64 exec, -1
    ds_read_b64_tr_b16 v[216:217], v231 offset:16384
    ds_read_b64_tr_b16 v[218:219], v231 offset:16896
    s_waitcnt lgkmcnt(7)
    v_mfma_f32_32x32x16_bf16 v[176:191], v[220:223], v[124:127], v[176:191]
    ds_read_b64_tr_b16 v[220:221], v249 offset:26624
    ds_read_b64_tr_b16 v[222:223], v249 offset:27136
    s_waitcnt lgkmcnt(7)
    v_mfma_f32_32x32x16_bf16 v[144:159], v[208:211], v[128:131], v[144:159]
    ds_read_b64_tr_b16 v[208:209], v230 offset:18432
    ds_read_b64_tr_b16 v[210:211], v230 offset:18944
    s_waitcnt lgkmcnt(7)
    v_mfma_f32_16x16x32_bf16 v[224:227], v[212:215], v[240:243], v[224:227]
    v_mfma_f32_32x32x16_bf16 v[160:175], v[212:215], v[128:131], v[160:175]
    s_mov_b64 exec, s[72:73]
    ds_read_b128 v[240:243], v248 offset:17408
    s_mov_b64 exec, -1
    ds_read_b64_tr_b16 v[212:213], v231 offset:18432
    ds_read_b64_tr_b16 v[214:215], v231 offset:18944
    s_waitcnt lgkmcnt(7)
    v_mfma_f32_32x32x16_bf16 v[176:191], v[216:219], v[128:131], v[176:191]
    ds_read_b64_tr_b16 v[216:217], v249 offset:28672
    ds_read_b64_tr_b16 v[218:219], v249 offset:29184
    s_waitcnt lgkmcnt(7)
    v_mfma_f32_32x32x16_bf16 v[144:159], v[220:223], v[132:135], v[144:159]
    ds_read_b64_tr_b16 v[220:221], v230 offset:20480
    ds_read_b64_tr_b16 v[222:223], v230 offset:20992
    s_waitcnt lgkmcnt(7)
    v_mfma_f32_16x16x32_bf16 v[224:227], v[208:211], v[244:247], v[224:227]
    v_mfma_f32_32x32x16_bf16 v[160:175], v[208:211], v[132:135], v[160:175]
    s_mov_b64 exec, s[72:73]
    ds_read_b128 v[244:247], v248 offset:17920
    s_mov_b64 exec, -1
    ds_read_b64_tr_b16 v[208:209], v231 offset:20480
    ds_read_b64_tr_b16 v[210:211], v231 offset:20992
    s_waitcnt lgkmcnt(7)
    v_mfma_f32_32x32x16_bf16 v[176:191], v[212:215], v[132:135], v[176:191]
    s_waitcnt lgkmcnt(2)
    s_barrier
    ds_read_b64_tr_b16 v[212:213], v249 offset:30720
    ds_read_b64_tr_b16 v[214:215], v249 offset:31232
    v_mfma_f32_32x32x16_bf16 v[144:159], v[216:219], v[136:139], v[144:159]
    ds_read_b64_tr_b16 v[216:217], v230 offset:22528
    ds_read_b64_tr_b16 v[218:219], v230 offset:23040
    v_mfma_f32_16x16x32_bf16 v[224:227], v[220:223], v[240:243], v[224:227]
    v_mfma_f32_32x32x16_bf16 v[160:175], v[220:223], v[136:139], v[160:175]
    ds_read_b64_tr_b16 v[220:221], v231 offset:22528
    ds_read_b64_tr_b16 v[222:223], v231 offset:23040
    s_waitcnt lgkmcnt(6)
    v_mfma_f32_32x32x16_bf16 v[176:191], v[208:211], v[136:139], v[176:191]
    s_waitcnt lgkmcnt(4)
    v_mfma_f32_32x32x16_bf16 v[144:159], v[212:215], v[140:143], v[144:159]
    s_waitcnt lgkmcnt(2)
    v_mfma_f32_16x16x32_bf16 v[224:227], v[216:219], v[244:247], v[224:227]
    v_mfma_f32_32x32x16_bf16 v[160:175], v[216:219], v[140:143], v[160:175]
    s_waitcnt lgkmcnt(0)
    v_mfma_f32_32x32x16_bf16 v[176:191], v[220:223], v[140:143], v[176:191]
    v_bfe_u32 v196, v238, 4, 5
    v_lshrrev_b32 v197, 9, v238
    v_cmp_eq_u32 s[74:75], 1, v197
    s_lshl_b32 s26, s3, 5
    s_add_u32 s26, s26, 16
    v_add_u32 v198, s26, v196
    v_mul_u32_u24 v199, 21760, v197
    v_add_u32 v199, 114688, v199
    v_mad_u32_u24 v200, v198, 5, 0
    v_lshl_add_u32 v200, v200, 4, v199
    s_nop 1
    v_cndmask_b32 v202, v184, v170, s[74:75]
    v_cndmask_b32 v203, v185, v171, s[74:75]
    ds_write_b128 v200, v[176:179]
    ds_write_b128 v200, v[180:183] offset:16
    ds_write_b128 v200, v[172:175] offset:32
    ds_write_b128 v200, v[188:191] offset:48
    ds_write_b64 v200, v[202:203] offset:64
    v_bfe_u32 v204, v238, 4, 4
    v_mul_u32_u24 v204, 80, v204
    v_bfe_u32 v205, v238, 8, 1
    s_mov_b32 s26, 21760
    v_mad_u32_u24 v204, v205, s26, v204
    v_add_u32 v204, 114688, v204
    s_cmp_eq_u32 s3, 4
    s_cbranch_scc0 K1_HW3
    s_mov_b64 exec, s[74:75]
    ds_write_b128 v204, v[224:227] offset:32
    s_mov_b32 exec_lo, 0xffff0000
    s_mov_b32 exec_hi, 0
    ds_write_b64 v204, v[226:227] offset:64
    s_mov_b64 exec, -1
K1_HW3:
    s_and_b32 s67, s23, 7
    s_lshl_b32 s67, s67, 9
    s_lshr_b32 s26, s23, 3
    s_mul_i32 s26, s26, 36864
    s_add_u32 s67, s67, s26
    s_add_u32 s67, s67, 32768
    v_mul_f32 v208, s64, v144
    v_mul_f32 v209, s64, v145
    v_mul_f32 v210, s64, v146
    v_mul_f32 v211, s64, v147
    v_mul_f32 v212, s64, v148
    v_mul_f32 v213, s64, v149
    v_mul_f32 v214, s64, v150
    v_mul_f32 v215, s64, v151
    v_exp_f32 v208, v208
    v_exp_f32 v209, v209
    v_exp_f32 v210, v210
    v_exp_f32 v211, v211
    v_exp_f32 v212, v212
    v_exp_f32 v213, v213
    v_exp_f32 v214, v214
    v_exp_f32 v215, v215
    v_mul_f32 v144, v144, v152
    v_mul_f32 v145, v145, v153
    v_mul_f32 v146, v146, v154
    v_mul_f32 v147, v147, v155
    v_mul_f32 v148, v148, v156
    v_mul_f32 v149, v149, v157
    v_mul_f32 v150, v150, v158
    v_mul_f32 v151, v151, v159
    v_add_f32 v208, 1.0, v208
    v_add_f32 v209, 1.0, v209
    v_add_f32 v210, 1.0, v210
    v_add_f32 v211, 1.0, v211
    v_add_f32 v212, 1.0, v212
    v_add_f32 v213, 1.0, v213
    v_add_f32 v214, 1.0, v214
    v_add_f32 v215, 1.0, v215
    v_rcp_f32 v208, v208
    v_rcp_f32 v209, v209
    v_rcp_f32 v210, v210
    v_rcp_f32 v211, v211
    v_rcp_f32 v212, v212
    v_rcp_f32 v213, v213
    v_rcp_f32 v214, v214
    v_rcp_f32 v215, v215
    v_mul_f32 v144, v144, v208
    v_mul_f32 v145, v145, v209
    v_mul_f32 v146, v146, v210
    v_mul_f32 v147, v147, v211
    v_mul_f32 v148, v148, v212
    v_mul_f32 v149, v149, v213
    v_mul_f32 v150, v150, v214
    v_mul_f32 v151, v151, v215
    v_cvt_pk_bf16_f32 v216, v144, v145
    v_cvt_pk_bf16_f32 v217, v146, v147
    v_cvt_pk_bf16_f32 v218, v148, v149
    v_cvt_pk_bf16_f32 v219, v150, v151
    buffer_store_dwordx4 v[216:219], v239, s[48:51], s67 offen offset:0 sc1
    v_cndmask_b32 v168, v168, 0, s[74:75]
    v_cndmask_b32 v169, v169, 0, s[74:75]
    s_cmp_eq_u32 s22, 0
    s_cselect_b32 s27, 16, 0
    s_waitcnt lgkmcnt(0)
    v_subrev_u32 v200, 0, v198
    v_max_u32 v144, s27, v200
    v_mad_u32_u24 v144, v144, 5, 0
    v_lshl_add_u32 v144, v144, 4, v199
    v_subrev_u32 v201, 2, v198
    v_max_u32 v145, s27, v201
    v_mad_u32_u24 v145, v145, 5, 0
    v_lshl_add_u32 v145, v145, 4, v199
    v_subrev_u32 v202, 4, v198
    v_max_u32 v146, s27, v202
    v_mad_u32_u24 v146, v146, 5, 0
    v_lshl_add_u32 v146, v146, 4, v199
    v_subrev_u32 v203, 6, v198
    v_max_u32 v147, s27, v203
    v_mad_u32_u24 v147, v147, 5, 0
    v_lshl_add_u32 v147, v147, 4, v199
    v_subrev_u32 v204, 8, v198
    v_max_u32 v148, s27, v204
    v_mad_u32_u24 v148, v148, 5, 0
    v_lshl_add_u32 v148, v148, 4, v199
    v_subrev_u32 v205, 10, v198
    v_max_u32 v149, s27, v205
    v_mad_u32_u24 v149, v149, 5, 0
    v_lshl_add_u32 v149, v149, 4, v199
    v_subrev_u32 v206, 12, v198
    v_max_u32 v150, s27, v206
    v_mad_u32_u24 v150, v150, 5, 0
    v_lshl_add_u32 v150, v150, 4, v199
    v_subrev_u32 v207, 14, v198
    v_max_u32 v151, s27, v207
    v_mad_u32_u24 v151, v151, 5, 0
    v_lshl_add_u32 v151, v151, 4, v199
    s_cmp_ge_u32 s3, 6
    s_cbranch_scc0 K_MIDOK
    s_waitcnt vmcnt(0)
    s_add_u32 s27, s76, 500
    v_xor_b32 v240, v250, v251
    v_xor_b32 v241, v252, v253
    v_xor_b32 v240, 0x5bd1e995, v240
    v_xor_b32 v241, 0x5bd1e995, v241
    v_or_b32 v240, v240, v241
    v_subrev_u32 v251, s27, v250
    v_subrev_u32 v253, s27, v252
    v_max_u32 v241, v251, v253
    v_lshrrev_b32 v241, 22, v241
    v_or_b32 v240, v240, v241
    v_cmp_ne_u32 vcc, 0, v240
    s_nop 4
    s_cbranch_vccz K_MIDF
    s_cmp_eq_u32 s3, 6
    s_cbranch_scc0 POLL2_7300_R
    v_mbcnt_lo_u32_b32 v0, -1, 0
    v_mbcnt_hi_u32_b32 v0, -1, v0
    s_mov_b32 s27, 0
    v_add_u32 v1, s27, v0
    v_max_i32 v1, 0, v1
    v_lshlrev_b32 v1, 4, v1
    v_cmp_gt_u32 vcc, 64, v0
    s_nop 0
    s_mov_b64 exec, vcc
    s_mov_b32 s26, 0
POLL2_7300_F:
    buffer_load_dwordx4 v[4:7], v1, s[52:55], 0 offen offset:2048 sc1
    s_add_u32 s26, s26, 1
    s_waitcnt vmcnt(0)
    s_add_u32 s27, s76, 500
    v_xor_b32 v2, v4, v5
    v_xor_b32 v3, v6, v7
    v_xor_b32 v2, 0x5bd1e995, v2
    v_xor_b32 v3, 0x5bd1e995, v3
    v_or_b32 v2, v2, v3
    v_subrev_u32 v5, s27, v4
    v_subrev_u32 v7, s27, v6
    v_max_u32 v3, v5, v7
    v_lshrrev_b32 v3, 22, v3
    v_or_b32 v2, v2, v3
    v_cmp_ne_u32 vcc, 0, v2
    s_nop 4
    s_cbranch_vccz POLL2_7300_D
    s_mov_b64 exec, vcc
    s_sleep 12
    s_cmp_lt_u32 s26, 0x8000
    s_cbranch_scc1 POLL2_7300_F
POLL2_7300_D:
    s_mov_b64 exec, -1
POLL2_7300_R:
    s_cmp_eq_u32 s3, 7
    s_cbranch_scc0 POLL2_7336_R
    v_mbcnt_lo_u32_b32 v0, -1, 0
    v_mbcnt_hi_u32_b32 v0, -1, v0
    s_mov_b32 s27, 0
    v_add_u32 v1, s27, v0
    v_max_i32 v1, 0, v1
    v_lshlrev_b32 v1, 4, v1
    v_cmp_gt_u32 vcc, 64, v0
    s_nop 0
    s_mov_b64 exec, vcc
    s_mov_b32 s26, 0
POLL2_7336_F:
    buffer_load_dwordx4 v[4:7], v1, s[52:55], 0 offen offset:3072 sc1
    s_add_u32 s26, s26, 1
    s_waitcnt vmcnt(0)
    s_add_u32 s27, s76, 500
    v_xor_b32 v2, v4, v5
    v_xor_b32 v3, v6, v7
    v_xor_b32 v2, 0x5bd1e995, v2
    v_xor_b32 v3, 0x5bd1e995, v3
    v_or_b32 v2, v2, v3
    v_subrev_u32 v5, s27, v4
    v_subrev_u32 v7, s27, v6
    v_max_u32 v3, v5, v7
    v_lshrrev_b32 v3, 22, v3
    v_or_b32 v2, v2, v3
    v_cmp_ne_u32 vcc, 0, v2
    s_nop 4
    s_cbranch_vccz POLL2_7336_D
    s_mov_b64 exec, vcc
    s_sleep 12
    s_cmp_lt_u32 s26, 0x8000
    s_cbranch_scc1 POLL2_7336_F
POLL2_7336_D:
    s_mov_b64 exec, -1
POLL2_7336_R:
K_MIDF:
K_MIDOK:
    s_waitcnt lgkmcnt(0)
    s_barrier
    s_cmp_eq_u32 s22, 0
    s_cselect_b32 s27, 16, 0
    s_and_b32 s30, s2, 3
    s_lshr_b32 s20, s2, 6
    s_lshl_b32 s20, s20, 1
    s_and_b32 s26, s2, 1
    s_add_u32 s20, s20, s26
    s_bfe_u32 s21, s2, 0x40002
    s_lshl_b32 s21, s21, 3
    s_bfe_u32 s26, s2, 0x10001
    s_lshl_b32 s26, s26, 2
    s_add_u32 s21, s21, s26
    s_and_b32 s26, s3, 3
    s_add_u32 s21, s21, s26
    s_mul_i32 s22, s26, 9216
    s_mul_i32 s67, s20, 746496
    s_add_u32 s67, s67, s22
    s_add_u32 s67, s67, 663552
    s_lshr_b32 s31, s26, 1
    s_xor_b32 s31, s31, s20
    s_mul_i32 s31, s31, 746496
    s_and_b32 s26, s26, 1
    s_mul_i32 s26, s26, 9216
    s_add_u32 s31, s31, s26
    s_mul_i32 s26, s30, 165888
    s_add_u32 s31, s31, s26
    s_add_u32 s24, s31, 0
    s_add_u32 m0, s22, 0
    s_nop 0
    buffer_load_dwordx4 v238, s[60:63], s24 offen offset:0 lds
    buffer_load_dwordx4 v238, s[60:63], s24 offen offset:1024 lds
    buffer_load_dwordx4 v238, s[60:63], s24 offen offset:2048 lds
    buffer_load_dwordx4 v238, s[60:63], s24 offen offset:3072 lds
    s_add_u32 s24, s31, 4096
    s_add_u32 m0, s22, 4096
    s_nop 0
    buffer_load_dwordx4 v238, s[60:63], s24 offen offset:0 lds
    buffer_load_dwordx4 v238, s[60:63], s24 offen offset:1024 lds
    buffer_load_dwordx4 v238, s[60:63], s24 offen offset:2048 lds
    buffer_load_dwordx4 v238, s[60:63], s24 offen offset:3072 lds
    s_add_u32 s24, s31, 8192
    s_add_u32 m0, s22, 8192
    s_nop 0
    buffer_load_dwordx4 v238, s[60:63], s24 offen offset:0 lds
    ds_read_b128 v[176:179], v144 offset:0
    ds_read_b128 v[180:183], v144 offset:16
    ds_read_b64 v[184:185], v144 offset:64
    ds_read_b128 v[208:211], v145 offset:0
    ds_read_b128 v[212:215], v145 offset:16
    ds_read_b64 v[216:217], v145 offset:64
    ds_read_b128 v[218:221], v146 offset:0
    ds_read_b128 v[222:225], v146 offset:16
    ds_read_b64 v[226:227], v146 offset:64
    s_waitcnt lgkmcnt(6)
    v_mul_f32 v152, v160, v176
    v_fmac_f32 v152, v161, v177
    v_fmac_f32 v152, v162, v178
    v_fmac_f32 v152, v163, v179
    v_fmac_f32 v152, v164, v180
    v_fmac_f32 v152, v165, v181
    v_fmac_f32 v152, v166, v182
    v_fmac_f32 v152, v167, v183
    v_fmac_f32 v152, v168, v184
    v_fmac_f32 v152, v169, v185
    ds_read_b128 v[176:179], v147 offset:0
    ds_read_b128 v[180:183], v147 offset:16
    ds_read_b64 v[184:185], v147 offset:64
    s_waitcnt lgkmcnt(6)
    v_mul_f32 v153, v160, v208
    v_fmac_f32 v153, v161, v209
    v_fmac_f32 v153, v162, v210
    v_fmac_f32 v153, v163, v211
    v_fmac_f32 v153, v164, v212
    v_fmac_f32 v153, v165, v213
    v_fmac_f32 v153, v166, v214
    v_fmac_f32 v153, v167, v215
    v_fmac_f32 v153, v168, v216
    v_fmac_f32 v153, v169, v217
    ds_read_b128 v[208:211], v148 offset:0
    ds_read_b128 v[212:215], v148 offset:16
    ds_read_b64 v[216:217], v148 offset:64
    s_waitcnt lgkmcnt(6)
    v_mul_f32 v154, v160, v218
    v_fmac_f32 v154, v161, v219
    v_fmac_f32 v154, v162, v220
    v_fmac_f32 v154, v163, v221
    v_fmac_f32 v154, v164, v222
    v_fmac_f32 v154, v165, v223
    v_fmac_f32 v154, v166, v224
    v_fmac_f32 v154, v167, v225
    v_fmac_f32 v154, v168, v226
    v_fmac_f32 v154, v169, v227
    ds_read_b128 v[218:221], v149 offset:0
    ds_read_b128 v[222:225], v149 offset:16
    ds_read_b64 v[226:227], v149 offset:64
    s_waitcnt lgkmcnt(6)
    v_mul_f32 v155, v160, v176
    v_fmac_f32 v155, v161, v177
    v_fmac_f32 v155, v162, v178
    v_fmac_f32 v155, v163, v179
    v_fmac_f32 v155, v164, v180
    v_fmac_f32 v155, v165, v181
    v_fmac_f32 v155, v166, v182
    v_fmac_f32 v155, v167, v183
    v_fmac_f32 v155, v168, v184
    v_fmac_f32 v155, v169, v185
    ds_read_b128 v[176:179], v150 offset:0
    ds_read_b128 v[180:183], v150 offset:16
    ds_read_b64 v[184:185], v150 offset:64
    s_waitcnt lgkmcnt(6)
    v_mul_f32 v156, v160, v208
    v_fmac_f32 v156, v161, v209
    v_fmac_f32 v156, v162, v210
    v_fmac_f32 v156, v163, v211
    v_fmac_f32 v156, v164, v212
    v_fmac_f32 v156, v165, v213
    v_fmac_f32 v156, v166, v214
    v_fmac_f32 v156, v167, v215
    v_fmac_f32 v156, v168, v216
    v_fmac_f32 v156, v169, v217
    ds_read_b128 v[208:211], v151 offset:0
    ds_read_b128 v[212:215], v151 offset:16
    ds_read_b64 v[216:217], v151 offset:64
    s_waitcnt lgkmcnt(6)
    v_mul_f32 v157, v160, v218
    v_fmac_f32 v157, v161, v219
    v_fmac_f32 v157, v162, v220
    v_fmac_f32 v157, v163, v221
    v_fmac_f32 v157, v164, v222
    v_fmac_f32 v157, v165, v223
    v_fmac_f32 v157, v166, v224
    v_fmac_f32 v157, v167, v225
    v_fmac_f32 v157, v168, v226
    v_fmac_f32 v157, v169, v227
    s_waitcnt lgkmcnt(3)
    v_mul_f32 v158, v160, v176
    v_fmac_f32 v158, v161, v177
    v_fmac_f32 v158, v162, v178
    v_fmac_f32 v158, v163, v179
    v_fmac_f32 v158, v164, v180
    v_fmac_f32 v158, v165, v181
    v_fmac_f32 v158, v166, v182
    v_fmac_f32 v158, v167, v183
    v_fmac_f32 v158, v168, v184
    v_fmac_f32 v158, v169, v185
    s_waitcnt lgkmcnt(0)
    v_mul_f32 v159, v160, v208
    v_fmac_f32 v159, v161, v209
    v_fmac_f32 v159, v162, v210
    v_fmac_f32 v159, v163, v211
    v_fmac_f32 v159, v164, v212
    v_fmac_f32 v159, v165, v213
    v_fmac_f32 v159, v166, v214
    v_fmac_f32 v159, v167, v215
    v_fmac_f32 v159, v168, v216
    v_fmac_f32 v159, v169, v217
    s_add_u32 s24, s31, 18432
    s_add_u32 m0, s22, 36864
    s_nop 0
    buffer_load_dwordx4 v238, s[60:63], s24 offen offset:0 lds
    buffer_load_dwordx4 v238, s[60:63], s24 offen offset:1024 lds
    buffer_load_dwordx4 v238, s[60:63], s24 offen offset:2048 lds
    buffer_load_dwordx4 v238, s[60:63], s24 offen offset:3072 lds
    s_add_u32 s24, s31, 22528
    s_add_u32 m0, s22, 40960
    s_nop 0
    buffer_load_dwordx4 v238, s[60:63], s24 offen offset:0 lds
    buffer_load_dwordx4 v238, s[60:63], s24 offen offset:1024 lds
    buffer_load_dwordx4 v238, s[60:63], s24 offen offset:2048 lds
    buffer_load_dwordx4 v238, s[60:63], s24 offen offset:3072 lds
    s_add_u32 s24, s31, 26624
    s_add_u32 m0, s22, 45056
    s_nop 0
    buffer_load_dwordx4 v238, s[60:63], s24 offen offset:0 lds
    ds_read_b128 v[176:179], v144 offset:32
    ds_read_b128 v[180:183], v144 offset:48
    ds_read_b64 v[184:185], v144 offset:64
    ds_read_b128 v[208:211], v145 offset:32
    ds_read_b128 v[212:215], v145 offset:48
    ds_read_b64 v[216:217], v145 offset:64
    v_mov_b32 v195, 0xceabfb8f
    v_cmp_le_u32 vcc, s27, v200
    v_mov_b32 v200, v152
    s_nop 1
    v_permlane32_swap_b32 v152, v200
    v_add_f32 v152, v152, v200
    v_mul_f32 v152, 0x3eae1a93, v152
    v_cndmask_b32 v152, v195, v152, vcc
    v_cmp_le_u32 vcc, s27, v201
    v_mov_b32 v201, v153
    s_nop 1
    v_permlane32_swap_b32 v153, v201
    v_add_f32 v153, v153, v201
    v_mul_f32 v153, 0x3eae1a93, v153
    v_cndmask_b32 v153, v195, v153, vcc
    v_cmp_le_u32 vcc, s27, v202
    v_mov_b32 v202, v154
    s_nop 1
    v_permlane32_swap_b32 v154, v202
    v_add_f32 v154, v154, v202
    v_mul_f32 v154, 0x3eae1a93, v154
    v_cndmask_b32 v154, v195, v154, vcc
    v_cmp_le_u32 vcc, s27, v203
    v_mov_b32 v203, v155
    s_nop 1
    v_permlane32_swap_b32 v155, v203
    v_add_f32 v155, v155, v203
    v_mul_f32 v155, 0x3eae1a93, v155
    v_cndmask_b32 v155, v195, v155, vcc
    v_cmp_le_u32 vcc, s27, v204
    v_mov_b32 v204, v156
    s_nop 1
    v_permlane32_swap_b32 v156, v204
    v_add_f32 v156, v156, v204
    v_mul_f32 v156, 0x3eae1a93, v156
    v_cndmask_b32 v156, v195, v156, vcc
    v_cmp_le_u32 vcc, s27, v205
    v_mov_b32 v205, v157
    s_nop 1
    v_permlane32_swap_b32 v157, v205
    v_add_f32 v157, v157, v205
    v_mul_f32 v157, 0x3eae1a93, v157
    v_cndmask_b32 v157, v195, v157, vcc
    v_cmp_le_u32 vcc, s27, v206
    v_mov_b32 v206, v158
    s_nop 1
    v_permlane32_swap_b32 v158, v206
    v_add_f32 v158, v158, v206
    v_mul_f32 v158, 0x3eae1a93, v158
    v_cndmask_b32 v158, v195, v158, vcc
    v_cmp_le_u32 vcc, s27, v207
    v_mov_b32 v207, v159
    s_nop 1
    v_permlane32_swap_b32 v159, v207
    v_add_f32 v159, v159, v207
    v_mul_f32 v159, 0x3eae1a93, v159
    v_cndmask_b32 v159, v195, v159, vcc
    v_max3_f32 v200, v152, v153, v154
    v_max3_f32 v200, v200, v155, v156
    v_max3_f32 v200, v200, v157, v158
    v_max_f32 v200, v200, v159
    v_sub_f32 v152, v152, v200
    v_sub_f32 v153, v153, v200
    v_sub_f32 v154, v154, v200
    v_sub_f32 v155, v155, v200
    v_sub_f32 v156, v156, v200
    v_sub_f32 v157, v157, v200
    v_sub_f32 v158, v158, v200
    v_sub_f32 v159, v159, v200
    v_exp_f32 v152, v152
    v_exp_f32 v153, v153
    v_exp_f32 v154, v154
    v_exp_f32 v155, v155
    v_exp_f32 v156, v156
    v_exp_f32 v157, v157
    v_exp_f32 v158, v158
    v_exp_f32 v159, v159
    v_add_f32 v201, v152, v153
    v_add_f32 v201, v201, v154
    v_add_f32 v201, v201, v155
    v_add_f32 v201, v201, v156
    v_add_f32 v201, v201, v157
    v_add_f32 v201, v201, v158
    v_add_f32 v201, v201, v159
    v_rcp_f32 v201, v201
    s_add_u32 s24, s31, 36864
    s_add_u32 m0, s22, 73728
    s_nop 0
    buffer_load_dwordx4 v238, s[60:63], s24 offen offset:0 lds
    buffer_load_dwordx4 v238, s[60:63], s24 offen offset:1024 lds
    buffer_load_dwordx4 v238, s[60:63], s24 offen offset:2048 lds
    buffer_load_dwordx4 v238, s[60:63], s24 offen offset:3072 lds
    s_add_u32 s24, s31, 40960
    s_add_u32 m0, s22, 77824
    s_nop 0
    buffer_load_dwordx4 v238, s[60:63], s24 offen offset:0 lds
    buffer_load_dwordx4 v238, s[60:63], s24 offen offset:1024 lds
    buffer_load_dwordx4 v238, s[60:63], s24 offen offset:2048 lds
    buffer_load_dwordx4 v238, s[60:63], s24 offen offset:3072 lds
    s_add_u32 s24, s31, 45056
    s_add_u32 m0, s22, 81920
    s_nop 0
    buffer_load_dwordx4 v238, s[60:63], s24 offen offset:0 lds
    ds_read_b128 v[218:221], v146 offset:32
    ds_read_b128 v[222:225], v146 offset:48
    ds_read_b64 v[226:227], v146 offset:64
    s_waitcnt lgkmcnt(6)
    v_mul_f32 v160, v152, v176
    v_mul_f32 v161, v152, v177
    v_mul_f32 v162, v152, v178
    v_mul_f32 v163, v152, v179
    v_mul_f32 v164, v152, v180
    v_mul_f32 v165, v152, v181
    v_mul_f32 v166, v152, v182
    v_mul_f32 v167, v152, v183
    v_mul_f32 v168, v152, v184
    v_mul_f32 v169, v152, v185
    ds_read_b128 v[176:179], v147 offset:32
    ds_read_b128 v[180:183], v147 offset:48
    ds_read_b64 v[184:185], v147 offset:64
    s_waitcnt lgkmcnt(6)
    v_fmac_f32 v160, v153, v208
    v_fmac_f32 v161, v153, v209
    v_fmac_f32 v162, v153, v210
    v_fmac_f32 v163, v153, v211
    v_fmac_f32 v164, v153, v212
    v_fmac_f32 v165, v153, v213
    v_fmac_f32 v166, v153, v214
    v_fmac_f32 v167, v153, v215
    v_fmac_f32 v168, v153, v216
    v_fmac_f32 v169, v153, v217
    ds_read_b128 v[208:211], v148 offset:32
    ds_read_b128 v[212:215], v148 offset:48
    ds_read_b64 v[216:217], v148 offset:64
    s_waitcnt lgkmcnt(6)
    v_fmac_f32 v160, v154, v218
    v_fmac_f32 v161, v154, v219
    v_fmac_f32 v162, v154, v220
    v_fmac_f32 v163, v154, v221
    v_fmac_f32 v164, v154, v222
    v_fmac_f32 v165, v154, v223
    v_fmac_f32 v166, v154, v224
    v_fmac_f32 v167, v154, v225
    v_fmac_f32 v168, v154, v226
    v_fmac_f32 v169, v154, v227
    ds_read_b128 v[218:221], v149 offset:32
    ds_read_b128 v[222:225], v149 offset:48
    ds_read_b64 v[226:227], v149 offset:64
    s_waitcnt lgkmcnt(6)
    v_fmac_f32 v160, v155, v176
    v_fmac_f32 v161, v155, v177
    v_fmac_f32 v162, v155, v178
    v_fmac_f32 v163, v155, v179
    v_fmac_f32 v164, v155, v180
    v_fmac_f32 v165, v155, v181
    v_fmac_f32 v166, v155, v182
    v_fmac_f32 v167, v155, v183
    v_fmac_f32 v168, v155, v184
    v_fmac_f32 v169, v155, v185
    ds_read_b128 v[176:179], v150 offset:32
    ds_read_b128 v[180:183], v150 offset:48
    ds_read_b64 v[184:185], v150 offset:64
    s_waitcnt lgkmcnt(6)
    v_fmac_f32 v160, v156, v208
    v_fmac_f32 v161, v156, v209
    v_fmac_f32 v162, v156, v210
    v_fmac_f32 v163, v156, v211
    v_fmac_f32 v164, v156, v212
    v_fmac_f32 v165, v156, v213
    v_fmac_f32 v166, v156, v214
    v_fmac_f32 v167, v156, v215
    v_fmac_f32 v168, v156, v216
    v_fmac_f32 v169, v156, v217
    ds_read_b128 v[208:211], v151 offset:32
    ds_read_b128 v[212:215], v151 offset:48
    ds_read_b64 v[216:217], v151 offset:64
    s_waitcnt lgkmcnt(6)
    v_fmac_f32 v160, v157, v218
    v_fmac_f32 v161, v157, v219
    v_fmac_f32 v162, v157, v220
    v_fmac_f32 v163, v157, v221
    v_fmac_f32 v164, v157, v222
    v_fmac_f32 v165, v157, v223
    v_fmac_f32 v166, v157, v224
    v_fmac_f32 v167, v157, v225
    v_fmac_f32 v168, v157, v226
    v_fmac_f32 v169, v157, v227
    s_waitcnt lgkmcnt(3)
    v_fmac_f32 v160, v158, v176
    v_fmac_f32 v161, v158, v177
    v_fmac_f32 v162, v158, v178
    v_fmac_f32 v163, v158, v179
    v_fmac_f32 v164, v158, v180
    v_fmac_f32 v165, v158, v181
    v_fmac_f32 v166, v158, v182
    v_fmac_f32 v167, v158, v183
    v_fmac_f32 v168, v158, v184
    v_fmac_f32 v169, v158, v185
    s_waitcnt lgkmcnt(0)
    v_fmac_f32 v160, v159, v208
    v_fmac_f32 v161, v159, v209
    v_fmac_f32 v162, v159, v210
    v_fmac_f32 v163, v159, v211
    v_fmac_f32 v164, v159, v212
    v_fmac_f32 v165, v159, v213
    v_fmac_f32 v166, v159, v214
    v_fmac_f32 v167, v159, v215
    v_fmac_f32 v168, v159, v216
    v_fmac_f32 v169, v159, v217
    v_mul_f32 v160, v160, v201
    v_mul_f32 v161, v161, v201
    v_mul_f32 v162, v162, v201
    v_mul_f32 v163, v163, v201
    v_mul_f32 v164, v164, v201
    v_mul_f32 v165, v165, v201
    v_mul_f32 v166, v166, v201
    v_mul_f32 v167, v167, v201
    v_mul_f32 v168, v168, v201
    v_mul_f32 v169, v169, v201
    v_cvt_pk_bf16_f32 v186, v160, v161
    v_cvt_pk_bf16_f32 v187, v162, v163
    v_cvt_pk_bf16_f32 v188, v164, v165
    v_cvt_pk_bf16_f32 v189, v166, v167
    v_cvt_pk_bf16_f32 v190, v168, v169
    s_lshl_b32 s26, s23, 9
    s_add_u32 s26, s26, 147456
    s_lshr_b32 s27, s23, 2
    s_lshl_b32 s27, s27, 8
    s_and_b32 s25, s23, 3
    s_lshl_b32 s25, s25, 2
    s_add_u32 s27, s27, s25
    s_add_u32 s27, s27, 163584
    buffer_store_dwordx4 v[186:189], v239, s[48:51], s26 offen sc1
    s_mov_b64 exec, s[74:75]
    buffer_store_dword v190, v239, s[48:51], s27 offen sc1
    s_mov_b64 exec, -1
    s_waitcnt vmcnt(20)
K_P2:
    s_barrier
    s_cmp_ge_u32 s3, 4
    s_cbranch_scc1 K2_LOADER
    ds_read_b128 v[180:183], v204 offset:0
    ds_read_b128 v[184:187], v204 offset:1024
    ds_read_b128 v[188:191], v204 offset:2048
    ds_read_b128 v[192:195], v204 offset:3072
    s_waitcnt vmcnt(23)
    ds_read_b128 v[196:199], v208 offset:0
    s_waitcnt lgkmcnt(3)
    v_mfma_f32_16x16x32_bf16 v[80:83], v[180:183], v[0:3], 0
    v_mfma_f32_16x16x32_bf16 v[120:123], v[180:183], v[4:7], 0
    buffer_load_dwordx4 v[72:75], v238, s[48:51], s29 offen offset:1024
    ds_read_b128 v[200:203], v204 offset:18432
    v_mfma_f32_16x16x32_bf16 v[84:87], v[184:187], v[0:3], 0
    v_mfma_f32_16x16x32_bf16 v[124:127], v[184:187], v[4:7], 0
    buffer_load_dwordx4 v[76:79], v238, s[48:51], s66 offen offset:1024
    ds_read_b128 v[180:183], v204 offset:19456
    s_waitcnt lgkmcnt(3)
    v_mfma_f32_16x16x32_bf16 v[88:91], v[188:191], v[0:3], 0
    v_mfma_f32_16x16x32_bf16 v[128:131], v[188:191], v[4:7], 0
    ds_read_b128 v[184:187], v204 offset:20480
    v_mfma_f32_16x16x32_bf16 v[92:95], v[192:195], v[0:3], 0
    v_mfma_f32_16x16x32_bf16 v[132:135], v[192:195], v[4:7], 0
    ds_read_b128 v[188:191], v204 offset:21504
    s_waitcnt lgkmcnt(3)
    v_mfma_f32_16x16x32_bf16 v[96:99], v[196:199], v[0:3], 0
    v_mfma_f32_16x16x32_bf16 v[136:139], v[196:199], v[4:7], 0
    ds_read_b128 v[192:195], v204 offset:4608
    v_mfma_f32_16x16x32_bf16 v[100:103], v[200:203], v[0:3], 0
    v_mfma_f32_16x16x32_bf16 v[140:143], v[200:203], v[4:7], 0
    ds_read_b128 v[196:199], v204 offset:5632
    s_waitcnt lgkmcnt(3)
    v_mfma_f32_16x16x32_bf16 v[104:107], v[180:183], v[0:3], 0
    v_mfma_f32_16x16x32_bf16 v[144:147], v[180:183], v[4:7], 0
    ds_read_b128 v[200:203], v204 offset:6656
    v_mfma_f32_16x16x32_bf16 v[108:111], v[184:187], v[0:3], 0
    v_mfma_f32_16x16x32_bf16 v[148:151], v[184:187], v[4:7], 0
    ds_read_b128 v[180:183], v204 offset:7680
    s_waitcnt lgkmcnt(3)
    v_mfma_f32_16x16x32_bf16 v[112:115], v[188:191], v[0:3], 0
    v_mfma_f32_16x16x32_bf16 v[152:155], v[188:191], v[4:7], 0
    s_waitcnt vmcnt(23)
    ds_read_b128 v[184:187], v208 offset:4608
    v_mfma_f32_16x16x32_bf16 v[80:83], v[192:195], v[8:11], v[80:83]
    v_mfma_f32_16x16x32_bf16 v[120:123], v[192:195], v[12:15], v[120:123]
    buffer_load_dwordx4 v[0:3], v238, s[48:51], s29 offen offset:2048
    ds_read_b128 v[188:191], v204 offset:23040
    s_waitcnt lgkmcnt(3)
    v_mfma_f32_16x16x32_bf16 v[84:87], v[196:199], v[8:11], v[84:87]
    v_mfma_f32_16x16x32_bf16 v[124:127], v[196:199], v[12:15], v[124:127]
    buffer_load_dwordx4 v[4:7], v238, s[48:51], s66 offen offset:2048
    ds_read_b128 v[192:195], v204 offset:24064
    v_mfma_f32_16x16x32_bf16 v[88:91], v[200:203], v[8:11], v[88:91]
    v_mfma_f32_16x16x32_bf16 v[128:131], v[200:203], v[12:15], v[128:131]
    ds_read_b128 v[196:199], v204 offset:25088
    s_waitcnt lgkmcnt(3)
    v_mfma_f32_16x16x32_bf16 v[92:95], v[180:183], v[8:11], v[92:95]
    v_mfma_f32_16x16x32_bf16 v[132:135], v[180:183], v[12:15], v[132:135]
    ds_read_b128 v[200:203], v204 offset:26112
    v_mfma_f32_16x16x32_bf16 v[96:99], v[184:187], v[8:11], v[96:99]
    v_mfma_f32_16x16x32_bf16 v[136:139], v[184:187], v[12:15], v[136:139]
    ds_read_b128 v[180:183], v204 offset:9216
    s_waitcnt lgkmcnt(3)
    v_mfma_f32_16x16x32_bf16 v[100:103], v[188:191], v[8:11], v[100:103]
    v_mfma_f32_16x16x32_bf16 v[140:143], v[188:191], v[12:15], v[140:143]
    ds_read_b128 v[184:187], v204 offset:10240
    v_mfma_f32_16x16x32_bf16 v[104:107], v[192:195], v[8:11], v[104:107]
    v_mfma_f32_16x16x32_bf16 v[144:147], v[192:195], v[12:15], v[144:147]
    ds_read_b128 v[188:191], v204 offset:11264
    s_waitcnt lgkmcnt(3)
    v_mfma_f32_16x16x32_bf16 v[108:111], v[196:199], v[8:11], v[108:111]
    v_mfma_f32_16x16x32_bf16 v[148:151], v[196:199], v[12:15], v[148:151]
    ds_read_b128 v[192:195], v204 offset:12288
    v_mfma_f32_16x16x32_bf16 v[112:115], v[200:203], v[8:11], v[112:115]
    v_mfma_f32_16x16x32_bf16 v[152:155], v[200:203], v[12:15], v[152:155]
    s_barrier
    s_waitcnt vmcnt(23)
    ds_read_b128 v[196:199], v208 offset:9216
    s_waitcnt lgkmcnt(3)
    v_mfma_f32_16x16x32_bf16 v[80:83], v[180:183], v[16:19], v[80:83]
    v_mfma_f32_16x16x32_bf16 v[120:123], v[180:183], v[20:23], v[120:123]
    buffer_load_dwordx4 v[8:11], v238, s[48:51], s29 offen offset:3072
    ds_read_b128 v[200:203], v204 offset:27648
    v_mfma_f32_16x16x32_bf16 v[84:87], v[184:187], v[16:19], v[84:87]
    v_mfma_f32_16x16x32_bf16 v[124:127], v[184:187], v[20:23], v[124:127]
    buffer_load_dwordx4 v[12:15], v238, s[48:51], s66 offen offset:3072
    ds_read_b128 v[180:183], v204 offset:28672
    s_waitcnt lgkmcnt(3)
    v_mfma_f32_16x16x32_bf16 v[88:91], v[188:191], v[16:19], v[88:91]
    v_mfma_f32_16x16x32_bf16 v[128:131], v[188:191], v[20:23], v[128:131]
    ds_read_b128 v[184:187], v204 offset:29696
    v_mfma_f32_16x16x32_bf16 v[92:95], v[192:195], v[16:19], v[92:95]
    v_mfma_f32_16x16x32_bf16 v[132:135], v[192:195], v[20:23], v[132:135]
    ds_read_b128 v[188:191], v204 offset:30720
    s_waitcnt lgkmcnt(3)
    v_mfma_f32_16x16x32_bf16 v[96:99], v[196:199], v[16:19], v[96:99]
    v_mfma_f32_16x16x32_bf16 v[136:139], v[196:199], v[20:23], v[136:139]
    ds_read_b128 v[192:195], v204 offset:13824
    v_mfma_f32_16x16x32_bf16 v[100:103], v[200:203], v[16:19], v[100:103]
    v_mfma_f32_16x16x32_bf16 v[140:143], v[200:203], v[20:23], v[140:143]
    ds_read_b128 v[196:199], v204 offset:14848
    s_waitcnt lgkmcnt(3)
    v_mfma_f32_16x16x32_bf16 v[104:107], v[180:183], v[16:19], v[104:107]
    v_mfma_f32_16x16x32_bf16 v[144:147], v[180:183], v[20:23], v[144:147]
    ds_read_b128 v[200:203], v204 offset:15872
    v_mfma_f32_16x16x32_bf16 v[108:111], v[184:187], v[16:19], v[108:111]
    v_mfma_f32_16x16x32_bf16 v[148:151], v[184:187], v[20:23], v[148:151]
    ds_read_b128 v[180:183], v204 offset:16896
    s_waitcnt lgkmcnt(3)
    v_mfma_f32_16x16x32_bf16 v[112:115], v[188:191], v[16:19], v[112:115]
    v_mfma_f32_16x16x32_bf16 v[152:155], v[188:191], v[20:23], v[152:155]
    s_waitcnt vmcnt(23)
    ds_read_b128 v[184:187], v208 offset:13824
    v_mfma_f32_16x16x32_bf16 v[80:83], v[192:195], v[24:27], v[80:83]
    v_mfma_f32_16x16x32_bf16 v[120:123], v[192:195], v[28:31], v[120:123]
    s_add_u32 s29, s28, 12288
    buffer_load_dwordx4 v[16:19], v238, s[48:51], s29 offen offset:0
    ds_read_b128 v[188:191], v204 offset:32256
    s_waitcnt lgkmcnt(3)
    v_mfma_f32_16x16x32_bf16 v[84:87], v[196:199], v[24:27], v[84:87]
    v_mfma_f32_16x16x32_bf16 v[124:127], v[196:199], v[28:31], v[124:127]
    s_add_u32 s66, s65, 12288
    buffer_load_dwordx4 v[20:23], v238, s[48:51], s66 offen offset:0
    ds_read_b128 v[192:195], v204 offset:33280
    v_mfma_f32_16x16x32_bf16 v[88:91], v[200:203], v[24:27], v[88:91]
    v_mfma_f32_16x16x32_bf16 v[128:131], v[200:203], v[28:31], v[128:131]
    ds_read_b128 v[196:199], v204 offset:34304
    s_waitcnt lgkmcnt(3)
    v_mfma_f32_16x16x32_bf16 v[92:95], v[180:183], v[24:27], v[92:95]
    v_mfma_f32_16x16x32_bf16 v[132:135], v[180:183], v[28:31], v[132:135]
    ds_read_b128 v[200:203], v204 offset:35328
    v_mfma_f32_16x16x32_bf16 v[96:99], v[184:187], v[24:27], v[96:99]
    v_mfma_f32_16x16x32_bf16 v[136:139], v[184:187], v[28:31], v[136:139]
    ds_read_b128 v[180:183], v205 offset:0
    s_waitcnt lgkmcnt(3)
    v_mfma_f32_16x16x32_bf16 v[100:103], v[188:191], v[24:27], v[100:103]
    v_mfma_f32_16x16x32_bf16 v[140:143], v[188:191], v[28:31], v[140:143]
    ds_read_b128 v[184:187], v205 offset:1024
    v_mfma_f32_16x16x32_bf16 v[104:107], v[192:195], v[24:27], v[104:107]
    v_mfma_f32_16x16x32_bf16 v[144:147], v[192:195], v[28:31], v[144:147]
    ds_read_b128 v[188:191], v205 offset:2048
    s_waitcnt lgkmcnt(3)
    v_mfma_f32_16x16x32_bf16 v[108:111], v[196:199], v[24:27], v[108:111]
    v_mfma_f32_16x16x32_bf16 v[148:151], v[196:199], v[28:31], v[148:151]
    ds_read_b128 v[192:195], v205 offset:3072
    v_mfma_f32_16x16x32_bf16 v[112:115], v[200:203], v[24:27], v[112:115]
    v_mfma_f32_16x16x32_bf16 v[152:155], v[200:203], v[28:31], v[152:155]
    s_waitcnt vmcnt(23)
    ds_read_b128 v[196:199], v209 offset:0
    s_waitcnt lgkmcnt(3)
    v_mfma_f32_16x16x32_bf16 v[80:83], v[180:183], v[32:35], v[80:83]
    v_mfma_f32_16x16x32_bf16 v[120:123], v[180:183], v[36:39], v[120:123]
    buffer_load_dwordx4 v[24:27], v238, s[48:51], s29 offen offset:1024
    ds_read_b128 v[200:203], v205 offset:18432
    v_mfma_f32_16x16x32_bf16 v[84:87], v[184:187], v[32:35], v[84:87]
    v_mfma_f32_16x16x32_bf16 v[124:127], v[184:187], v[36:39], v[124:127]
    buffer_load_dwordx4 v[28:31], v238, s[48:51], s66 offen offset:1024
    ds_read_b128 v[180:183], v205 offset:19456
    s_waitcnt lgkmcnt(3)
    v_mfma_f32_16x16x32_bf16 v[88:91], v[188:191], v[32:35], v[88:91]
    v_mfma_f32_16x16x32_bf16 v[128:131], v[188:191], v[36:39], v[128:131]
    ds_read_b128 v[184:187], v205 offset:20480
    v_mfma_f32_16x16x32_bf16 v[92:95], v[192:195], v[32:35], v[92:95]
    v_mfma_f32_16x16x32_bf16 v[132:135], v[192:195], v[36:39], v[132:135]
    ds_read_b128 v[188:191], v205 offset:21504
    s_waitcnt lgkmcnt(3)
    v_mfma_f32_16x16x32_bf16 v[96:99], v[196:199], v[32:35], v[96:99]
    v_mfma_f32_16x16x32_bf16 v[136:139], v[196:199], v[36:39], v[136:139]
    ds_read_b128 v[192:195], v205 offset:4608
    v_mfma_f32_16x16x32_bf16 v[100:103], v[200:203], v[32:35], v[100:103]
    v_mfma_f32_16x16x32_bf16 v[140:143], v[200:203], v[36:39], v[140:143]
    ds_read_b128 v[196:199], v205 offset:5632
    s_waitcnt lgkmcnt(3)
    v_mfma_f32_16x16x32_bf16 v[104:107], v[180:183], v[32:35], v[104:107]
    v_mfma_f32_16x16x32_bf16 v[144:147], v[180:183], v[36:39], v[144:147]
    ds_read_b128 v[200:203], v205 offset:6656
    v_mfma_f32_16x16x32_bf16 v[108:111], v[184:187], v[32:35], v[108:111]
    v_mfma_f32_16x16x32_bf16 v[148:151], v[184:187], v[36:39], v[148:151]
    ds_read_b128 v[180:183], v205 offset:7680
    s_waitcnt lgkmcnt(3)
    v_mfma_f32_16x16x32_bf16 v[112:115], v[188:191], v[32:35], v[112:115]
    v_mfma_f32_16x16x32_bf16 v[152:155], v[188:191], v[36:39], v[152:155]
    s_waitcnt vmcnt(23)
    ds_read_b128 v[184:187], v209 offset:4608
    v_mfma_f32_16x16x32_bf16 v[80:83], v[192:195], v[40:43], v[80:83]
    v_mfma_f32_16x16x32_bf16 v[120:123], v[192:195], v[44:47], v[120:123]
    buffer_load_dwordx4 v[32:35], v238, s[48:51], s29 offen offset:2048
    ds_read_b128 v[188:191], v205 offset:23040
    s_waitcnt lgkmcnt(3)
    v_mfma_f32_16x16x32_bf16 v[84:87], v[196:199], v[40:43], v[84:87]
    v_mfma_f32_16x16x32_bf16 v[124:127], v[196:199], v[44:47], v[124:127]
    buffer_load_dwordx4 v[36:39], v238, s[48:51], s66 offen offset:2048
    ds_read_b128 v[192:195], v205 offset:24064
    v_mfma_f32_16x16x32_bf16 v[88:91], v[200:203], v[40:43], v[88:91]
    v_mfma_f32_16x16x32_bf16 v[128:131], v[200:203], v[44:47], v[128:131]
    ds_read_b128 v[196:199], v205 offset:25088
    s_waitcnt lgkmcnt(3)
    v_mfma_f32_16x16x32_bf16 v[92:95], v[180:183], v[40:43], v[92:95]
    v_mfma_f32_16x16x32_bf16 v[132:135], v[180:183], v[44:47], v[132:135]
    ds_read_b128 v[200:203], v205 offset:26112
    v_mfma_f32_16x16x32_bf16 v[96:99], v[184:187], v[40:43], v[96:99]
    v_mfma_f32_16x16x32_bf16 v[136:139], v[184:187], v[44:47], v[136:139]
    ds_read_b128 v[180:183], v205 offset:9216
    s_waitcnt lgkmcnt(3)
    v_mfma_f32_16x16x32_bf16 v[100:103], v[188:191], v[40:43], v[100:103]
    v_mfma_f32_16x16x32_bf16 v[140:143], v[188:191], v[44:47], v[140:143]
    ds_read_b128 v[184:187], v205 offset:10240
    v_mfma_f32_16x16x32_bf16 v[104:107], v[192:195], v[40:43], v[104:107]
    v_mfma_f32_16x16x32_bf16 v[144:147], v[192:195], v[44:47], v[144:147]
    ds_read_b128 v[188:191], v205 offset:11264
    s_waitcnt lgkmcnt(3)
    v_mfma_f32_16x16x32_bf16 v[108:111], v[196:199], v[40:43], v[108:111]
    v_mfma_f32_16x16x32_bf16 v[148:151], v[196:199], v[44:47], v[148:151]
    ds_read_b128 v[192:195], v205 offset:12288
    v_mfma_f32_16x16x32_bf16 v[112:115], v[200:203], v[40:43], v[112:115]
    v_mfma_f32_16x16x32_bf16 v[152:155], v[200:203], v[44:47], v[152:155]
    s_waitcnt vmcnt(17)
    s_barrier
    ds_read_b128 v[196:199], v209 offset:9216
    s_waitcnt lgkmcnt(3)
    v_mfma_f32_16x16x32_bf16 v[80:83], v[180:183], v[48:51], v[80:83]
    v_mfma_f32_16x16x32_bf16 v[120:123], v[180:183], v[52:55], v[120:123]
    buffer_load_dwordx4 v[40:43], v238, s[48:51], s29 offen offset:3072
    ds_read_b128 v[200:203], v205 offset:27648
    v_mfma_f32_16x16x32_bf16 v[84:87], v[184:187], v[48:51], v[84:87]
    v_mfma_f32_16x16x32_bf16 v[124:127], v[184:187], v[52:55], v[124:127]
    buffer_load_dwordx4 v[44:47], v238, s[48:51], s66 offen offset:3072
    ds_read_b128 v[180:183], v205 offset:28672
    s_waitcnt lgkmcnt(3)
    v_mfma_f32_16x16x32_bf16 v[88:91], v[188:191], v[48:51], v[88:91]
    v_mfma_f32_16x16x32_bf16 v[128:131], v[188:191], v[52:55], v[128:131]
    ds_read_b128 v[184:187], v205 offset:29696
    v_mfma_f32_16x16x32_bf16 v[92:95], v[192:195], v[48:51], v[92:95]
    v_mfma_f32_16x16x32_bf16 v[132:135], v[192:195], v[52:55], v[132:135]
    ds_read_b128 v[188:191], v205 offset:30720
    s_waitcnt lgkmcnt(3)
    v_mfma_f32_16x16x32_bf16 v[96:99], v[196:199], v[48:51], v[96:99]
    v_mfma_f32_16x16x32_bf16 v[136:139], v[196:199], v[52:55], v[136:139]
    ds_read_b128 v[192:195], v205 offset:13824
    v_mfma_f32_16x16x32_bf16 v[100:103], v[200:203], v[48:51], v[100:103]
    v_mfma_f32_16x16x32_bf16 v[140:143], v[200:203], v[52:55], v[140:143]
    ds_read_b128 v[196:199], v205 offset:14848
    s_waitcnt lgkmcnt(3)
    v_mfma_f32_16x16x32_bf16 v[104:107], v[180:183], v[48:51], v[104:107]
    v_mfma_f32_16x16x32_bf16 v[144:147], v[180:183], v[52:55], v[144:147]
    ds_read_b128 v[200:203], v205 offset:15872
    v_mfma_f32_16x16x32_bf16 v[108:111], v[184:187], v[48:51], v[108:111]
    v_mfma_f32_16x16x32_bf16 v[148:151], v[184:187], v[52:55], v[148:151]
    ds_read_b128 v[180:183], v205 offset:16896
    s_waitcnt lgkmcnt(3)
    v_mfma_f32_16x16x32_bf16 v[112:115], v[188:191], v[48:51], v[112:115]
    v_mfma_f32_16x16x32_bf16 v[152:155], v[188:191], v[52:55], v[152:155]
    ds_read_b128 v[184:187], v209 offset:13824
    v_mfma_f32_16x16x32_bf16 v[80:83], v[192:195], v[56:59], v[80:83]
    v_mfma_f32_16x16x32_bf16 v[120:123], v[192:195], v[60:63], v[120:123]
    s_add_u32 s29, s28, 16384
    buffer_load_dwordx4 v[48:51], v238, s[48:51], s29 offen offset:0
    ds_read_b128 v[188:191], v205 offset:32256
    s_waitcnt lgkmcnt(3)
    v_mfma_f32_16x16x32_bf16 v[84:87], v[196:199], v[56:59], v[84:87]
    v_mfma_f32_16x16x32_bf16 v[124:127], v[196:199], v[60:63], v[124:127]
    s_add_u32 s66, s65, 16384
    buffer_load_dwordx4 v[52:55], v238, s[48:51], s66 offen offset:0
    ds_read_b128 v[192:195], v205 offset:33280
    v_mfma_f32_16x16x32_bf16 v[88:91], v[200:203], v[56:59], v[88:91]
    v_mfma_f32_16x16x32_bf16 v[128:131], v[200:203], v[60:63], v[128:131]
    ds_read_b128 v[196:199], v205 offset:34304
    s_waitcnt lgkmcnt(3)
    v_mfma_f32_16x16x32_bf16 v[92:95], v[180:183], v[56:59], v[92:95]
    v_mfma_f32_16x16x32_bf16 v[132:135], v[180:183], v[60:63], v[132:135]
    ds_read_b128 v[200:203], v205 offset:35328
    v_mfma_f32_16x16x32_bf16 v[96:99], v[184:187], v[56:59], v[96:99]
    v_mfma_f32_16x16x32_bf16 v[136:139], v[184:187], v[60:63], v[136:139]
    ds_read_b128 v[180:183], v206 offset:0
    s_waitcnt lgkmcnt(3)
    v_mfma_f32_16x16x32_bf16 v[100:103], v[188:191], v[56:59], v[100:103]
    v_mfma_f32_16x16x32_bf16 v[140:143], v[188:191], v[60:63], v[140:143]
    ds_read_b128 v[184:187], v206 offset:1024
    v_mfma_f32_16x16x32_bf16 v[104:107], v[192:195], v[56:59], v[104:107]
    v_mfma_f32_16x16x32_bf16 v[144:147], v[192:195], v[60:63], v[144:147]
    ds_read_b128 v[188:191], v206 offset:2048
    s_waitcnt lgkmcnt(3)
    v_mfma_f32_16x16x32_bf16 v[108:111], v[196:199], v[56:59], v[108:111]
    v_mfma_f32_16x16x32_bf16 v[148:151], v[196:199], v[60:63], v[148:151]
    ds_read_b128 v[192:195], v206 offset:3072
    v_mfma_f32_16x16x32_bf16 v[112:115], v[200:203], v[56:59], v[112:115]
    v_mfma_f32_16x16x32_bf16 v[152:155], v[200:203], v[60:63], v[152:155]
    ds_read_b128 v[196:199], v210 offset:0
    s_waitcnt lgkmcnt(3)
    v_mfma_f32_16x16x32_bf16 v[80:83], v[180:183], v[64:67], v[80:83]
    v_mfma_f32_16x16x32_bf16 v[120:123], v[180:183], v[68:71], v[120:123]
    buffer_load_dwordx4 v[56:59], v238, s[48:51], s29 offen offset:1024
    ds_read_b128 v[200:203], v206 offset:18432
    v_mfma_f32_16x16x32_bf16 v[84:87], v[184:187], v[64:67], v[84:87]
    v_mfma_f32_16x16x32_bf16 v[124:127], v[184:187], v[68:71], v[124:127]
    buffer_load_dwordx4 v[60:63], v238, s[48:51], s66 offen offset:1024
    ds_read_b128 v[180:183], v206 offset:19456
    s_waitcnt lgkmcnt(3)
    v_mfma_f32_16x16x32_bf16 v[88:91], v[188:191], v[64:67], v[88:91]
    v_mfma_f32_16x16x32_bf16 v[128:131], v[188:191], v[68:71], v[128:131]
    ds_read_b128 v[184:187], v206 offset:20480
    v_mfma_f32_16x16x32_bf16 v[92:95], v[192:195], v[64:67], v[92:95]
    v_mfma_f32_16x16x32_bf16 v[132:135], v[192:195], v[68:71], v[132:135]
    ds_read_b128 v[188:191], v206 offset:21504
    s_waitcnt lgkmcnt(3)
    v_mfma_f32_16x16x32_bf16 v[96:99], v[196:199], v[64:67], v[96:99]
    v_mfma_f32_16x16x32_bf16 v[136:139], v[196:199], v[68:71], v[136:139]
    ds_read_b128 v[192:195], v206 offset:4608
    v_mfma_f32_16x16x32_bf16 v[100:103], v[200:203], v[64:67], v[100:103]
    v_mfma_f32_16x16x32_bf16 v[140:143], v[200:203], v[68:71], v[140:143]
    ds_read_b128 v[196:199], v206 offset:5632
    s_waitcnt lgkmcnt(3)
    v_mfma_f32_16x16x32_bf16 v[104:107], v[180:183], v[64:67], v[104:107]
    v_mfma_f32_16x16x32_bf16 v[144:147], v[180:183], v[68:71], v[144:147]
    ds_read_b128 v[200:203], v206 offset:6656
    v_mfma_f32_16x16x32_bf16 v[108:111], v[184:187], v[64:67], v[108:111]
    v_mfma_f32_16x16x32_bf16 v[148:151], v[184:187], v[68:71], v[148:151]
    ds_read_b128 v[180:183], v206 offset:7680
    s_waitcnt lgkmcnt(3)
    v_mfma_f32_16x16x32_bf16 v[112:115], v[188:191], v[64:67], v[112:115]
    v_mfma_f32_16x16x32_bf16 v[152:155], v[188:191], v[68:71], v[152:155]
    s_waitcnt vmcnt(16)
    ds_read_b128 v[184:187], v210 offset:4608
    v_mfma_f32_16x16x32_bf16 v[80:83], v[192:195], v[72:75], v[80:83]
    v_mfma_f32_16x16x32_bf16 v[120:123], v[192:195], v[76:79], v[120:123]
    buffer_load_dwordx4 v[64:67], v238, s[48:51], s29 offen offset:2048
    ds_read_b128 v[188:191], v206 offset:23040
    s_waitcnt lgkmcnt(3)
    v_mfma_f32_16x16x32_bf16 v[84:87], v[196:199], v[72:75], v[84:87]
    v_mfma_f32_16x16x32_bf16 v[124:127], v[196:199], v[76:79], v[124:127]
    buffer_load_dwordx4 v[68:71], v238, s[48:51], s66 offen offset:2048
    ds_read_b128 v[192:195], v206 offset:24064
    v_mfma_f32_16x16x32_bf16 v[88:91], v[200:203], v[72:75], v[88:91]
    v_mfma_f32_16x16x32_bf16 v[128:131], v[200:203], v[76:79], v[128:131]
    ds_read_b128 v[196:199], v206 offset:25088
    s_waitcnt lgkmcnt(3)
    v_mfma_f32_16x16x32_bf16 v[92:95], v[180:183], v[72:75], v[92:95]
    v_mfma_f32_16x16x32_bf16 v[132:135], v[180:183], v[76:79], v[132:135]
    ds_read_b128 v[200:203], v206 offset:26112
    v_mfma_f32_16x16x32_bf16 v[96:99], v[184:187], v[72:75], v[96:99]
    v_mfma_f32_16x16x32_bf16 v[136:139], v[184:187], v[76:79], v[136:139]
    ds_read_b128 v[180:183], v206 offset:9216
    s_waitcnt lgkmcnt(3)
    v_mfma_f32_16x16x32_bf16 v[100:103], v[188:191], v[72:75], v[100:103]
    v_mfma_f32_16x16x32_bf16 v[140:143], v[188:191], v[76:79], v[140:143]
    ds_read_b128 v[184:187], v206 offset:10240
    v_mfma_f32_16x16x32_bf16 v[104:107], v[192:195], v[72:75], v[104:107]
    v_mfma_f32_16x16x32_bf16 v[144:147], v[192:195], v[76:79], v[144:147]
    ds_read_b128 v[188:191], v206 offset:11264
    s_waitcnt lgkmcnt(3)
    v_mfma_f32_16x16x32_bf16 v[108:111], v[196:199], v[72:75], v[108:111]
    v_mfma_f32_16x16x32_bf16 v[148:151], v[196:199], v[76:79], v[148:151]
    ds_read_b128 v[192:195], v206 offset:12288
    v_mfma_f32_16x16x32_bf16 v[112:115], v[200:203], v[72:75], v[112:115]
    v_mfma_f32_16x16x32_bf16 v[152:155], v[200:203], v[76:79], v[152:155]
    s_barrier
    s_waitcnt vmcnt(16)
    ds_read_b128 v[196:199], v210 offset:9216
    s_waitcnt lgkmcnt(3)
    v_mfma_f32_16x16x32_bf16 v[80:83], v[180:183], v[0:3], v[80:83]
    v_mfma_f32_16x16x32_bf16 v[120:123], v[180:183], v[4:7], v[120:123]
    buffer_load_dwordx4 v[72:75], v238, s[48:51], s29 offen offset:3072
    ds_read_b128 v[200:203], v206 offset:27648
    v_mfma_f32_16x16x32_bf16 v[84:87], v[184:187], v[0:3], v[84:87]
    v_mfma_f32_16x16x32_bf16 v[124:127], v[184:187], v[4:7], v[124:127]
    buffer_load_dwordx4 v[76:79], v238, s[48:51], s66 offen offset:3072
    ds_read_b128 v[180:183], v206 offset:28672
    s_waitcnt lgkmcnt(3)
    v_mfma_f32_16x16x32_bf16 v[88:91], v[188:191], v[0:3], v[88:91]
    v_mfma_f32_16x16x32_bf16 v[128:131], v[188:191], v[4:7], v[128:131]
    ds_read_b128 v[184:187], v206 offset:29696
    v_mfma_f32_16x16x32_bf16 v[92:95], v[192:195], v[0:3], v[92:95]
    v_mfma_f32_16x16x32_bf16 v[132:135], v[192:195], v[4:7], v[132:135]
    ds_read_b128 v[188:191], v206 offset:30720
    s_waitcnt lgkmcnt(3)
    v_mfma_f32_16x16x32_bf16 v[96:99], v[196:199], v[0:3], v[96:99]
    v_mfma_f32_16x16x32_bf16 v[136:139], v[196:199], v[4:7], v[136:139]
    ds_read_b128 v[192:195], v206 offset:13824
    v_mfma_f32_16x16x32_bf16 v[100:103], v[200:203], v[0:3], v[100:103]
    v_mfma_f32_16x16x32_bf16 v[140:143], v[200:203], v[4:7], v[140:143]
    ds_read_b128 v[196:199], v206 offset:14848
    s_waitcnt lgkmcnt(3)
    v_mfma_f32_16x16x32_bf16 v[104:107], v[180:183], v[0:3], v[104:107]
    v_mfma_f32_16x16x32_bf16 v[144:147], v[180:183], v[4:7], v[144:147]
    ds_read_b128 v[200:203], v206 offset:15872
    v_mfma_f32_16x16x32_bf16 v[108:111], v[184:187], v[0:3], v[108:111]
    v_mfma_f32_16x16x32_bf16 v[148:151], v[184:187], v[4:7], v[148:151]
    ds_read_b128 v[180:183], v206 offset:16896
    s_waitcnt lgkmcnt(3)
    v_mfma_f32_16x16x32_bf16 v[112:115], v[188:191], v[0:3], v[112:115]
    v_mfma_f32_16x16x32_bf16 v[152:155], v[188:191], v[4:7], v[152:155]
    s_waitcnt vmcnt(16)
    ds_read_b128 v[184:187], v210 offset:13824
    v_mfma_f32_16x16x32_bf16 v[80:83], v[192:195], v[8:11], v[80:83]
    v_mfma_f32_16x16x32_bf16 v[120:123], v[192:195], v[12:15], v[120:123]
    s_add_u32 s29, s28, 20480
    buffer_load_dwordx4 v[0:3], v238, s[48:51], s29 offen offset:0
    ds_read_b128 v[188:191], v206 offset:32256
    s_waitcnt lgkmcnt(3)
    v_mfma_f32_16x16x32_bf16 v[84:87], v[196:199], v[8:11], v[84:87]
    v_mfma_f32_16x16x32_bf16 v[124:127], v[196:199], v[12:15], v[124:127]
    s_add_u32 s66, s65, 20480
    buffer_load_dwordx4 v[4:7], v238, s[48:51], s66 offen offset:0
    ds_read_b128 v[192:195], v206 offset:33280
    v_mfma_f32_16x16x32_bf16 v[88:91], v[200:203], v[8:11], v[88:91]
    v_mfma_f32_16x16x32_bf16 v[128:131], v[200:203], v[12:15], v[128:131]
    ds_read_b128 v[196:199], v206 offset:34304
    s_waitcnt lgkmcnt(3)
    v_mfma_f32_16x16x32_bf16 v[92:95], v[180:183], v[8:11], v[92:95]
    v_mfma_f32_16x16x32_bf16 v[132:135], v[180:183], v[12:15], v[132:135]
    ds_read_b128 v[200:203], v206 offset:35328
    v_mfma_f32_16x16x32_bf16 v[96:99], v[184:187], v[8:11], v[96:99]
    v_mfma_f32_16x16x32_bf16 v[136:139], v[184:187], v[12:15], v[136:139]
    ds_read_b128 v[180:183], v207 offset:0
    s_waitcnt lgkmcnt(3)
    v_mfma_f32_16x16x32_bf16 v[100:103], v[188:191], v[8:11], v[100:103]
    v_mfma_f32_16x16x32_bf16 v[140:143], v[188:191], v[12:15], v[140:143]
    ds_read_b128 v[184:187], v207 offset:1024
    v_mfma_f32_16x16x32_bf16 v[104:107], v[192:195], v[8:11], v[104:107]
    v_mfma_f32_16x16x32_bf16 v[144:147], v[192:195], v[12:15], v[144:147]
    ds_read_b128 v[188:191], v207 offset:2048
    s_waitcnt lgkmcnt(3)
    v_mfma_f32_16x16x32_bf16 v[108:111], v[196:199], v[8:11], v[108:111]
    v_mfma_f32_16x16x32_bf16 v[148:151], v[196:199], v[12:15], v[148:151]
    ds_read_b128 v[192:195], v207 offset:3072
    v_mfma_f32_16x16x32_bf16 v[112:115], v[200:203], v[8:11], v[112:115]
    v_mfma_f32_16x16x32_bf16 v[152:155], v[200:203], v[12:15], v[152:155]
    s_waitcnt vmcnt(16)
    ds_read_b128 v[196:199], v211 offset:0
    s_waitcnt lgkmcnt(3)
    v_mfma_f32_16x16x32_bf16 v[80:83], v[180:183], v[16:19], v[80:83]
    v_mfma_f32_16x16x32_bf16 v[120:123], v[180:183], v[20:23], v[120:123]
    buffer_load_dwordx4 v[8:11], v238, s[48:51], s29 offen offset:1024
    ds_read_b128 v[200:203], v207 offset:18432
    v_mfma_f32_16x16x32_bf16 v[84:87], v[184:187], v[16:19], v[84:87]
    v_mfma_f32_16x16x32_bf16 v[124:127], v[184:187], v[20:23], v[124:127]
    buffer_load_dwordx4 v[12:15], v238, s[48:51], s66 offen offset:1024
    ds_read_b128 v[180:183], v207 offset:19456
    s_waitcnt lgkmcnt(3)
    v_mfma_f32_16x16x32_bf16 v[88:91], v[188:191], v[16:19], v[88:91]
    v_mfma_f32_16x16x32_bf16 v[128:131], v[188:191], v[20:23], v[128:131]
    ds_read_b128 v[184:187], v207 offset:20480
    v_mfma_f32_16x16x32_bf16 v[92:95], v[192:195], v[16:19], v[92:95]
    v_mfma_f32_16x16x32_bf16 v[132:135], v[192:195], v[20:23], v[132:135]
    ds_read_b128 v[188:191], v207 offset:21504
    s_waitcnt lgkmcnt(3)
    v_mfma_f32_16x16x32_bf16 v[96:99], v[196:199], v[16:19], v[96:99]
    v_mfma_f32_16x16x32_bf16 v[136:139], v[196:199], v[20:23], v[136:139]
    ds_read_b128 v[192:195], v207 offset:4608
    v_mfma_f32_16x16x32_bf16 v[100:103], v[200:203], v[16:19], v[100:103]
    v_mfma_f32_16x16x32_bf16 v[140:143], v[200:203], v[20:23], v[140:143]
    ds_read_b128 v[196:199], v207 offset:5632
    s_waitcnt lgkmcnt(3)
    v_mfma_f32_16x16x32_bf16 v[104:107], v[180:183], v[16:19], v[104:107]
    v_mfma_f32_16x16x32_bf16 v[144:147], v[180:183], v[20:23], v[144:147]
    ds_read_b128 v[200:203], v207 offset:6656
    v_mfma_f32_16x16x32_bf16 v[108:111], v[184:187], v[16:19], v[108:111]
    v_mfma_f32_16x16x32_bf16 v[148:151], v[184:187], v[20:23], v[148:151]
    ds_read_b128 v[180:183], v207 offset:7680
    s_waitcnt lgkmcnt(3)
    v_mfma_f32_16x16x32_bf16 v[112:115], v[188:191], v[16:19], v[112:115]
    v_mfma_f32_16x16x32_bf16 v[152:155], v[188:191], v[20:23], v[152:155]
    s_waitcnt vmcnt(16)
    ds_read_b128 v[184:187], v211 offset:4608
    v_mfma_f32_16x16x32_bf16 v[80:83], v[192:195], v[24:27], v[80:83]
    v_mfma_f32_16x16x32_bf16 v[120:123], v[192:195], v[28:31], v[120:123]
    buffer_load_dwordx4 v[16:19], v238, s[48:51], s29 offen offset:2048
    ds_read_b128 v[188:191], v207 offset:23040
    s_waitcnt lgkmcnt(3)
    v_mfma_f32_16x16x32_bf16 v[84:87], v[196:199], v[24:27], v[84:87]
    v_mfma_f32_16x16x32_bf16 v[124:127], v[196:199], v[28:31], v[124:127]
    buffer_load_dwordx4 v[20:23], v238, s[48:51], s66 offen offset:2048
    ds_read_b128 v[192:195], v207 offset:24064
    v_mfma_f32_16x16x32_bf16 v[88:91], v[200:203], v[24:27], v[88:91]
    v_mfma_f32_16x16x32_bf16 v[128:131], v[200:203], v[28:31], v[128:131]
    ds_read_b128 v[196:199], v207 offset:25088
    s_waitcnt lgkmcnt(3)
    v_mfma_f32_16x16x32_bf16 v[92:95], v[180:183], v[24:27], v[92:95]
    v_mfma_f32_16x16x32_bf16 v[132:135], v[180:183], v[28:31], v[132:135]
    ds_read_b128 v[200:203], v207 offset:26112
    v_mfma_f32_16x16x32_bf16 v[96:99], v[184:187], v[24:27], v[96:99]
    v_mfma_f32_16x16x32_bf16 v[136:139], v[184:187], v[28:31], v[136:139]
    ds_read_b128 v[180:183], v207 offset:9216
    s_waitcnt lgkmcnt(3)
    v_mfma_f32_16x16x32_bf16 v[100:103], v[188:191], v[24:27], v[100:103]
    v_mfma_f32_16x16x32_bf16 v[140:143], v[188:191], v[28:31], v[140:143]
    ds_read_b128 v[184:187], v207 offset:10240
    v_mfma_f32_16x16x32_bf16 v[104:107], v[192:195], v[24:27], v[104:107]
    v_mfma_f32_16x16x32_bf16 v[144:147], v[192:195], v[28:31], v[144:147]
    ds_read_b128 v[188:191], v207 offset:11264
    s_waitcnt lgkmcnt(3)
    v_mfma_f32_16x16x32_bf16 v[108:111], v[196:199], v[24:27], v[108:111]
    v_mfma_f32_16x16x32_bf16 v[148:151], v[196:199], v[28:31], v[148:151]
    ds_read_b128 v[192:195], v207 offset:12288
    v_mfma_f32_16x16x32_bf16 v[112:115], v[200:203], v[24:27], v[112:115]
    v_mfma_f32_16x16x32_bf16 v[152:155], v[200:203], v[28:31], v[152:155]
    s_barrier
    s_waitcnt vmcnt(16)
    ds_read_b128 v[196:199], v211 offset:9216
    s_waitcnt lgkmcnt(3)
    v_mfma_f32_16x16x32_bf16 v[80:83], v[180:183], v[32:35], v[80:83]
    v_mfma_f32_16x16x32_bf16 v[120:123], v[180:183], v[36:39], v[120:123]
    buffer_load_dwordx4 v[24:27], v238, s[48:51], s29 offen offset:3072
    ds_read_b128 v[200:203], v207 offset:27648
    v_mfma_f32_16x16x32_bf16 v[84:87], v[184:187], v[32:35], v[84:87]
    v_mfma_f32_16x16x32_bf16 v[124:127], v[184:187], v[36:39], v[124:127]
    buffer_load_dwordx4 v[28:31], v238, s[48:51], s66 offen offset:3072
    ds_read_b128 v[180:183], v207 offset:28672
    s_waitcnt lgkmcnt(3)
    v_mfma_f32_16x16x32_bf16 v[88:91], v[188:191], v[32:35], v[88:91]
    v_mfma_f32_16x16x32_bf16 v[128:131], v[188:191], v[36:39], v[128:131]
    ds_read_b128 v[184:187], v207 offset:29696
    v_mfma_f32_16x16x32_bf16 v[92:95], v[192:195], v[32:35], v[92:95]
    v_mfma_f32_16x16x32_bf16 v[132:135], v[192:195], v[36:39], v[132:135]
    ds_read_b128 v[188:191], v207 offset:30720
    s_waitcnt lgkmcnt(3)
    v_mfma_f32_16x16x32_bf16 v[96:99], v[196:199], v[32:35], v[96:99]
    v_mfma_f32_16x16x32_bf16 v[136:139], v[196:199], v[36:39], v[136:139]
    ds_read_b128 v[192:195], v207 offset:13824
    v_mfma_f32_16x16x32_bf16 v[100:103], v[200:203], v[32:35], v[100:103]
    v_mfma_f32_16x16x32_bf16 v[140:143], v[200:203], v[36:39], v[140:143]
    ds_read_b128 v[196:199], v207 offset:14848
    s_waitcnt lgkmcnt(3)
    v_mfma_f32_16x16x32_bf16 v[104:107], v[180:183], v[32:35], v[104:107]
    v_mfma_f32_16x16x32_bf16 v[144:147], v[180:183], v[36:39], v[144:147]
    ds_read_b128 v[200:203], v207 offset:15872
    v_mfma_f32_16x16x32_bf16 v[108:111], v[184:187], v[32:35], v[108:111]
    v_mfma_f32_16x16x32_bf16 v[148:151], v[184:187], v[36:39], v[148:151]
    ds_read_b128 v[180:183], v207 offset:16896
    s_waitcnt lgkmcnt(3)
    v_mfma_f32_16x16x32_bf16 v[112:115], v[188:191], v[32:35], v[112:115]
    v_mfma_f32_16x16x32_bf16 v[152:155], v[188:191], v[36:39], v[152:155]
    s_waitcnt vmcnt(16)
    ds_read_b128 v[184:187], v211 offset:13824
    v_mfma_f32_16x16x32_bf16 v[80:83], v[192:195], v[40:43], v[80:83]
    v_mfma_f32_16x16x32_bf16 v[120:123], v[192:195], v[44:47], v[120:123]
    s_add_u32 s29, s28, 24576
    buffer_load_dwordx4 v[32:35], v238, s[48:51], s29 offen offset:0
    ds_read_b128 v[188:191], v207 offset:32256
    s_waitcnt lgkmcnt(3)
    v_mfma_f32_16x16x32_bf16 v[84:87], v[196:199], v[40:43], v[84:87]
    v_mfma_f32_16x16x32_bf16 v[124:127], v[196:199], v[44:47], v[124:127]
    s_add_u32 s66, s65, 24576
    buffer_load_dwordx4 v[36:39], v238, s[48:51], s66 offen offset:0
    ds_read_b128 v[192:195], v207 offset:33280
    v_mfma_f32_16x16x32_bf16 v[88:91], v[200:203], v[40:43], v[88:91]
    v_mfma_f32_16x16x32_bf16 v[128:131], v[200:203], v[44:47], v[128:131]
    ds_read_b128 v[196:199], v207 offset:34304
    s_waitcnt lgkmcnt(3)
    v_mfma_f32_16x16x32_bf16 v[92:95], v[180:183], v[40:43], v[92:95]
    v_mfma_f32_16x16x32_bf16 v[132:135], v[180:183], v[44:47], v[132:135]
    ds_read_b128 v[200:203], v207 offset:35328
    v_mfma_f32_16x16x32_bf16 v[96:99], v[184:187], v[40:43], v[96:99]
    v_mfma_f32_16x16x32_bf16 v[136:139], v[184:187], v[44:47], v[136:139]
    ds_read_b128 v[180:183], v204 offset:0
    s_waitcnt lgkmcnt(3)
    v_mfma_f32_16x16x32_bf16 v[100:103], v[188:191], v[40:43], v[100:103]
    v_mfma_f32_16x16x32_bf16 v[140:143], v[188:191], v[44:47], v[140:143]
    ds_read_b128 v[184:187], v204 offset:1024
    v_mfma_f32_16x16x32_bf16 v[104:107], v[192:195], v[40:43], v[104:107]
    v_mfma_f32_16x16x32_bf16 v[144:147], v[192:195], v[44:47], v[144:147]
    ds_read_b128 v[188:191], v204 offset:2048
    s_waitcnt lgkmcnt(3)
    v_mfma_f32_16x16x32_bf16 v[108:111], v[196:199], v[40:43], v[108:111]
    v_mfma_f32_16x16x32_bf16 v[148:151], v[196:199], v[44:47], v[148:151]
    ds_read_b128 v[192:195], v204 offset:3072
    v_mfma_f32_16x16x32_bf16 v[112:115], v[200:203], v[40:43], v[112:115]
    v_mfma_f32_16x16x32_bf16 v[152:155], v[200:203], v[44:47], v[152:155]
    s_waitcnt vmcnt(16)
    ds_read_b128 v[196:199], v208 offset:0
    s_waitcnt lgkmcnt(3)
    v_mfma_f32_16x16x32_bf16 v[80:83], v[180:183], v[48:51], v[80:83]
    v_mfma_f32_16x16x32_bf16 v[120:123], v[180:183], v[52:55], v[120:123]
    buffer_load_dwordx4 v[40:43], v238, s[48:51], s29 offen offset:1024
    ds_read_b128 v[200:203], v204 offset:18432
    v_mfma_f32_16x16x32_bf16 v[84:87], v[184:187], v[48:51], v[84:87]
    v_mfma_f32_16x16x32_bf16 v[124:127], v[184:187], v[52:55], v[124:127]
    buffer_load_dwordx4 v[44:47], v238, s[48:51], s66 offen offset:1024
    ds_read_b128 v[180:183], v204 offset:19456
    s_waitcnt lgkmcnt(3)
    v_mfma_f32_16x16x32_bf16 v[88:91], v[188:191], v[48:51], v[88:91]
    v_mfma_f32_16x16x32_bf16 v[128:131], v[188:191], v[52:55], v[128:131]
    ds_read_b128 v[184:187], v204 offset:20480
    v_mfma_f32_16x16x32_bf16 v[92:95], v[192:195], v[48:51], v[92:95]
    v_mfma_f32_16x16x32_bf16 v[132:135], v[192:195], v[52:55], v[132:135]
    ds_read_b128 v[188:191], v204 offset:21504
    s_waitcnt lgkmcnt(3)
    v_mfma_f32_16x16x32_bf16 v[96:99], v[196:199], v[48:51], v[96:99]
    v_mfma_f32_16x16x32_bf16 v[136:139], v[196:199], v[52:55], v[136:139]
    ds_read_b128 v[192:195], v204 offset:4608
    v_mfma_f32_16x16x32_bf16 v[100:103], v[200:203], v[48:51], v[100:103]
    v_mfma_f32_16x16x32_bf16 v[140:143], v[200:203], v[52:55], v[140:143]
    ds_read_b128 v[196:199], v204 offset:5632
    s_waitcnt lgkmcnt(3)
    v_mfma_f32_16x16x32_bf16 v[104:107], v[180:183], v[48:51], v[104:107]
    v_mfma_f32_16x16x32_bf16 v[144:147], v[180:183], v[52:55], v[144:147]
    ds_read_b128 v[200:203], v204 offset:6656
    v_mfma_f32_16x16x32_bf16 v[108:111], v[184:187], v[48:51], v[108:111]
    v_mfma_f32_16x16x32_bf16 v[148:151], v[184:187], v[52:55], v[148:151]
    ds_read_b128 v[180:183], v204 offset:7680
    s_waitcnt lgkmcnt(3)
    v_mfma_f32_16x16x32_bf16 v[112:115], v[188:191], v[48:51], v[112:115]
    v_mfma_f32_16x16x32_bf16 v[152:155], v[188:191], v[52:55], v[152:155]
    s_waitcnt vmcnt(16)
    ds_read_b128 v[184:187], v208 offset:4608
    v_mfma_f32_16x16x32_bf16 v[80:83], v[192:195], v[56:59], v[80:83]
    v_mfma_f32_16x16x32_bf16 v[120:123], v[192:195], v[60:63], v[120:123]
    buffer_load_dwordx4 v[48:51], v238, s[48:51], s29 offen offset:2048
    ds_read_b128 v[188:191], v204 offset:23040
    s_waitcnt lgkmcnt(3)
    v_mfma_f32_16x16x32_bf16 v[84:87], v[196:199], v[56:59], v[84:87]
    v_mfma_f32_16x16x32_bf16 v[124:127], v[196:199], v[60:63], v[124:127]
    buffer_load_dwordx4 v[52:55], v238, s[48:51], s66 offen offset:2048
    ds_read_b128 v[192:195], v204 offset:24064
    v_mfma_f32_16x16x32_bf16 v[88:91], v[200:203], v[56:59], v[88:91]
    v_mfma_f32_16x16x32_bf16 v[128:131], v[200:203], v[60:63], v[128:131]
    ds_read_b128 v[196:199], v204 offset:25088
    s_waitcnt lgkmcnt(3)
    v_mfma_f32_16x16x32_bf16 v[92:95], v[180:183], v[56:59], v[92:95]
    v_mfma_f32_16x16x32_bf16 v[132:135], v[180:183], v[60:63], v[132:135]
    ds_read_b128 v[200:203], v204 offset:26112
    v_mfma_f32_16x16x32_bf16 v[96:99], v[184:187], v[56:59], v[96:99]
    v_mfma_f32_16x16x32_bf16 v[136:139], v[184:187], v[60:63], v[136:139]
    ds_read_b128 v[180:183], v204 offset:9216
    s_waitcnt lgkmcnt(3)
    v_mfma_f32_16x16x32_bf16 v[100:103], v[188:191], v[56:59], v[100:103]
    v_mfma_f32_16x16x32_bf16 v[140:143], v[188:191], v[60:63], v[140:143]
    ds_read_b128 v[184:187], v204 offset:10240
    v_mfma_f32_16x16x32_bf16 v[104:107], v[192:195], v[56:59], v[104:107]
    v_mfma_f32_16x16x32_bf16 v[144:147], v[192:195], v[60:63], v[144:147]
    ds_read_b128 v[188:191], v204 offset:11264
    s_waitcnt lgkmcnt(3)
    v_mfma_f32_16x16x32_bf16 v[108:111], v[196:199], v[56:59], v[108:111]
    v_mfma_f32_16x16x32_bf16 v[148:151], v[196:199], v[60:63], v[148:151]
    ds_read_b128 v[192:195], v204 offset:12288
    v_mfma_f32_16x16x32_bf16 v[112:115], v[200:203], v[56:59], v[112:115]
    v_mfma_f32_16x16x32_bf16 v[152:155], v[200:203], v[60:63], v[152:155]
    s_barrier
    s_waitcnt vmcnt(16)
    ds_read_b128 v[196:199], v208 offset:9216
    s_waitcnt lgkmcnt(3)
    v_mfma_f32_16x16x32_bf16 v[80:83], v[180:183], v[64:67], v[80:83]
    v_mfma_f32_16x16x32_bf16 v[120:123], v[180:183], v[68:71], v[120:123]
    buffer_load_dwordx4 v[56:59], v238, s[48:51], s29 offen offset:3072
    ds_read_b128 v[200:203], v204 offset:27648
    v_mfma_f32_16x16x32_bf16 v[84:87], v[184:187], v[64:67], v[84:87]
    v_mfma_f32_16x16x32_bf16 v[124:127], v[184:187], v[68:71], v[124:127]
    buffer_load_dwordx4 v[60:63], v238, s[48:51], s66 offen offset:3072
    ds_read_b128 v[180:183], v204 offset:28672
    s_waitcnt lgkmcnt(3)
    v_mfma_f32_16x16x32_bf16 v[88:91], v[188:191], v[64:67], v[88:91]
    v_mfma_f32_16x16x32_bf16 v[128:131], v[188:191], v[68:71], v[128:131]
    ds_read_b128 v[184:187], v204 offset:29696
    v_mfma_f32_16x16x32_bf16 v[92:95], v[192:195], v[64:67], v[92:95]
    v_mfma_f32_16x16x32_bf16 v[132:135], v[192:195], v[68:71], v[132:135]
    ds_read_b128 v[188:191], v204 offset:30720
    s_waitcnt lgkmcnt(3)
    v_mfma_f32_16x16x32_bf16 v[96:99], v[196:199], v[64:67], v[96:99]
    v_mfma_f32_16x16x32_bf16 v[136:139], v[196:199], v[68:71], v[136:139]
    ds_read_b128 v[192:195], v204 offset:13824
    v_mfma_f32_16x16x32_bf16 v[100:103], v[200:203], v[64:67], v[100:103]
    v_mfma_f32_16x16x32_bf16 v[140:143], v[200:203], v[68:71], v[140:143]
    ds_read_b128 v[196:199], v204 offset:14848
    s_waitcnt lgkmcnt(3)
    v_mfma_f32_16x16x32_bf16 v[104:107], v[180:183], v[64:67], v[104:107]
    v_mfma_f32_16x16x32_bf16 v[144:147], v[180:183], v[68:71], v[144:147]
    ds_read_b128 v[200:203], v204 offset:15872
    v_mfma_f32_16x16x32_bf16 v[108:111], v[184:187], v[64:67], v[108:111]
    v_mfma_f32_16x16x32_bf16 v[148:151], v[184:187], v[68:71], v[148:151]
    ds_read_b128 v[180:183], v204 offset:16896
    s_waitcnt lgkmcnt(3)
    v_mfma_f32_16x16x32_bf16 v[112:115], v[188:191], v[64:67], v[112:115]
    v_mfma_f32_16x16x32_bf16 v[152:155], v[188:191], v[68:71], v[152:155]
    s_waitcnt vmcnt(16)
    ds_read_b128 v[184:187], v208 offset:13824
    v_mfma_f32_16x16x32_bf16 v[80:83], v[192:195], v[72:75], v[80:83]
    v_mfma_f32_16x16x32_bf16 v[120:123], v[192:195], v[76:79], v[120:123]
    s_add_u32 s29, s28, 28672
    buffer_load_dwordx4 v[64:67], v238, s[48:51], s29 offen offset:0
    ds_read_b128 v[188:191], v204 offset:32256
    s_waitcnt lgkmcnt(3)
    v_mfma_f32_16x16x32_bf16 v[84:87], v[196:199], v[72:75], v[84:87]
    v_mfma_f32_16x16x32_bf16 v[124:127], v[196:199], v[76:79], v[124:127]
    s_add_u32 s66, s65, 28672
    buffer_load_dwordx4 v[68:71], v238, s[48:51], s66 offen offset:0
    ds_read_b128 v[192:195], v204 offset:33280
    v_mfma_f32_16x16x32_bf16 v[88:91], v[200:203], v[72:75], v[88:91]
    v_mfma_f32_16x16x32_bf16 v[128:131], v[200:203], v[76:79], v[128:131]
    ds_read_b128 v[196:199], v204 offset:34304
    s_waitcnt lgkmcnt(3)
    v_mfma_f32_16x16x32_bf16 v[92:95], v[180:183], v[72:75], v[92:95]
    v_mfma_f32_16x16x32_bf16 v[132:135], v[180:183], v[76:79], v[132:135]
    ds_read_b128 v[200:203], v204 offset:35328
    v_mfma_f32_16x16x32_bf16 v[96:99], v[184:187], v[72:75], v[96:99]
    v_mfma_f32_16x16x32_bf16 v[136:139], v[184:187], v[76:79], v[136:139]
    ds_read_b128 v[180:183], v205 offset:0
    s_waitcnt lgkmcnt(3)
    v_mfma_f32_16x16x32_bf16 v[100:103], v[188:191], v[72:75], v[100:103]
    v_mfma_f32_16x16x32_bf16 v[140:143], v[188:191], v[76:79], v[140:143]
    ds_read_b128 v[184:187], v205 offset:1024
    v_mfma_f32_16x16x32_bf16 v[104:107], v[192:195], v[72:75], v[104:107]
    v_mfma_f32_16x16x32_bf16 v[144:147], v[192:195], v[76:79], v[144:147]
    ds_read_b128 v[188:191], v205 offset:2048
    s_waitcnt lgkmcnt(3)
    v_mfma_f32_16x16x32_bf16 v[108:111], v[196:199], v[72:75], v[108:111]
    v_mfma_f32_16x16x32_bf16 v[148:151], v[196:199], v[76:79], v[148:151]
    ds_read_b128 v[192:195], v205 offset:3072
    v_mfma_f32_16x16x32_bf16 v[112:115], v[200:203], v[72:75], v[112:115]
    v_mfma_f32_16x16x32_bf16 v[152:155], v[200:203], v[76:79], v[152:155]
    s_waitcnt vmcnt(16)
    ds_read_b128 v[196:199], v209 offset:0
    s_waitcnt lgkmcnt(3)
    v_mfma_f32_16x16x32_bf16 v[80:83], v[180:183], v[0:3], v[80:83]
    v_mfma_f32_16x16x32_bf16 v[120:123], v[180:183], v[4:7], v[120:123]
    buffer_load_dwordx4 v[72:75], v238, s[48:51], s29 offen offset:1024
    ds_read_b128 v[200:203], v205 offset:18432
    v_mfma_f32_16x16x32_bf16 v[84:87], v[184:187], v[0:3], v[84:87]
    v_mfma_f32_16x16x32_bf16 v[124:127], v[184:187], v[4:7], v[124:127]
    buffer_load_dwordx4 v[76:79], v238, s[48:51], s66 offen offset:1024
    ds_read_b128 v[180:183], v205 offset:19456
    s_waitcnt lgkmcnt(3)
    v_mfma_f32_16x16x32_bf16 v[88:91], v[188:191], v[0:3], v[88:91]
    v_mfma_f32_16x16x32_bf16 v[128:131], v[188:191], v[4:7], v[128:131]
    ds_read_b128 v[184:187], v205 offset:20480
    v_mfma_f32_16x16x32_bf16 v[92:95], v[192:195], v[0:3], v[92:95]
    v_mfma_f32_16x16x32_bf16 v[132:135], v[192:195], v[4:7], v[132:135]
    ds_read_b128 v[188:191], v205 offset:21504
    s_waitcnt lgkmcnt(3)
    v_mfma_f32_16x16x32_bf16 v[96:99], v[196:199], v[0:3], v[96:99]
    v_mfma_f32_16x16x32_bf16 v[136:139], v[196:199], v[4:7], v[136:139]
    ds_read_b128 v[192:195], v205 offset:4608
    v_mfma_f32_16x16x32_bf16 v[100:103], v[200:203], v[0:3], v[100:103]
    v_mfma_f32_16x16x32_bf16 v[140:143], v[200:203], v[4:7], v[140:143]
    ds_read_b128 v[196:199], v205 offset:5632
    s_waitcnt lgkmcnt(3)
    v_mfma_f32_16x16x32_bf16 v[104:107], v[180:183], v[0:3], v[104:107]
    v_mfma_f32_16x16x32_bf16 v[144:147], v[180:183], v[4:7], v[144:147]
    ds_read_b128 v[200:203], v205 offset:6656
    v_mfma_f32_16x16x32_bf16 v[108:111], v[184:187], v[0:3], v[108:111]
    v_mfma_f32_16x16x32_bf16 v[148:151], v[184:187], v[4:7], v[148:151]
    ds_read_b128 v[180:183], v205 offset:7680
    s_waitcnt lgkmcnt(3)
    v_mfma_f32_16x16x32_bf16 v[112:115], v[188:191], v[0:3], v[112:115]
    v_mfma_f32_16x16x32_bf16 v[152:155], v[188:191], v[4:7], v[152:155]
    s_waitcnt vmcnt(16)
    ds_read_b128 v[184:187], v209 offset:4608
    v_mfma_f32_16x16x32_bf16 v[80:83], v[192:195], v[8:11], v[80:83]
    v_mfma_f32_16x16x32_bf16 v[120:123], v[192:195], v[12:15], v[120:123]
    buffer_load_dwordx4 v[0:3], v238, s[48:51], s29 offen offset:2048
    ds_read_b128 v[188:191], v205 offset:23040
    s_waitcnt lgkmcnt(3)
    v_mfma_f32_16x16x32_bf16 v[84:87], v[196:199], v[8:11], v[84:87]
    v_mfma_f32_16x16x32_bf16 v[124:127], v[196:199], v[12:15], v[124:127]
    buffer_load_dwordx4 v[4:7], v238, s[48:51], s66 offen offset:2048
    ds_read_b128 v[192:195], v205 offset:24064
    v_mfma_f32_16x16x32_bf16 v[88:91], v[200:203], v[8:11], v[88:91]
    v_mfma_f32_16x16x32_bf16 v[128:131], v[200:203], v[12:15], v[128:131]
    ds_read_b128 v[196:199], v205 offset:25088
    s_waitcnt lgkmcnt(3)
    v_mfma_f32_16x16x32_bf16 v[92:95], v[180:183], v[8:11], v[92:95]
    v_mfma_f32_16x16x32_bf16 v[132:135], v[180:183], v[12:15], v[132:135]
    ds_read_b128 v[200:203], v205 offset:26112
    v_mfma_f32_16x16x32_bf16 v[96:99], v[184:187], v[8:11], v[96:99]
    v_mfma_f32_16x16x32_bf16 v[136:139], v[184:187], v[12:15], v[136:139]
    ds_read_b128 v[180:183], v205 offset:9216
    s_waitcnt lgkmcnt(3)
    v_mfma_f32_16x16x32_bf16 v[100:103], v[188:191], v[8:11], v[100:103]
    v_mfma_f32_16x16x32_bf16 v[140:143], v[188:191], v[12:15], v[140:143]
    ds_read_b128 v[184:187], v205 offset:10240
    v_mfma_f32_16x16x32_bf16 v[104:107], v[192:195], v[8:11], v[104:107]
    v_mfma_f32_16x16x32_bf16 v[144:147], v[192:195], v[12:15], v[144:147]
    ds_read_b128 v[188:191], v205 offset:11264
    s_waitcnt lgkmcnt(3)
    v_mfma_f32_16x16x32_bf16 v[108:111], v[196:199], v[8:11], v[108:111]
    v_mfma_f32_16x16x32_bf16 v[148:151], v[196:199], v[12:15], v[148:151]
    ds_read_b128 v[192:195], v205 offset:12288
    v_mfma_f32_16x16x32_bf16 v[112:115], v[200:203], v[8:11], v[112:115]
    v_mfma_f32_16x16x32_bf16 v[152:155], v[200:203], v[12:15], v[152:155]
    s_barrier
    s_waitcnt vmcnt(16)
    ds_read_b128 v[196:199], v209 offset:9216
    s_waitcnt lgkmcnt(3)
    v_mfma_f32_16x16x32_bf16 v[80:83], v[180:183], v[16:19], v[80:83]
    v_mfma_f32_16x16x32_bf16 v[120:123], v[180:183], v[20:23], v[120:123]
    buffer_load_dwordx4 v[8:11], v238, s[48:51], s29 offen offset:3072
    ds_read_b128 v[200:203], v205 offset:27648
    v_mfma_f32_16x16x32_bf16 v[84:87], v[184:187], v[16:19], v[84:87]
    v_mfma_f32_16x16x32_bf16 v[124:127], v[184:187], v[20:23], v[124:127]
    buffer_load_dwordx4 v[12:15], v238, s[48:51], s66 offen offset:3072
    ds_read_b128 v[180:183], v205 offset:28672
    s_waitcnt lgkmcnt(3)
    v_mfma_f32_16x16x32_bf16 v[88:91], v[188:191], v[16:19], v[88:91]
    v_mfma_f32_16x16x32_bf16 v[128:131], v[188:191], v[20:23], v[128:131]
    ds_read_b128 v[184:187], v205 offset:29696
    v_mfma_f32_16x16x32_bf16 v[92:95], v[192:195], v[16:19], v[92:95]
    v_mfma_f32_16x16x32_bf16 v[132:135], v[192:195], v[20:23], v[132:135]
    ds_read_b128 v[188:191], v205 offset:30720
    s_waitcnt lgkmcnt(3)
    v_mfma_f32_16x16x32_bf16 v[96:99], v[196:199], v[16:19], v[96:99]
    v_mfma_f32_16x16x32_bf16 v[136:139], v[196:199], v[20:23], v[136:139]
    ds_read_b128 v[192:195], v205 offset:13824
    v_mfma_f32_16x16x32_bf16 v[100:103], v[200:203], v[16:19], v[100:103]
    v_mfma_f32_16x16x32_bf16 v[140:143], v[200:203], v[20:23], v[140:143]
    ds_read_b128 v[196:199], v205 offset:14848
    s_waitcnt lgkmcnt(3)
    v_mfma_f32_16x16x32_bf16 v[104:107], v[180:183], v[16:19], v[104:107]
    v_mfma_f32_16x16x32_bf16 v[144:147], v[180:183], v[20:23], v[144:147]
    ds_read_b128 v[200:203], v205 offset:15872
    v_mfma_f32_16x16x32_bf16 v[108:111], v[184:187], v[16:19], v[108:111]
    v_mfma_f32_16x16x32_bf16 v[148:151], v[184:187], v[20:23], v[148:151]
    ds_read_b128 v[180:183], v205 offset:16896
    s_waitcnt lgkmcnt(3)
    v_mfma_f32_16x16x32_bf16 v[112:115], v[188:191], v[16:19], v[112:115]
    v_mfma_f32_16x16x32_bf16 v[152:155], v[188:191], v[20:23], v[152:155]
    s_waitcnt vmcnt(16)
    ds_read_b128 v[184:187], v209 offset:13824
    v_mfma_f32_16x16x32_bf16 v[80:83], v[192:195], v[24:27], v[80:83]
    v_mfma_f32_16x16x32_bf16 v[120:123], v[192:195], v[28:31], v[120:123]
    ds_read_b128 v[188:191], v205 offset:32256
    s_waitcnt lgkmcnt(3)
    v_mfma_f32_16x16x32_bf16 v[84:87], v[196:199], v[24:27], v[84:87]
    v_mfma_f32_16x16x32_bf16 v[124:127], v[196:199], v[28:31], v[124:127]
    ds_read_b128 v[192:195], v205 offset:33280
    v_mfma_f32_16x16x32_bf16 v[88:91], v[200:203], v[24:27], v[88:91]
    v_mfma_f32_16x16x32_bf16 v[128:131], v[200:203], v[28:31], v[128:131]
    ds_read_b128 v[196:199], v205 offset:34304
    s_waitcnt lgkmcnt(3)
    v_mfma_f32_16x16x32_bf16 v[92:95], v[180:183], v[24:27], v[92:95]
    v_mfma_f32_16x16x32_bf16 v[132:135], v[180:183], v[28:31], v[132:135]
    ds_read_b128 v[200:203], v205 offset:35328
    v_mfma_f32_16x16x32_bf16 v[96:99], v[184:187], v[24:27], v[96:99]
    v_mfma_f32_16x16x32_bf16 v[136:139], v[184:187], v[28:31], v[136:139]
    ds_read_b128 v[180:183], v206 offset:0
    s_waitcnt lgkmcnt(3)
    v_mfma_f32_16x16x32_bf16 v[100:103], v[188:191], v[24:27], v[100:103]
    v_mfma_f32_16x16x32_bf16 v[140:143], v[188:191], v[28:31], v[140:143]
    ds_read_b128 v[184:187], v206 offset:1024
    v_mfma_f32_16x16x32_bf16 v[104:107], v[192:195], v[24:27], v[104:107]
    v_mfma_f32_16x16x32_bf16 v[144:147], v[192:195], v[28:31], v[144:147]
    ds_read_b128 v[188:191], v206 offset:2048
    s_waitcnt lgkmcnt(3)
    v_mfma_f32_16x16x32_bf16 v[108:111], v[196:199], v[24:27], v[108:111]
    v_mfma_f32_16x16x32_bf16 v[148:151], v[196:199], v[28:31], v[148:151]
    ds_read_b128 v[192:195], v206 offset:3072
    v_mfma_f32_16x16x32_bf16 v[112:115], v[200:203], v[24:27], v[112:115]
    v_mfma_f32_16x16x32_bf16 v[152:155], v[200:203], v[28:31], v[152:155]
    s_waitcnt vmcnt(14)
    ds_read_b128 v[196:199], v210 offset:0
    s_waitcnt lgkmcnt(3)
    v_mfma_f32_16x16x32_bf16 v[80:83], v[180:183], v[32:35], v[80:83]
    v_mfma_f32_16x16x32_bf16 v[120:123], v[180:183], v[36:39], v[120:123]
    ds_read_b128 v[200:203], v206 offset:18432
    v_mfma_f32_16x16x32_bf16 v[84:87], v[184:187], v[32:35], v[84:87]
    v_mfma_f32_16x16x32_bf16 v[124:127], v[184:187], v[36:39], v[124:127]
    ds_read_b128 v[180:183], v206 offset:19456
    s_waitcnt lgkmcnt(3)
    v_mfma_f32_16x16x32_bf16 v[88:91], v[188:191], v[32:35], v[88:91]
    v_mfma_f32_16x16x32_bf16 v[128:131], v[188:191], v[36:39], v[128:131]
    ds_read_b128 v[184:187], v206 offset:20480
    v_mfma_f32_16x16x32_bf16 v[92:95], v[192:195], v[32:35], v[92:95]
    v_mfma_f32_16x16x32_bf16 v[132:135], v[192:195], v[36:39], v[132:135]
    ds_read_b128 v[188:191], v206 offset:21504
    s_waitcnt lgkmcnt(3)
    v_mfma_f32_16x16x32_bf16 v[96:99], v[196:199], v[32:35], v[96:99]
    v_mfma_f32_16x16x32_bf16 v[136:139], v[196:199], v[36:39], v[136:139]
    ds_read_b128 v[192:195], v206 offset:4608
    v_mfma_f32_16x16x32_bf16 v[100:103], v[200:203], v[32:35], v[100:103]
    v_mfma_f32_16x16x32_bf16 v[140:143], v[200:203], v[36:39], v[140:143]
    ds_read_b128 v[196:199], v206 offset:5632
    s_waitcnt lgkmcnt(3)
    v_mfma_f32_16x16x32_bf16 v[104:107], v[180:183], v[32:35], v[104:107]
    v_mfma_f32_16x16x32_bf16 v[144:147], v[180:183], v[36:39], v[144:147]
    ds_read_b128 v[200:203], v206 offset:6656
    v_mfma_f32_16x16x32_bf16 v[108:111], v[184:187], v[32:35], v[108:111]
    v_mfma_f32_16x16x32_bf16 v[148:151], v[184:187], v[36:39], v[148:151]
    ds_read_b128 v[180:183], v206 offset:7680
    s_waitcnt lgkmcnt(3)
    v_mfma_f32_16x16x32_bf16 v[112:115], v[188:191], v[32:35], v[112:115]
    v_mfma_f32_16x16x32_bf16 v[152:155], v[188:191], v[36:39], v[152:155]
    s_waitcnt vmcnt(12)
    ds_read_b128 v[184:187], v210 offset:4608
    v_mfma_f32_16x16x32_bf16 v[80:83], v[192:195], v[40:43], v[80:83]
    v_mfma_f32_16x16x32_bf16 v[120:123], v[192:195], v[44:47], v[120:123]
    ds_read_b128 v[188:191], v206 offset:23040
    s_waitcnt lgkmcnt(3)
    v_mfma_f32_16x16x32_bf16 v[84:87], v[196:199], v[40:43], v[84:87]
    v_mfma_f32_16x16x32_bf16 v[124:127], v[196:199], v[44:47], v[124:127]
    ds_read_b128 v[192:195], v206 offset:24064
    v_mfma_f32_16x16x32_bf16 v[88:91], v[200:203], v[40:43], v[88:91]
    v_mfma_f32_16x16x32_bf16 v[128:131], v[200:203], v[44:47], v[128:131]
    ds_read_b128 v[196:199], v206 offset:25088
    s_waitcnt lgkmcnt(3)
    v_mfma_f32_16x16x32_bf16 v[92:95], v[180:183], v[40:43], v[92:95]
    v_mfma_f32_16x16x32_bf16 v[132:135], v[180:183], v[44:47], v[132:135]
    ds_read_b128 v[200:203], v206 offset:26112
    v_mfma_f32_16x16x32_bf16 v[96:99], v[184:187], v[40:43], v[96:99]
    v_mfma_f32_16x16x32_bf16 v[136:139], v[184:187], v[44:47], v[136:139]
    ds_read_b128 v[180:183], v206 offset:9216
    s_waitcnt lgkmcnt(3)
    v_mfma_f32_16x16x32_bf16 v[100:103], v[188:191], v[40:43], v[100:103]
    v_mfma_f32_16x16x32_bf16 v[140:143], v[188:191], v[44:47], v[140:143]
    ds_read_b128 v[184:187], v206 offset:10240
    v_mfma_f32_16x16x32_bf16 v[104:107], v[192:195], v[40:43], v[104:107]
    v_mfma_f32_16x16x32_bf16 v[144:147], v[192:195], v[44:47], v[144:147]
    ds_read_b128 v[188:191], v206 offset:11264
    s_waitcnt lgkmcnt(3)
    v_mfma_f32_16x16x32_bf16 v[108:111], v[196:199], v[40:43], v[108:111]
    v_mfma_f32_16x16x32_bf16 v[148:151], v[196:199], v[44:47], v[148:151]
    ds_read_b128 v[192:195], v206 offset:12288
    v_mfma_f32_16x16x32_bf16 v[112:115], v[200:203], v[40:43], v[112:115]
    v_mfma_f32_16x16x32_bf16 v[152:155], v[200:203], v[44:47], v[152:155]
    s_barrier
    s_waitcnt vmcnt(10)
    ds_read_b128 v[196:199], v210 offset:9216
    s_waitcnt lgkmcnt(3)
    v_mfma_f32_16x16x32_bf16 v[80:83], v[180:183], v[48:51], v[80:83]
    v_mfma_f32_16x16x32_bf16 v[120:123], v[180:183], v[52:55], v[120:123]
    s_add_u32 s29, s28, 32768
    buffer_load_dwordx4 v[16:19], v238, s[48:51], s29 offen offset:0
    ds_read_b128 v[200:203], v206 offset:27648
    v_mfma_f32_16x16x32_bf16 v[84:87], v[184:187], v[48:51], v[84:87]
    v_mfma_f32_16x16x32_bf16 v[124:127], v[184:187], v[52:55], v[124:127]
    s_add_u32 s66, s65, 32768
    buffer_load_dwordx4 v[20:23], v238, s[48:51], s66 offen offset:0
    ds_read_b128 v[180:183], v206 offset:28672
    s_waitcnt lgkmcnt(3)
    v_mfma_f32_16x16x32_bf16 v[88:91], v[188:191], v[48:51], v[88:91]
    v_mfma_f32_16x16x32_bf16 v[128:131], v[188:191], v[52:55], v[128:131]
    buffer_load_dwordx4 v[24:27], v238, s[48:51], s29 offen offset:1024
    ds_read_b128 v[184:187], v206 offset:29696
    v_mfma_f32_16x16x32_bf16 v[92:95], v[192:195], v[48:51], v[92:95]
    v_mfma_f32_16x16x32_bf16 v[132:135], v[192:195], v[52:55], v[132:135]
    buffer_load_dwordx4 v[28:31], v238, s[48:51], s66 offen offset:1024
    ds_read_b128 v[188:191], v206 offset:30720
    s_waitcnt lgkmcnt(3)
    v_mfma_f32_16x16x32_bf16 v[96:99], v[196:199], v[48:51], v[96:99]
    v_mfma_f32_16x16x32_bf16 v[136:139], v[196:199], v[52:55], v[136:139]
    ds_read_b128 v[192:195], v206 offset:13824
    v_mfma_f32_16x16x32_bf16 v[100:103], v[200:203], v[48:51], v[100:103]
    v_mfma_f32_16x16x32_bf16 v[140:143], v[200:203], v[52:55], v[140:143]
    buffer_load_dwordx4 v[32:35], v238, s[48:51], s29 offen offset:2048
    ds_read_b128 v[196:199], v206 offset:14848
    s_waitcnt lgkmcnt(3)
    v_mfma_f32_16x16x32_bf16 v[104:107], v[180:183], v[48:51], v[104:107]
    v_mfma_f32_16x16x32_bf16 v[144:147], v[180:183], v[52:55], v[144:147]
    buffer_load_dwordx4 v[36:39], v238, s[48:51], s66 offen offset:2048
    ds_read_b128 v[200:203], v206 offset:15872
    v_mfma_f32_16x16x32_bf16 v[108:111], v[184:187], v[48:51], v[108:111]
    v_mfma_f32_16x16x32_bf16 v[148:151], v[184:187], v[52:55], v[148:151]
    buffer_load_dwordx4 v[40:43], v238, s[48:51], s29 offen offset:3072
    ds_read_b128 v[180:183], v206 offset:16896
    s_waitcnt lgkmcnt(3)
    v_mfma_f32_16x16x32_bf16 v[112:115], v[188:191], v[48:51], v[112:115]
    v_mfma_f32_16x16x32_bf16 v[152:155], v[188:191], v[52:55], v[152:155]
    s_waitcnt vmcnt(15)
    ds_read_b128 v[184:187], v210 offset:13824
    v_mfma_f32_16x16x32_bf16 v[80:83], v[192:195], v[56:59], v[80:83]
    v_mfma_f32_16x16x32_bf16 v[120:123], v[192:195], v[60:63], v[120:123]
    buffer_load_dwordx4 v[44:47], v238, s[48:51], s66 offen offset:3072
    ds_read_b128 v[188:191], v206 offset:32256
    s_waitcnt lgkmcnt(3)
    v_mfma_f32_16x16x32_bf16 v[84:87], v[196:199], v[56:59], v[84:87]
    v_mfma_f32_16x16x32_bf16 v[124:127], v[196:199], v[60:63], v[124:127]
    s_mul_i32 s29, s21, 165888
    s_add_u32 s29, s29, 147456
    buffer_load_dwordx4 v[48:51], v238, s[48:51], s29 offen offset:0
    ds_read_b128 v[192:195], v206 offset:33280
    v_mfma_f32_16x16x32_bf16 v[88:91], v[200:203], v[56:59], v[88:91]
    v_mfma_f32_16x16x32_bf16 v[128:131], v[200:203], v[60:63], v[128:131]
    ds_read_b128 v[196:199], v206 offset:34304
    s_waitcnt lgkmcnt(3)
    v_mfma_f32_16x16x32_bf16 v[92:95], v[180:183], v[56:59], v[92:95]
    v_mfma_f32_16x16x32_bf16 v[132:135], v[180:183], v[60:63], v[132:135]
    ds_read_b128 v[200:203], v206 offset:35328
    v_mfma_f32_16x16x32_bf16 v[96:99], v[184:187], v[56:59], v[96:99]
    v_mfma_f32_16x16x32_bf16 v[136:139], v[184:187], v[60:63], v[136:139]
    ds_read_b128 v[180:183], v207 offset:0
    s_waitcnt lgkmcnt(3)
    v_mfma_f32_16x16x32_bf16 v[100:103], v[188:191], v[56:59], v[100:103]
    v_mfma_f32_16x16x32_bf16 v[140:143], v[188:191], v[60:63], v[140:143]
    ds_read_b128 v[184:187], v207 offset:1024
    v_mfma_f32_16x16x32_bf16 v[104:107], v[192:195], v[56:59], v[104:107]
    v_mfma_f32_16x16x32_bf16 v[144:147], v[192:195], v[60:63], v[144:147]
    ds_read_b128 v[188:191], v207 offset:2048
    s_waitcnt lgkmcnt(3)
    v_mfma_f32_16x16x32_bf16 v[108:111], v[196:199], v[56:59], v[108:111]
    v_mfma_f32_16x16x32_bf16 v[148:151], v[196:199], v[60:63], v[148:151]
    ds_read_b128 v[192:195], v207 offset:3072
    v_mfma_f32_16x16x32_bf16 v[112:115], v[200:203], v[56:59], v[112:115]
    v_mfma_f32_16x16x32_bf16 v[152:155], v[200:203], v[60:63], v[152:155]
    s_waitcnt vmcnt(15)
    ds_read_b128 v[196:199], v211 offset:0
    s_waitcnt lgkmcnt(3)
    v_mfma_f32_16x16x32_bf16 v[80:83], v[180:183], v[64:67], v[80:83]
    v_mfma_f32_16x16x32_bf16 v[120:123], v[180:183], v[68:71], v[120:123]
    buffer_load_dwordx4 v[56:59], v238, s[48:51], s29 offen offset:1024
    ds_read_b128 v[200:203], v207 offset:18432
    v_mfma_f32_16x16x32_bf16 v[84:87], v[184:187], v[64:67], v[84:87]
    v_mfma_f32_16x16x32_bf16 v[124:127], v[184:187], v[68:71], v[124:127]
    ds_read_b128 v[180:183], v207 offset:19456
    s_waitcnt lgkmcnt(3)
    v_mfma_f32_16x16x32_bf16 v[88:91], v[188:191], v[64:67], v[88:91]
    v_mfma_f32_16x16x32_bf16 v[128:131], v[188:191], v[68:71], v[128:131]
    ds_read_b128 v[184:187], v207 offset:20480
    v_mfma_f32_16x16x32_bf16 v[92:95], v[192:195], v[64:67], v[92:95]
    v_mfma_f32_16x16x32_bf16 v[132:135], v[192:195], v[68:71], v[132:135]
    ds_read_b128 v[188:191], v207 offset:21504
    s_waitcnt lgkmcnt(3)
    v_mfma_f32_16x16x32_bf16 v[96:99], v[196:199], v[64:67], v[96:99]
    v_mfma_f32_16x16x32_bf16 v[136:139], v[196:199], v[68:71], v[136:139]
    ds_read_b128 v[192:195], v207 offset:4608
    v_mfma_f32_16x16x32_bf16 v[100:103], v[200:203], v[64:67], v[100:103]
    v_mfma_f32_16x16x32_bf16 v[140:143], v[200:203], v[68:71], v[140:143]
    ds_read_b128 v[196:199], v207 offset:5632
    s_waitcnt lgkmcnt(3)
    v_mfma_f32_16x16x32_bf16 v[104:107], v[180:183], v[64:67], v[104:107]
    v_mfma_f32_16x16x32_bf16 v[144:147], v[180:183], v[68:71], v[144:147]
    ds_read_b128 v[200:203], v207 offset:6656
    v_mfma_f32_16x16x32_bf16 v[108:111], v[184:187], v[64:67], v[108:111]
    v_mfma_f32_16x16x32_bf16 v[148:151], v[184:187], v[68:71], v[148:151]
    ds_read_b128 v[180:183], v207 offset:7680
    s_waitcnt lgkmcnt(3)
    v_mfma_f32_16x16x32_bf16 v[112:115], v[188:191], v[64:67], v[112:115]
    v_mfma_f32_16x16x32_bf16 v[152:155], v[188:191], v[68:71], v[152:155]
    s_waitcnt vmcnt(14)
    ds_read_b128 v[184:187], v211 offset:4608
    v_mfma_f32_16x16x32_bf16 v[80:83], v[192:195], v[72:75], v[80:83]
    v_mfma_f32_16x16x32_bf16 v[120:123], v[192:195], v[76:79], v[120:123]
    buffer_load_dwordx4 v[64:67], v238, s[48:51], s29 offen offset:2048
    ds_read_b128 v[188:191], v207 offset:23040
    s_waitcnt lgkmcnt(3)
    v_mfma_f32_16x16x32_bf16 v[84:87], v[196:199], v[72:75], v[84:87]
    v_mfma_f32_16x16x32_bf16 v[124:127], v[196:199], v[76:79], v[124:127]
    ds_read_b128 v[192:195], v207 offset:24064
    v_mfma_f32_16x16x32_bf16 v[88:91], v[200:203], v[72:75], v[88:91]
    v_mfma_f32_16x16x32_bf16 v[128:131], v[200:203], v[76:79], v[128:131]
    ds_read_b128 v[196:199], v207 offset:25088
    s_waitcnt lgkmcnt(3)
    v_mfma_f32_16x16x32_bf16 v[92:95], v[180:183], v[72:75], v[92:95]
    v_mfma_f32_16x16x32_bf16 v[132:135], v[180:183], v[76:79], v[132:135]
    ds_read_b128 v[200:203], v207 offset:26112
    v_mfma_f32_16x16x32_bf16 v[96:99], v[184:187], v[72:75], v[96:99]
    v_mfma_f32_16x16x32_bf16 v[136:139], v[184:187], v[76:79], v[136:139]
    ds_read_b128 v[180:183], v207 offset:9216
    s_waitcnt lgkmcnt(3)
    v_mfma_f32_16x16x32_bf16 v[100:103], v[188:191], v[72:75], v[100:103]
    v_mfma_f32_16x16x32_bf16 v[140:143], v[188:191], v[76:79], v[140:143]
    ds_read_b128 v[184:187], v207 offset:10240
    v_mfma_f32_16x16x32_bf16 v[104:107], v[192:195], v[72:75], v[104:107]
    v_mfma_f32_16x16x32_bf16 v[144:147], v[192:195], v[76:79], v[144:147]
    ds_read_b128 v[188:191], v207 offset:11264
    s_waitcnt lgkmcnt(3)
    v_mfma_f32_16x16x32_bf16 v[108:111], v[196:199], v[72:75], v[108:111]
    v_mfma_f32_16x16x32_bf16 v[148:151], v[196:199], v[76:79], v[148:151]
    ds_read_b128 v[192:195], v207 offset:12288
    v_mfma_f32_16x16x32_bf16 v[112:115], v[200:203], v[72:75], v[112:115]
    v_mfma_f32_16x16x32_bf16 v[152:155], v[200:203], v[76:79], v[152:155]
    s_barrier
    s_waitcnt vmcnt(13)
    ds_read_b128 v[196:199], v211 offset:9216
    s_waitcnt lgkmcnt(3)
    v_mfma_f32_16x16x32_bf16 v[80:83], v[180:183], v[0:3], v[80:83]
    v_mfma_f32_16x16x32_bf16 v[120:123], v[180:183], v[4:7], v[120:123]
    buffer_load_dwordx4 v[72:75], v238, s[48:51], s29 offen offset:3072
    ds_read_b128 v[200:203], v207 offset:27648
    v_mfma_f32_16x16x32_bf16 v[84:87], v[184:187], v[0:3], v[84:87]
    v_mfma_f32_16x16x32_bf16 v[124:127], v[184:187], v[4:7], v[124:127]
    ds_read_b128 v[180:183], v207 offset:28672
    s_waitcnt lgkmcnt(3)
    v_mfma_f32_16x16x32_bf16 v[88:91], v[188:191], v[0:3], v[88:91]
    v_mfma_f32_16x16x32_bf16 v[128:131], v[188:191], v[4:7], v[128:131]
    ds_read_b128 v[184:187], v207 offset:29696
    v_mfma_f32_16x16x32_bf16 v[92:95], v[192:195], v[0:3], v[92:95]
    v_mfma_f32_16x16x32_bf16 v[132:135], v[192:195], v[4:7], v[132:135]
    ds_read_b128 v[188:191], v207 offset:30720
    s_waitcnt lgkmcnt(3)
    v_mfma_f32_16x16x32_bf16 v[96:99], v[196:199], v[0:3], v[96:99]
    v_mfma_f32_16x16x32_bf16 v[136:139], v[196:199], v[4:7], v[136:139]
    ds_read_b128 v[192:195], v207 offset:13824
    v_mfma_f32_16x16x32_bf16 v[100:103], v[200:203], v[0:3], v[100:103]
    v_mfma_f32_16x16x32_bf16 v[140:143], v[200:203], v[4:7], v[140:143]
    ds_read_b128 v[196:199], v207 offset:14848
    s_waitcnt lgkmcnt(3)
    v_mfma_f32_16x16x32_bf16 v[104:107], v[180:183], v[0:3], v[104:107]
    v_mfma_f32_16x16x32_bf16 v[144:147], v[180:183], v[4:7], v[144:147]
    ds_read_b128 v[200:203], v207 offset:15872
    v_mfma_f32_16x16x32_bf16 v[108:111], v[184:187], v[0:3], v[108:111]
    v_mfma_f32_16x16x32_bf16 v[148:151], v[184:187], v[4:7], v[148:151]
    ds_read_b128 v[180:183], v207 offset:16896
    s_waitcnt lgkmcnt(3)
    v_mfma_f32_16x16x32_bf16 v[112:115], v[188:191], v[0:3], v[112:115]
    v_mfma_f32_16x16x32_bf16 v[152:155], v[188:191], v[4:7], v[152:155]
    s_waitcnt vmcnt(12)
    ds_read_b128 v[184:187], v211 offset:13824
    v_mfma_f32_16x16x32_bf16 v[80:83], v[192:195], v[8:11], v[80:83]
    v_mfma_f32_16x16x32_bf16 v[120:123], v[192:195], v[12:15], v[120:123]
    s_mul_i32 s29, s21, 165888
    s_add_u32 s29, s29, 151552
    buffer_load_dwordx4 v[0:3], v238, s[48:51], s29 offen offset:0
    ds_read_b128 v[188:191], v207 offset:32256
    s_waitcnt lgkmcnt(3)
    v_mfma_f32_16x16x32_bf16 v[84:87], v[196:199], v[8:11], v[84:87]
    v_mfma_f32_16x16x32_bf16 v[124:127], v[196:199], v[12:15], v[124:127]
    ds_read_b128 v[192:195], v207 offset:33280
    v_mfma_f32_16x16x32_bf16 v[88:91], v[200:203], v[8:11], v[88:91]
    v_mfma_f32_16x16x32_bf16 v[128:131], v[200:203], v[12:15], v[128:131]
    ds_read_b128 v[196:199], v207 offset:34304
    s_waitcnt lgkmcnt(3)
    v_mfma_f32_16x16x32_bf16 v[92:95], v[180:183], v[8:11], v[92:95]
    v_mfma_f32_16x16x32_bf16 v[132:135], v[180:183], v[12:15], v[132:135]
    ds_read_b128 v[200:203], v207 offset:35328
    v_mfma_f32_16x16x32_bf16 v[96:99], v[184:187], v[8:11], v[96:99]
    v_mfma_f32_16x16x32_bf16 v[136:139], v[184:187], v[12:15], v[136:139]
    ds_read_b128 v[180:183], v204 offset:0
    s_waitcnt lgkmcnt(3)
    v_mfma_f32_16x16x32_bf16 v[100:103], v[188:191], v[8:11], v[100:103]
    v_mfma_f32_16x16x32_bf16 v[140:143], v[188:191], v[12:15], v[140:143]
    ds_read_b128 v[184:187], v204 offset:1024
    v_mfma_f32_16x16x32_bf16 v[104:107], v[192:195], v[8:11], v[104:107]
    v_mfma_f32_16x16x32_bf16 v[144:147], v[192:195], v[12:15], v[144:147]
    ds_read_b128 v[188:191], v204 offset:2048
    s_waitcnt lgkmcnt(3)
    v_mfma_f32_16x16x32_bf16 v[108:111], v[196:199], v[8:11], v[108:111]
    v_mfma_f32_16x16x32_bf16 v[148:151], v[196:199], v[12:15], v[148:151]
    ds_read_b128 v[192:195], v204 offset:3072
    v_mfma_f32_16x16x32_bf16 v[112:115], v[200:203], v[8:11], v[112:115]
    v_mfma_f32_16x16x32_bf16 v[152:155], v[200:203], v[12:15], v[152:155]
    s_waitcnt vmcnt(11)
    ds_read_b128 v[196:199], v208 offset:0
    s_waitcnt lgkmcnt(3)
    v_mfma_f32_16x16x32_bf16 v[80:83], v[180:183], v[16:19], v[80:83]
    v_mfma_f32_16x16x32_bf16 v[120:123], v[180:183], v[20:23], v[120:123]
    buffer_load_dwordx4 v[8:11], v238, s[48:51], s29 offen offset:1024
    ds_read_b128 v[200:203], v204 offset:18432
    v_mfma_f32_16x16x32_bf16 v[84:87], v[184:187], v[16:19], v[84:87]
    v_mfma_f32_16x16x32_bf16 v[124:127], v[184:187], v[20:23], v[124:127]
    ds_read_b128 v[180:183], v204 offset:19456
    s_waitcnt lgkmcnt(3)
    v_mfma_f32_16x16x32_bf16 v[88:91], v[188:191], v[16:19], v[88:91]
    v_mfma_f32_16x16x32_bf16 v[128:131], v[188:191], v[20:23], v[128:131]
    ds_read_b128 v[184:187], v204 offset:20480
    v_mfma_f32_16x16x32_bf16 v[92:95], v[192:195], v[16:19], v[92:95]
    v_mfma_f32_16x16x32_bf16 v[132:135], v[192:195], v[20:23], v[132:135]
    ds_read_b128 v[188:191], v204 offset:21504
    s_waitcnt lgkmcnt(3)
    v_mfma_f32_16x16x32_bf16 v[96:99], v[196:199], v[16:19], v[96:99]
    v_mfma_f32_16x16x32_bf16 v[136:139], v[196:199], v[20:23], v[136:139]
    ds_read_b128 v[192:195], v204 offset:4608
    v_mfma_f32_16x16x32_bf16 v[100:103], v[200:203], v[16:19], v[100:103]
    v_mfma_f32_16x16x32_bf16 v[140:143], v[200:203], v[20:23], v[140:143]
    ds_read_b128 v[196:199], v204 offset:5632
    s_waitcnt lgkmcnt(3)
    v_mfma_f32_16x16x32_bf16 v[104:107], v[180:183], v[16:19], v[104:107]
    v_mfma_f32_16x16x32_bf16 v[144:147], v[180:183], v[20:23], v[144:147]
    ds_read_b128 v[200:203], v204 offset:6656
    v_mfma_f32_16x16x32_bf16 v[108:111], v[184:187], v[16:19], v[108:111]
    v_mfma_f32_16x16x32_bf16 v[148:151], v[184:187], v[20:23], v[148:151]
    ds_read_b128 v[180:183], v204 offset:7680
    s_waitcnt lgkmcnt(3)
    v_mfma_f32_16x16x32_bf16 v[112:115], v[188:191], v[16:19], v[112:115]
    v_mfma_f32_16x16x32_bf16 v[152:155], v[188:191], v[20:23], v[152:155]
    s_waitcnt vmcnt(10)
    ds_read_b128 v[184:187], v208 offset:4608
    v_mfma_f32_16x16x32_bf16 v[80:83], v[192:195], v[24:27], v[80:83]
    v_mfma_f32_16x16x32_bf16 v[120:123], v[192:195], v[28:31], v[120:123]
    buffer_load_dwordx4 v[16:19], v238, s[48:51], s29 offen offset:2048
    ds_read_b128 v[188:191], v204 offset:23040
    s_waitcnt lgkmcnt(3)
    v_mfma_f32_16x16x32_bf16 v[84:87], v[196:199], v[24:27], v[84:87]
    v_mfma_f32_16x16x32_bf16 v[124:127], v[196:199], v[28:31], v[124:127]
    ds_read_b128 v[192:195], v204 offset:24064
    v_mfma_f32_16x16x32_bf16 v[88:91], v[200:203], v[24:27], v[88:91]
    v_mfma_f32_16x16x32_bf16 v[128:131], v[200:203], v[28:31], v[128:131]
    ds_read_b128 v[196:199], v204 offset:25088
    s_waitcnt lgkmcnt(3)
    v_mfma_f32_16x16x32_bf16 v[92:95], v[180:183], v[24:27], v[92:95]
    v_mfma_f32_16x16x32_bf16 v[132:135], v[180:183], v[28:31], v[132:135]
    ds_read_b128 v[200:203], v204 offset:26112
    v_mfma_f32_16x16x32_bf16 v[96:99], v[184:187], v[24:27], v[96:99]
    v_mfma_f32_16x16x32_bf16 v[136:139], v[184:187], v[28:31], v[136:139]
    ds_read_b128 v[180:183], v204 offset:9216
    s_waitcnt lgkmcnt(3)
    v_mfma_f32_16x16x32_bf16 v[100:103], v[188:191], v[24:27], v[100:103]
    v_mfma_f32_16x16x32_bf16 v[140:143], v[188:191], v[28:31], v[140:143]
    ds_read_b128 v[184:187], v204 offset:10240
    v_mfma_f32_16x16x32_bf16 v[104:107], v[192:195], v[24:27], v[104:107]
    v_mfma_f32_16x16x32_bf16 v[144:147], v[192:195], v[28:31], v[144:147]
    ds_read_b128 v[188:191], v204 offset:11264
    s_waitcnt lgkmcnt(3)
    v_mfma_f32_16x16x32_bf16 v[108:111], v[196:199], v[24:27], v[108:111]
    v_mfma_f32_16x16x32_bf16 v[148:151], v[196:199], v[28:31], v[148:151]
    ds_read_b128 v[192:195], v204 offset:12288
    v_mfma_f32_16x16x32_bf16 v[112:115], v[200:203], v[24:27], v[112:115]
    v_mfma_f32_16x16x32_bf16 v[152:155], v[200:203], v[28:31], v[152:155]
    s_barrier
    s_waitcnt vmcnt(9)
    ds_read_b128 v[196:199], v208 offset:9216
    s_waitcnt lgkmcnt(3)
    v_mfma_f32_16x16x32_bf16 v[80:83], v[180:183], v[32:35], v[80:83]
    v_mfma_f32_16x16x32_bf16 v[120:123], v[180:183], v[36:39], v[120:123]
    buffer_load_dwordx4 v[24:27], v238, s[48:51], s29 offen offset:3072
    ds_read_b128 v[200:203], v204 offset:27648
    v_mfma_f32_16x16x32_bf16 v[84:87], v[184:187], v[32:35], v[84:87]
    v_mfma_f32_16x16x32_bf16 v[124:127], v[184:187], v[36:39], v[124:127]
    ds_read_b128 v[180:183], v204 offset:28672
    s_waitcnt lgkmcnt(3)
    v_mfma_f32_16x16x32_bf16 v[88:91], v[188:191], v[32:35], v[88:91]
    v_mfma_f32_16x16x32_bf16 v[128:131], v[188:191], v[36:39], v[128:131]
    ds_read_b128 v[184:187], v204 offset:29696
    v_mfma_f32_16x16x32_bf16 v[92:95], v[192:195], v[32:35], v[92:95]
    v_mfma_f32_16x16x32_bf16 v[132:135], v[192:195], v[36:39], v[132:135]
    ds_read_b128 v[188:191], v204 offset:30720
    s_waitcnt lgkmcnt(3)
    v_mfma_f32_16x16x32_bf16 v[96:99], v[196:199], v[32:35], v[96:99]
    v_mfma_f32_16x16x32_bf16 v[136:139], v[196:199], v[36:39], v[136:139]
    ds_read_b128 v[192:195], v204 offset:13824
    v_mfma_f32_16x16x32_bf16 v[100:103], v[200:203], v[32:35], v[100:103]
    v_mfma_f32_16x16x32_bf16 v[140:143], v[200:203], v[36:39], v[140:143]
    ds_read_b128 v[196:199], v204 offset:14848
    s_waitcnt lgkmcnt(3)
    v_mfma_f32_16x16x32_bf16 v[104:107], v[180:183], v[32:35], v[104:107]
    v_mfma_f32_16x16x32_bf16 v[144:147], v[180:183], v[36:39], v[144:147]
    ds_read_b128 v[200:203], v204 offset:15872
    v_mfma_f32_16x16x32_bf16 v[108:111], v[184:187], v[32:35], v[108:111]
    v_mfma_f32_16x16x32_bf16 v[148:151], v[184:187], v[36:39], v[148:151]
    ds_read_b128 v[180:183], v204 offset:16896
    s_waitcnt lgkmcnt(3)
    v_mfma_f32_16x16x32_bf16 v[112:115], v[188:191], v[32:35], v[112:115]
    v_mfma_f32_16x16x32_bf16 v[152:155], v[188:191], v[36:39], v[152:155]
    s_waitcnt vmcnt(8)
    ds_read_b128 v[184:187], v208 offset:13824
    v_mfma_f32_16x16x32_bf16 v[80:83], v[192:195], v[40:43], v[80:83]
    v_mfma_f32_16x16x32_bf16 v[120:123], v[192:195], v[44:47], v[120:123]
    s_mul_i32 s29, s21, 165888
    s_add_u32 s29, s29, 155648
    buffer_load_dwordx4 v[32:35], v238, s[48:51], s29 offen offset:0
    ds_read_b128 v[188:191], v204 offset:32256
    s_waitcnt lgkmcnt(3)
    v_mfma_f32_16x16x32_bf16 v[84:87], v[196:199], v[40:43], v[84:87]
    v_mfma_f32_16x16x32_bf16 v[124:127], v[196:199], v[44:47], v[124:127]
    ds_read_b128 v[192:195], v204 offset:33280
    v_mfma_f32_16x16x32_bf16 v[88:91], v[200:203], v[40:43], v[88:91]
    v_mfma_f32_16x16x32_bf16 v[128:131], v[200:203], v[44:47], v[128:131]
    ds_read_b128 v[196:199], v204 offset:34304
    s_waitcnt lgkmcnt(3)
    v_mfma_f32_16x16x32_bf16 v[92:95], v[180:183], v[40:43], v[92:95]
    v_mfma_f32_16x16x32_bf16 v[132:135], v[180:183], v[44:47], v[132:135]
    ds_read_b128 v[200:203], v204 offset:35328
    v_mfma_f32_16x16x32_bf16 v[96:99], v[184:187], v[40:43], v[96:99]
    v_mfma_f32_16x16x32_bf16 v[136:139], v[184:187], v[44:47], v[136:139]
    v_sub_u32 v208, v208, v237
    v_sub_u32 v209, v209, v237
    v_sub_u32 v210, v210, v237
    v_sub_u32 v211, v211, v237
    ds_read_b128 v[180:183], v205 offset:0
    s_waitcnt lgkmcnt(3)
    v_mfma_f32_16x16x32_bf16 v[100:103], v[188:191], v[40:43], v[100:103]
    v_mfma_f32_16x16x32_bf16 v[140:143], v[188:191], v[44:47], v[140:143]
    ds_read_b128 v[184:187], v205 offset:1024
    v_mfma_f32_16x16x32_bf16 v[104:107], v[192:195], v[40:43], v[104:107]
    v_mfma_f32_16x16x32_bf16 v[144:147], v[192:195], v[44:47], v[144:147]
    ds_read_b128 v[188:191], v205 offset:2048
    s_waitcnt lgkmcnt(3)
    v_mfma_f32_16x16x32_bf16 v[108:111], v[196:199], v[40:43], v[108:111]
    v_mfma_f32_16x16x32_bf16 v[148:151], v[196:199], v[44:47], v[148:151]
    ds_read_b128 v[192:195], v205 offset:3072
    v_mfma_f32_16x16x32_bf16 v[112:115], v[200:203], v[40:43], v[112:115]
    v_mfma_f32_16x16x32_bf16 v[152:155], v[200:203], v[44:47], v[152:155]
    s_waitcnt vmcnt(8)
    ds_read_b128 v[196:199], v209 offset:0
    s_waitcnt lgkmcnt(3)
    v_mfma_f32_16x16x32_bf16 v[160:163], v[180:183], v[48:51], 0
    buffer_load_dwordx4 v[40:43], v238, s[48:51], s29 offen offset:1024
    ds_read_b128 v[200:203], v205 offset:4608
    v_mfma_f32_16x16x32_bf16 v[164:167], v[184:187], v[48:51], 0
    ds_read_b128 v[180:183], v205 offset:5632
    s_waitcnt lgkmcnt(3)
    v_mfma_f32_16x16x32_bf16 v[168:171], v[188:191], v[48:51], 0
    ds_read_b128 v[184:187], v205 offset:6656
    v_mfma_f32_16x16x32_bf16 v[172:175], v[192:195], v[48:51], 0
    ds_read_b128 v[188:191], v205 offset:7680
    s_waitcnt lgkmcnt(3)
    v_mfma_f32_16x16x32_bf16 v[176:179], v[196:199], v[48:51], 0
    s_xor_b32 s26, s2, 1
    s_mul_i32 s26, s26, 61440
    s_mul_i32 s27, s3, 5120
    s_add_u32 s26, s26, s27
    s_add_u32 s26, s26, 0
    v_cvt_pk_bf16_f32 v100, v100, v101
    v_cvt_pk_bf16_f32 v101, v102, v103
    v_cvt_pk_bf16_f32 v102, v104, v105
    v_cvt_pk_bf16_f32 v103, v106, v107
    buffer_store_dwordx4 v[100:103], v238, s[44:47], s26 offen offset:0 sc1
    s_waitcnt vmcnt(9)
    ds_read_b128 v[192:195], v209 offset:4608
    v_mfma_f32_16x16x32_bf16 v[160:163], v[200:203], v[56:59], v[160:163]
    v_cvt_pk_bf16_f32 v108, v108, v109
    v_cvt_pk_bf16_f32 v109, v110, v111
    v_cvt_pk_bf16_f32 v110, v112, v113
    v_cvt_pk_bf16_f32 v111, v114, v115
    buffer_store_dwordx4 v[108:111], v238, s[44:47], s26 offen offset:1024 sc1
    buffer_load_dwordx4 v[48:51], v238, s[48:51], s29 offen offset:2048
    ds_read_b128 v[196:199], v205 offset:9216
    s_waitcnt lgkmcnt(3)
    v_mfma_f32_16x16x32_bf16 v[164:167], v[180:183], v[56:59], v[164:167]
    v_cvt_pk_bf16_f32 v116, v96, v97
    v_cvt_pk_bf16_f32 v117, v98, v99
    buffer_store_dwordx2 v[116:117], v233, s[44:47], s26 offen offset:2048 sc1
    ds_read_b128 v[200:203], v205 offset:10240
    v_mfma_f32_16x16x32_bf16 v[168:171], v[184:187], v[56:59], v[168:171]
    s_xor_b32 s26, s2, 2
    s_mul_i32 s26, s26, 61440
    s_mul_i32 s27, s3, 5120
    s_add_u32 s26, s26, s27
    s_add_u32 s26, s26, 20480
    v_cvt_pk_bf16_f32 v120, v120, v121
    v_cvt_pk_bf16_f32 v121, v122, v123
    v_cvt_pk_bf16_f32 v122, v124, v125
    v_cvt_pk_bf16_f32 v123, v126, v127
    buffer_store_dwordx4 v[120:123], v238, s[44:47], s26 offen offset:0 sc1
    ds_read_b128 v[180:183], v205 offset:11264
    s_waitcnt lgkmcnt(3)
    v_mfma_f32_16x16x32_bf16 v[172:175], v[188:191], v[56:59], v[172:175]
    v_cvt_pk_bf16_f32 v128, v128, v129
    v_cvt_pk_bf16_f32 v129, v130, v131
    v_cvt_pk_bf16_f32 v130, v132, v133
    v_cvt_pk_bf16_f32 v131, v134, v135
    buffer_store_dwordx4 v[128:131], v238, s[44:47], s26 offen offset:1024 sc1
    ds_read_b128 v[184:187], v205 offset:12288
    v_mfma_f32_16x16x32_bf16 v[176:179], v[192:195], v[56:59], v[176:179]
    v_cvt_pk_bf16_f32 v158, v136, v137
    v_cvt_pk_bf16_f32 v159, v138, v139
    buffer_store_dwordx2 v[158:159], v233, s[44:47], s26 offen offset:2048 sc1
    s_waitcnt vmcnt(14)
    ds_read_b128 v[188:191], v209 offset:9216
    s_waitcnt lgkmcnt(3)
    v_mfma_f32_16x16x32_bf16 v[160:163], v[196:199], v[64:67], v[160:163]
    s_xor_b32 s26, s2, 3
    s_mul_i32 s26, s26, 61440
    s_mul_i32 s27, s3, 5120
    s_add_u32 s26, s26, s27
    s_add_u32 s26, s26, 40960
    v_cvt_pk_bf16_f32 v140, v140, v141
    v_cvt_pk_bf16_f32 v141, v142, v143
    v_cvt_pk_bf16_f32 v142, v144, v145
    v_cvt_pk_bf16_f32 v143, v146, v147
    buffer_store_dwordx4 v[140:143], v238, s[44:47], s26 offen offset:0 sc1
    buffer_load_dwordx4 v[56:59], v238, s[48:51], s29 offen offset:3072
    ds_read_b128 v[192:195], v205 offset:13824
    v_mfma_f32_16x16x32_bf16 v[164:167], v[200:203], v[64:67], v[164:167]
    v_cvt_pk_bf16_f32 v148, v148, v149
    v_cvt_pk_bf16_f32 v149, v150, v151
    v_cvt_pk_bf16_f32 v150, v152, v153
    v_cvt_pk_bf16_f32 v151, v154, v155
    buffer_store_dwordx4 v[148:151], v238, s[44:47], s26 offen offset:1024 sc1
    ds_read_b128 v[196:199], v205 offset:14848
    s_waitcnt lgkmcnt(3)
    v_mfma_f32_16x16x32_bf16 v[168:171], v[180:183], v[64:67], v[168:171]
    v_cvt_pk_bf16_f32 v156, v136, v137
    v_cvt_pk_bf16_f32 v157, v138, v139
    buffer_store_dwordx2 v[156:157], v233, s[44:47], s26 offen offset:2048 sc1
    ds_read_b128 v[200:203], v205 offset:15872
    v_mfma_f32_16x16x32_bf16 v[172:175], v[184:187], v[64:67], v[172:175]
    ds_read_b128 v[180:183], v205 offset:16896
    s_waitcnt lgkmcnt(3)
    v_mfma_f32_16x16x32_bf16 v[176:179], v[188:191], v[64:67], v[176:179]
    s_waitcnt vmcnt(17)
    ds_read_b128 v[184:187], v209 offset:13824
    v_mfma_f32_16x16x32_bf16 v[160:163], v[192:195], v[72:75], v[160:163]
    s_mul_i32 s29, s21, 165888
    s_add_u32 s29, s29, 159744
    buffer_load_dwordx4 v[64:67], v238, s[48:51], s29 offen offset:0
    ds_read_b128 v[188:191], v205 offset:18432
    s_waitcnt lgkmcnt(3)
    v_mfma_f32_16x16x32_bf16 v[164:167], v[196:199], v[72:75], v[164:167]
    ds_read_b128 v[192:195], v205 offset:19456
    v_mfma_f32_16x16x32_bf16 v[168:171], v[200:203], v[72:75], v[168:171]
    ds_read_b128 v[196:199], v205 offset:20480
    s_waitcnt lgkmcnt(3)
    v_mfma_f32_16x16x32_bf16 v[172:175], v[180:183], v[72:75], v[172:175]
    ds_read_b128 v[200:203], v205 offset:21504
    v_mfma_f32_16x16x32_bf16 v[176:179], v[184:187], v[72:75], v[176:179]
    s_barrier
    s_waitcnt vmcnt(17)
    ds_read_b128 v[180:183], v209 offset:18432
    s_waitcnt lgkmcnt(3)
    v_mfma_f32_16x16x32_bf16 v[160:163], v[188:191], v[0:3], v[160:163]
    buffer_load_dwordx4 v[72:75], v238, s[48:51], s29 offen offset:1024
    ds_read_b128 v[184:187], v205 offset:23040
    v_mfma_f32_16x16x32_bf16 v[164:167], v[192:195], v[0:3], v[164:167]
    ds_read_b128 v[188:191], v205 offset:24064
    s_waitcnt lgkmcnt(3)
    v_mfma_f32_16x16x32_bf16 v[168:171], v[196:199], v[0:3], v[168:171]
    ds_read_b128 v[192:195], v205 offset:25088
    v_mfma_f32_16x16x32_bf16 v[172:175], v[200:203], v[0:3], v[172:175]
    ds_read_b128 v[196:199], v205 offset:26112
    s_waitcnt lgkmcnt(3)
    v_mfma_f32_16x16x32_bf16 v[176:179], v[180:183], v[0:3], v[176:179]
    s_waitcnt vmcnt(17)
    ds_read_b128 v[200:203], v209 offset:23040
    v_mfma_f32_16x16x32_bf16 v[160:163], v[184:187], v[8:11], v[160:163]
    buffer_load_dwordx4 v[0:3], v238, s[48:51], s29 offen offset:2048
    ds_read_b128 v[180:183], v205 offset:27648
    s_waitcnt lgkmcnt(3)
    v_mfma_f32_16x16x32_bf16 v[164:167], v[188:191], v[8:11], v[164:167]
    ds_read_b128 v[184:187], v205 offset:28672
    v_mfma_f32_16x16x32_bf16 v[168:171], v[192:195], v[8:11], v[168:171]
    ds_read_b128 v[188:191], v205 offset:29696
    s_waitcnt lgkmcnt(3)
    v_mfma_f32_16x16x32_bf16 v[172:175], v[196:199], v[8:11], v[172:175]
    ds_read_b128 v[192:195], v205 offset:30720
    v_mfma_f32_16x16x32_bf16 v[176:179], v[200:203], v[8:11], v[176:179]
    s_waitcnt vmcnt(17)
    ds_read_b128 v[196:199], v209 offset:27648
    s_waitcnt lgkmcnt(3)
    v_mfma_f32_16x16x32_bf16 v[160:163], v[180:183], v[16:19], v[160:163]
    buffer_load_dwordx4 v[8:11], v238, s[48:51], s29 offen offset:3072
    ds_read_b128 v[200:203], v205 offset:32256
    v_mfma_f32_16x16x32_bf16 v[164:167], v[184:187], v[16:19], v[164:167]
    ds_read_b128 v[180:183], v205 offset:33280
    s_waitcnt lgkmcnt(3)
    v_mfma_f32_16x16x32_bf16 v[168:171], v[188:191], v[16:19], v[168:171]
    ds_read_b128 v[184:187], v205 offset:34304
    v_mfma_f32_16x16x32_bf16 v[172:175], v[192:195], v[16:19], v[172:175]
    ds_read_b128 v[188:191], v205 offset:35328
    s_waitcnt lgkmcnt(3)
    v_mfma_f32_16x16x32_bf16 v[176:179], v[196:199], v[16:19], v[176:179]
    s_waitcnt vmcnt(17)
    ds_read_b128 v[192:195], v209 offset:32256
    v_mfma_f32_16x16x32_bf16 v[160:163], v[200:203], v[24:27], v[160:163]
    s_mul_i32 s29, s21, 165888
    s_add_u32 s29, s29, 163840
    buffer_load_dwordx4 v[16:19], v238, s[48:51], s29 offen offset:0
    ds_read_b128 v[196:199], v206 offset:0
    s_waitcnt lgkmcnt(3)
    v_mfma_f32_16x16x32_bf16 v[164:167], v[180:183], v[24:27], v[164:167]
    ds_read_b128 v[200:203], v206 offset:1024
    v_mfma_f32_16x16x32_bf16 v[168:171], v[184:187], v[24:27], v[168:171]
    ds_read_b128 v[180:183], v206 offset:2048
    s_waitcnt lgkmcnt(3)
    v_mfma_f32_16x16x32_bf16 v[172:175], v[188:191], v[24:27], v[172:175]
    ds_read_b128 v[184:187], v206 offset:3072
    v_mfma_f32_16x16x32_bf16 v[176:179], v[192:195], v[24:27], v[176:179]
    s_waitcnt vmcnt(17)
    ds_read_b128 v[188:191], v210 offset:0
    s_waitcnt lgkmcnt(3)
    v_mfma_f32_16x16x32_bf16 v[160:163], v[196:199], v[32:35], v[160:163]
    buffer_load_dwordx4 v[24:27], v238, s[48:51], s29 offen offset:1024
    ds_read_b128 v[192:195], v206 offset:4608
    v_mfma_f32_16x16x32_bf16 v[164:167], v[200:203], v[32:35], v[164:167]
    ds_read_b128 v[196:199], v206 offset:5632
    s_waitcnt lgkmcnt(3)
    v_mfma_f32_16x16x32_bf16 v[168:171], v[180:183], v[32:35], v[168:171]
    ds_read_b128 v[200:203], v206 offset:6656
    v_mfma_f32_16x16x32_bf16 v[172:175], v[184:187], v[32:35], v[172:175]
    ds_read_b128 v[180:183], v206 offset:7680
    s_waitcnt lgkmcnt(3)
    v_mfma_f32_16x16x32_bf16 v[176:179], v[188:191], v[32:35], v[176:179]
    s_waitcnt vmcnt(6)
    s_waitcnt lgkmcnt(0)
    s_memrealtime s[90:91]
    s_mul_i32 s26, s3, 24
    s_waitcnt lgkmcnt(0)
    v_mov_b32 v226, s90
    v_xor_b32 v227, 0x5bd1e995, v226
    s_mov_b64 exec, 7
    buffer_store_dwordx2 v[226:227], v236, s[56:59], s26 offen offset:2048 sc1
    s_mov_b64 exec, -1
    ds_read_b128 v[184:187], v210 offset:4608
    v_mfma_f32_16x16x32_bf16 v[160:163], v[192:195], v[40:43], v[160:163]
    ds_read_b128 v[188:191], v206 offset:9216
    v_mfma_f32_16x16x32_bf16 v[164:167], v[196:199], v[40:43], v[164:167]
    ds_read_b128 v[192:195], v206 offset:10240
    v_mfma_f32_16x16x32_bf16 v[168:171], v[200:203], v[40:43], v[168:171]
    ds_read_b128 v[196:199], v206 offset:11264
    s_waitcnt lgkmcnt(3)
    v_mfma_f32_16x16x32_bf16 v[172:175], v[180:183], v[40:43], v[172:175]
    ds_read_b128 v[200:203], v206 offset:12288
    v_mfma_f32_16x16x32_bf16 v[176:179], v[184:187], v[40:43], v[176:179]
    ds_read_b128 v[180:183], v210 offset:9216
    s_waitcnt lgkmcnt(3)
    v_mfma_f32_16x16x32_bf16 v[160:163], v[188:191], v[48:51], v[160:163]
    ds_read_b128 v[184:187], v206 offset:13824
    v_mfma_f32_16x16x32_bf16 v[164:167], v[192:195], v[48:51], v[164:167]
    ds_read_b128 v[188:191], v206 offset:14848
    s_waitcnt lgkmcnt(3)
    v_mfma_f32_16x16x32_bf16 v[168:171], v[196:199], v[48:51], v[168:171]
    ds_read_b128 v[192:195], v206 offset:15872
    v_mfma_f32_16x16x32_bf16 v[172:175], v[200:203], v[48:51], v[172:175]
    ds_read_b128 v[196:199], v206 offset:16896
    s_waitcnt lgkmcnt(3)
    v_mfma_f32_16x16x32_bf16 v[176:179], v[180:183], v[48:51], v[176:179]
    ds_read_b128 v[200:203], v210 offset:13824
    v_mfma_f32_16x16x32_bf16 v[160:163], v[184:187], v[56:59], v[160:163]
    ds_read_b128 v[180:183], v206 offset:18432
    s_waitcnt lgkmcnt(3)
    v_mfma_f32_16x16x32_bf16 v[164:167], v[188:191], v[56:59], v[164:167]
    ds_read_b128 v[184:187], v206 offset:19456
    v_mfma_f32_16x16x32_bf16 v[168:171], v[192:195], v[56:59], v[168:171]
    ds_read_b128 v[188:191], v206 offset:20480
    s_waitcnt lgkmcnt(3)
    v_mfma_f32_16x16x32_bf16 v[172:175], v[196:199], v[56:59], v[172:175]
    ds_read_b128 v[192:195], v206 offset:21504
    v_mfma_f32_16x16x32_bf16 v[176:179], v[200:203], v[56:59], v[176:179]
    s_barrier
    s_waitcnt vmcnt(6)
    ds_read_b128 v[196:199], v210 offset:18432
    s_waitcnt lgkmcnt(3)
    v_mfma_f32_16x16x32_bf16 v[160:163], v[180:183], v[64:67], v[160:163]
    ds_read_b128 v[200:203], v206 offset:23040
    v_mfma_f32_16x16x32_bf16 v[164:167], v[184:187], v[64:67], v[164:167]
    ds_read_b128 v[180:183], v206 offset:24064
    s_waitcnt lgkmcnt(3)
    v_mfma_f32_16x16x32_bf16 v[168:171], v[188:191], v[64:67], v[168:171]
    ds_read_b128 v[184:187], v206 offset:25088
    v_mfma_f32_16x16x32_bf16 v[172:175], v[192:195], v[64:67], v[172:175]
    ds_read_b128 v[188:191], v206 offset:26112
    s_waitcnt lgkmcnt(3)
    v_mfma_f32_16x16x32_bf16 v[176:179], v[196:199], v[64:67], v[176:179]
    s_waitcnt vmcnt(5)
    ds_read_b128 v[192:195], v210 offset:23040
    v_mfma_f32_16x16x32_bf16 v[160:163], v[200:203], v[72:75], v[160:163]
    ds_read_b128 v[196:199], v206 offset:27648
    s_waitcnt lgkmcnt(3)
    v_mfma_f32_16x16x32_bf16 v[164:167], v[180:183], v[72:75], v[164:167]
    ds_read_b128 v[200:203], v206 offset:28672
    v_mfma_f32_16x16x32_bf16 v[168:171], v[184:187], v[72:75], v[168:171]
    ds_read_b128 v[180:183], v206 offset:29696
    s_waitcnt lgkmcnt(3)
    v_mfma_f32_16x16x32_bf16 v[172:175], v[188:191], v[72:75], v[172:175]
    ds_read_b128 v[184:187], v206 offset:30720
    v_mfma_f32_16x16x32_bf16 v[176:179], v[192:195], v[72:75], v[176:179]
    s_barrier
    s_mul_i32 s26, s2, 61440
    s_mul_i32 s27, s3, 5120
    s_add_u32 s26, s26, s27
    s_add_u32 s27, s26, 0
    buffer_load_dwordx4 v[100:103], v238, s[44:47], s27 offen
    s_add_u32 s27, s26, 20480
    buffer_load_dwordx4 v[120:123], v238, s[44:47], s27 offen
    s_add_u32 s27, s26, 40960
    buffer_load_dwordx4 v[140:143], v238, s[44:47], s27 offen
    s_add_u32 s27, s26, 1024
    buffer_load_dwordx4 v[104:107], v238, s[44:47], s27 offen
    s_add_u32 s27, s26, 21504
    buffer_load_dwordx4 v[124:127], v238, s[44:47], s27 offen
    s_add_u32 s27, s26, 41984
    buffer_load_dwordx4 v[144:147], v238, s[44:47], s27 offen
    s_add_u32 s27, s26, 2304
    buffer_load_dwordx2 v[108:109], v230, s[44:47], s27 offen
    s_add_u32 s27, s26, 22528
    buffer_load_dwordx2 v[128:129], v230, s[44:47], s27 offen
    s_add_u32 s27, s26, 43264
    buffer_load_dwordx2 v[148:149], v230, s[44:47], s27 offen
    s_waitcnt vmcnt(13)
    ds_read_b128 v[188:191], v210 offset:27648
    s_waitcnt lgkmcnt(3)
    v_mfma_f32_16x16x32_bf16 v[160:163], v[196:199], v[0:3], v[160:163]
    ds_read_b128 v[192:195], v206 offset:32256
    v_mfma_f32_16x16x32_bf16 v[164:167], v[200:203], v[0:3], v[164:167]
    ds_read_b128 v[196:199], v206 offset:33280
    s_waitcnt lgkmcnt(3)
    v_mfma_f32_16x16x32_bf16 v[168:171], v[180:183], v[0:3], v[168:171]
    ds_read_b128 v[200:203], v206 offset:34304
    v_mfma_f32_16x16x32_bf16 v[172:175], v[184:187], v[0:3], v[172:175]
    ds_read_b128 v[180:183], v206 offset:35328
    s_waitcnt lgkmcnt(3)
    v_mfma_f32_16x16x32_bf16 v[176:179], v[188:191], v[0:3], v[176:179]
    s_waitcnt vmcnt(12)
    ds_read_b128 v[184:187], v210 offset:32256
    v_mfma_f32_16x16x32_bf16 v[160:163], v[192:195], v[8:11], v[160:163]
    ds_read_b128 v[188:191], v207 offset:0
    s_waitcnt lgkmcnt(3)
    v_mfma_f32_16x16x32_bf16 v[164:167], v[196:199], v[8:11], v[164:167]
    ds_read_b128 v[192:195], v207 offset:1024
    v_mfma_f32_16x16x32_bf16 v[168:171], v[200:203], v[8:11], v[168:171]
    ds_read_b128 v[196:199], v207 offset:2048
    s_waitcnt lgkmcnt(3)
    v_mfma_f32_16x16x32_bf16 v[172:175], v[180:183], v[8:11], v[172:175]
    ds_read_b128 v[200:203], v207 offset:3072
    v_mfma_f32_16x16x32_bf16 v[176:179], v[184:187], v[8:11], v[176:179]
    s_waitcnt vmcnt(11)
    ds_read_b128 v[180:183], v211 offset:0
    s_waitcnt lgkmcnt(3)
    v_mfma_f32_16x16x32_bf16 v[160:163], v[188:191], v[16:19], v[160:163]
    ds_read_b128 v[184:187], v207 offset:4608
    v_mfma_f32_16x16x32_bf16 v[164:167], v[192:195], v[16:19], v[164:167]
    ds_read_b128 v[188:191], v207 offset:5632
    s_waitcnt lgkmcnt(3)
    v_mfma_f32_16x16x32_bf16 v[168:171], v[196:199], v[16:19], v[168:171]
    ds_read_b128 v[192:195], v207 offset:6656
    v_mfma_f32_16x16x32_bf16 v[172:175], v[200:203], v[16:19], v[172:175]
    ds_read_b128 v[196:199], v207 offset:7680
    s_waitcnt lgkmcnt(3)
    v_mfma_f32_16x16x32_bf16 v[176:179], v[180:183], v[16:19], v[176:179]
    s_waitcnt vmcnt(10)
    ds_read_b128 v[200:203], v211 offset:4608
    v_mfma_f32_16x16x32_bf16 v[160:163], v[184:187], v[24:27], v[160:163]
    s_waitcnt lgkmcnt(2)
    v_mfma_f32_16x16x32_bf16 v[164:167], v[188:191], v[24:27], v[164:167]
    v_mfma_f32_16x16x32_bf16 v[168:171], v[192:195], v[24:27], v[168:171]
    s_waitcnt lgkmcnt(0)
    v_mfma_f32_16x16x32_bf16 v[172:175], v[196:199], v[24:27], v[172:175]
    v_mfma_f32_16x16x32_bf16 v[176:179], v[200:203], v[24:27], v[176:179]
    s_waitcnt vmcnt(6)
    v_lshlrev_b32 v180, 16, v100
    v_and_b32 v181, 0xffff0000, v100
    v_lshlrev_b32 v182, 16, v101
    v_and_b32 v183, 0xffff0000, v101
    v_add_f32 v80, v80, v180
    v_add_f32 v81, v81, v181
    v_add_f32 v82, v82, v182
    v_add_f32 v83, v83, v183
    v_lshlrev_b32 v180, 16, v120
    v_and_b32 v181, 0xffff0000, v120
    v_lshlrev_b32 v182, 16, v121
    v_and_b32 v183, 0xffff0000, v121
    v_add_f32 v80, v80, v180
    v_add_f32 v81, v81, v181
    v_add_f32 v82, v82, v182
    v_add_f32 v83, v83, v183
    v_lshlrev_b32 v180, 16, v140
    v_and_b32 v181, 0xffff0000, v140
    v_lshlrev_b32 v182, 16, v141
    v_and_b32 v183, 0xffff0000, v141
    v_add_f32 v80, v80, v180
    v_add_f32 v81, v81, v181
    v_add_f32 v82, v82, v182
    v_add_f32 v83, v83, v183
    v_mul_f32 v180, s64, v80
    v_mul_f32 v181, s64, v81
    v_mul_f32 v182, s64, v82
    v_mul_f32 v183, s64, v83
    v_exp_f32 v180, v180
    v_exp_f32 v181, v181
    v_exp_f32 v182, v182
    v_exp_f32 v183, v183
    v_lshlrev_b32 v184, 16, v216
    v_and_b32 v185, 0xffff0000, v216
    v_lshlrev_b32 v186, 16, v217
    v_and_b32 v187, 0xffff0000, v217
    v_add_f32 v180, 1.0, v180
    v_add_f32 v181, 1.0, v181
    v_add_f32 v182, 1.0, v182
    v_add_f32 v183, 1.0, v183
    v_rcp_f32 v180, v180
    v_rcp_f32 v181, v181
    v_rcp_f32 v182, v182
    v_rcp_f32 v183, v183
    v_mul_f32 v80, v80, v160
    v_mul_f32 v81, v81, v161
    v_mul_f32 v82, v82, v162
    v_mul_f32 v83, v83, v163
    v_fmac_f32 v184, v80, v180
    v_fmac_f32 v185, v81, v181
    v_fmac_f32 v186, v82, v182
    v_fmac_f32 v187, v83, v183
    v_cvt_pk_bf16_f32 v188, v184, v185
    v_cvt_pk_bf16_f32 v189, v186, v187
    buffer_store_dwordx2 v[188:189], v214, s[40:43], 0 offen offset:0
    v_lshlrev_b32 v180, 16, v102
    v_and_b32 v181, 0xffff0000, v102
    v_lshlrev_b32 v182, 16, v103
    v_and_b32 v183, 0xffff0000, v103
    v_add_f32 v84, v84, v180
    v_add_f32 v85, v85, v181
    v_add_f32 v86, v86, v182
    v_add_f32 v87, v87, v183
    v_lshlrev_b32 v180, 16, v122
    v_and_b32 v181, 0xffff0000, v122
    v_lshlrev_b32 v182, 16, v123
    v_and_b32 v183, 0xffff0000, v123
    v_add_f32 v84, v84, v180
    v_add_f32 v85, v85, v181
    v_add_f32 v86, v86, v182
    v_add_f32 v87, v87, v183
    v_lshlrev_b32 v180, 16, v142
    v_and_b32 v181, 0xffff0000, v142
    v_lshlrev_b32 v182, 16, v143
    v_and_b32 v183, 0xffff0000, v143
    v_add_f32 v84, v84, v180
    v_add_f32 v85, v85, v181
    v_add_f32 v86, v86, v182
    v_add_f32 v87, v87, v183
    v_mul_f32 v180, s64, v84
    v_mul_f32 v181, s64, v85
    v_mul_f32 v182, s64, v86
    v_mul_f32 v183, s64, v87
    v_exp_f32 v180, v180
    v_exp_f32 v181, v181
    v_exp_f32 v182, v182
    v_exp_f32 v183, v183
    v_lshlrev_b32 v184, 16, v218
    v_and_b32 v185, 0xffff0000, v218
    v_lshlrev_b32 v186, 16, v219
    v_and_b32 v187, 0xffff0000, v219
    v_add_f32 v180, 1.0, v180
    v_add_f32 v181, 1.0, v181
    v_add_f32 v182, 1.0, v182
    v_add_f32 v183, 1.0, v183
    v_rcp_f32 v180, v180
    v_rcp_f32 v181, v181
    v_rcp_f32 v182, v182
    v_rcp_f32 v183, v183
    v_mul_f32 v84, v84, v164
    v_mul_f32 v85, v85, v165
    v_mul_f32 v86, v86, v166
    v_mul_f32 v87, v87, v167
    v_fmac_f32 v184, v84, v180
    v_fmac_f32 v185, v85, v181
    v_fmac_f32 v186, v86, v182
    v_fmac_f32 v187, v87, v183
    v_cvt_pk_bf16_f32 v190, v184, v185
    v_cvt_pk_bf16_f32 v191, v186, v187
    buffer_store_dwordx2 v[190:191], v214, s[40:43], 0 offen offset:32
    s_waitcnt vmcnt(5)
    v_lshlrev_b32 v180, 16, v104
    v_and_b32 v181, 0xffff0000, v104
    v_lshlrev_b32 v182, 16, v105
    v_and_b32 v183, 0xffff0000, v105
    v_add_f32 v88, v88, v180
    v_add_f32 v89, v89, v181
    v_add_f32 v90, v90, v182
    v_add_f32 v91, v91, v183
    v_lshlrev_b32 v180, 16, v124
    v_and_b32 v181, 0xffff0000, v124
    v_lshlrev_b32 v182, 16, v125
    v_and_b32 v183, 0xffff0000, v125
    v_add_f32 v88, v88, v180
    v_add_f32 v89, v89, v181
    v_add_f32 v90, v90, v182
    v_add_f32 v91, v91, v183
    v_lshlrev_b32 v180, 16, v144
    v_and_b32 v181, 0xffff0000, v144
    v_lshlrev_b32 v182, 16, v145
    v_and_b32 v183, 0xffff0000, v145
    v_add_f32 v88, v88, v180
    v_add_f32 v89, v89, v181
    v_add_f32 v90, v90, v182
    v_add_f32 v91, v91, v183
    v_mul_f32 v180, s64, v88
    v_mul_f32 v181, s64, v89
    v_mul_f32 v182, s64, v90
    v_mul_f32 v183, s64, v91
    v_exp_f32 v180, v180
    v_exp_f32 v181, v181
    v_exp_f32 v182, v182
    v_exp_f32 v183, v183
    v_lshlrev_b32 v184, 16, v220
    v_and_b32 v185, 0xffff0000, v220
    v_lshlrev_b32 v186, 16, v221
    v_and_b32 v187, 0xffff0000, v221
    v_add_f32 v180, 1.0, v180
    v_add_f32 v181, 1.0, v181
    v_add_f32 v182, 1.0, v182
    v_add_f32 v183, 1.0, v183
    v_rcp_f32 v180, v180
    v_rcp_f32 v181, v181
    v_rcp_f32 v182, v182
    v_rcp_f32 v183, v183
    v_mul_f32 v88, v88, v168
    v_mul_f32 v89, v89, v169
    v_mul_f32 v90, v90, v170
    v_mul_f32 v91, v91, v171
    v_fmac_f32 v184, v88, v180
    v_fmac_f32 v185, v89, v181
    v_fmac_f32 v186, v90, v182
    v_fmac_f32 v187, v91, v183
    v_cvt_pk_bf16_f32 v192, v184, v185
    v_cvt_pk_bf16_f32 v193, v186, v187
    buffer_store_dwordx2 v[192:193], v214, s[40:43], 0 offen offset:64
    v_lshlrev_b32 v180, 16, v106
    v_and_b32 v181, 0xffff0000, v106
    v_lshlrev_b32 v182, 16, v107
    v_and_b32 v183, 0xffff0000, v107
    v_add_f32 v92, v92, v180
    v_add_f32 v93, v93, v181
    v_add_f32 v94, v94, v182
    v_add_f32 v95, v95, v183
    v_lshlrev_b32 v180, 16, v126
    v_and_b32 v181, 0xffff0000, v126
    v_lshlrev_b32 v182, 16, v127
    v_and_b32 v183, 0xffff0000, v127
    v_add_f32 v92, v92, v180
    v_add_f32 v93, v93, v181
    v_add_f32 v94, v94, v182
    v_add_f32 v95, v95, v183
    v_lshlrev_b32 v180, 16, v146
    v_and_b32 v181, 0xffff0000, v146
    v_lshlrev_b32 v182, 16, v147
    v_and_b32 v183, 0xffff0000, v147
    v_add_f32 v92, v92, v180
    v_add_f32 v93, v93, v181
    v_add_f32 v94, v94, v182
    v_add_f32 v95, v95, v183
    v_mul_f32 v180, s64, v92
    v_mul_f32 v181, s64, v93
    v_mul_f32 v182, s64, v94
    v_mul_f32 v183, s64, v95
    v_exp_f32 v180, v180
    v_exp_f32 v181, v181
    v_exp_f32 v182, v182
    v_exp_f32 v183, v183
    v_lshlrev_b32 v184, 16, v222
    v_and_b32 v185, 0xffff0000, v222
    v_lshlrev_b32 v186, 16, v223
    v_and_b32 v187, 0xffff0000, v223
    v_add_f32 v180, 1.0, v180
    v_add_f32 v181, 1.0, v181
    v_add_f32 v182, 1.0, v182
    v_add_f32 v183, 1.0, v183
    v_rcp_f32 v180, v180
    v_rcp_f32 v181, v181
    v_rcp_f32 v182, v182
    v_rcp_f32 v183, v183
    v_mul_f32 v92, v92, v172
    v_mul_f32 v93, v93, v173
    v_mul_f32 v94, v94, v174
    v_mul_f32 v95, v95, v175
    v_fmac_f32 v184, v92, v180
    v_fmac_f32 v185, v93, v181
    v_fmac_f32 v186, v94, v182
    v_fmac_f32 v187, v95, v183
    v_cvt_pk_bf16_f32 v194, v184, v185
    v_cvt_pk_bf16_f32 v195, v186, v187
    buffer_store_dwordx2 v[194:195], v214, s[40:43], 0 offen offset:96
    s_waitcnt vmcnt(4)
    v_lshlrev_b32 v180, 16, v108
    v_and_b32 v181, 0xffff0000, v108
    v_lshlrev_b32 v182, 16, v109
    v_and_b32 v183, 0xffff0000, v109
    v_add_f32 v96, v96, v180
    v_add_f32 v97, v97, v181
    v_add_f32 v98, v98, v182
    v_add_f32 v99, v99, v183
    v_lshlrev_b32 v180, 16, v128
    v_and_b32 v181, 0xffff0000, v128
    v_lshlrev_b32 v182, 16, v129
    v_and_b32 v183, 0xffff0000, v129
    v_add_f32 v96, v96, v180
    v_add_f32 v97, v97, v181
    v_add_f32 v98, v98, v182
    v_add_f32 v99, v99, v183
    v_lshlrev_b32 v180, 16, v148
    v_and_b32 v181, 0xffff0000, v148
    v_lshlrev_b32 v182, 16, v149
    v_and_b32 v183, 0xffff0000, v149
    v_add_f32 v96, v96, v180
    v_add_f32 v97, v97, v181
    v_add_f32 v98, v98, v182
    v_add_f32 v99, v99, v183
    v_mul_f32 v180, s64, v96
    v_mul_f32 v181, s64, v97
    v_mul_f32 v182, s64, v98
    v_mul_f32 v183, s64, v99
    v_exp_f32 v180, v180
    v_exp_f32 v181, v181
    v_exp_f32 v182, v182
    v_exp_f32 v183, v183
    v_lshlrev_b32 v184, 16, v224
    v_and_b32 v185, 0xffff0000, v224
    v_lshlrev_b32 v186, 16, v225
    v_and_b32 v187, 0xffff0000, v225
    v_add_f32 v180, 1.0, v180
    v_add_f32 v181, 1.0, v181
    v_add_f32 v182, 1.0, v182
    v_add_f32 v183, 1.0, v183
    v_rcp_f32 v180, v180
    v_rcp_f32 v181, v181
    v_rcp_f32 v182, v182
    v_rcp_f32 v183, v183
    v_mul_f32 v96, v96, v176
    v_mul_f32 v97, v97, v177
    v_mul_f32 v98, v98, v178
    v_mul_f32 v99, v99, v179
    v_fmac_f32 v184, v96, v180
    v_fmac_f32 v185, v97, v181
    v_fmac_f32 v186, v98, v182
    v_fmac_f32 v187, v99, v183
    v_cvt_pk_bf16_f32 v196, v184, v185
    v_cvt_pk_bf16_f32 v197, v186, v187
    buffer_store_dwordx2 v[196:197], v215, s[40:43], 0 offen offset:128
    s_endpgm
K2_LOADER:
    s_waitcnt vmcnt(11)
    s_barrier
    s_add_u32 s24, s31, 55296
    s_add_u32 m0, s22, 110592
    s_nop 0
    buffer_load_dwordx4 v238, s[60:63], s24 offen offset:0 lds
    buffer_load_dwordx4 v238, s[60:63], s24 offen offset:1024 lds
    buffer_load_dwordx4 v238, s[60:63], s24 offen offset:2048 lds
    buffer_load_dwordx4 v238, s[60:63], s24 offen offset:3072 lds
    s_add_u32 s24, s31, 59392
    s_add_u32 m0, s22, 114688
    s_nop 0
    buffer_load_dwordx4 v238, s[60:63], s24 offen offset:0 lds
    buffer_load_dwordx4 v238, s[60:63], s24 offen offset:1024 lds
    buffer_load_dwordx4 v238, s[60:63], s24 offen offset:2048 lds
    buffer_load_dwordx4 v238, s[60:63], s24 offen offset:3072 lds
    s_add_u32 s24, s31, 63488
    s_add_u32 m0, s22, 118784
    s_nop 0
    buffer_load_dwordx4 v238, s[60:63], s24 offen offset:0 lds
    s_waitcnt vmcnt(11)
    s_waitcnt vmcnt(9)
    s_barrier
    s_cmp_eq_u32 s3, 4
    s_cbranch_scc0 SIG3_9682
    s_memrealtime s[90:91]
    v_mov_b32 v2, 0
    s_lshl_b32 s25, s2, 3
    s_waitcnt lgkmcnt(0)
    v_mov_b32 v0, s90
    v_xor_b32 v1, 0x5bd1e995, v0
    s_mov_b64 exec, 1
    buffer_store_dwordx2 v[0:1], v2, s[56:59], s25 offen sc1
    s_mov_b64 exec, -1
SIG3_9682:
    s_add_u32 s24, s31, 73728
    s_add_u32 m0, s22, 0
    s_nop 0
    buffer_load_dwordx4 v238, s[60:63], s24 offen offset:0 lds
    buffer_load_dwordx4 v238, s[60:63], s24 offen offset:1024 lds
    buffer_load_dwordx4 v238, s[60:63], s24 offen offset:2048 lds
    buffer_load_dwordx4 v238, s[60:63], s24 offen offset:3072 lds
    s_add_u32 s24, s31, 77824
    s_add_u32 m0, s22, 4096
    s_nop 0
    buffer_load_dwordx4 v238, s[60:63], s24 offen offset:0 lds
    buffer_load_dwordx4 v238, s[60:63], s24 offen offset:1024 lds
    buffer_load_dwordx4 v238, s[60:63], s24 offen offset:2048 lds
    buffer_load_dwordx4 v238, s[60:63], s24 offen offset:3072 lds
    s_add_u32 s24, s31, 81920
    s_add_u32 m0, s22, 8192
    s_nop 0
    buffer_load_dwordx4 v238, s[60:63], s24 offen offset:0 lds
    s_waitcnt vmcnt(9)
    s_barrier
    s_add_u32 s24, s31, 92160
    s_add_u32 m0, s22, 36864
    s_nop 0
    buffer_load_dwordx4 v238, s[60:63], s24 offen offset:0 lds
    buffer_load_dwordx4 v238, s[60:63], s24 offen offset:1024 lds
    buffer_load_dwordx4 v238, s[60:63], s24 offen offset:2048 lds
    buffer_load_dwordx4 v238, s[60:63], s24 offen offset:3072 lds
    s_add_u32 s24, s31, 96256
    s_add_u32 m0, s22, 40960
    s_nop 0
    buffer_load_dwordx4 v238, s[60:63], s24 offen offset:0 lds
    buffer_load_dwordx4 v238, s[60:63], s24 offen offset:1024 lds
    buffer_load_dwordx4 v238, s[60:63], s24 offen offset:2048 lds
    buffer_load_dwordx4 v238, s[60:63], s24 offen offset:3072 lds
    s_add_u32 s24, s31, 100352
    s_add_u32 m0, s22, 45056
    s_nop 0
    buffer_load_dwordx4 v238, s[60:63], s24 offen offset:0 lds
    s_waitcnt vmcnt(9)
    s_barrier
    s_add_u32 s24, s31, 110592
    s_add_u32 m0, s22, 73728
    s_nop 0
    buffer_load_dwordx4 v238, s[60:63], s24 offen offset:0 lds
    buffer_load_dwordx4 v238, s[60:63], s24 offen offset:1024 lds
    buffer_load_dwordx4 v238, s[60:63], s24 offen offset:2048 lds
    buffer_load_dwordx4 v238, s[60:63], s24 offen offset:3072 lds
    s_add_u32 s24, s31, 114688
    s_add_u32 m0, s22, 77824
    s_nop 0
    buffer_load_dwordx4 v238, s[60:63], s24 offen offset:0 lds
    buffer_load_dwordx4 v238, s[60:63], s24 offen offset:1024 lds
    buffer_load_dwordx4 v238, s[60:63], s24 offen offset:2048 lds
    buffer_load_dwordx4 v238, s[60:63], s24 offen offset:3072 lds
    s_add_u32 s24, s31, 118784
    s_add_u32 m0, s22, 81920
    s_nop 0
    buffer_load_dwordx4 v238, s[60:63], s24 offen offset:0 lds
    s_waitcnt vmcnt(9)
    s_barrier
    s_add_u32 s24, s31, 129024
    s_add_u32 m0, s22, 110592
    s_nop 0
    buffer_load_dwordx4 v238, s[60:63], s24 offen offset:0 lds
    buffer_load_dwordx4 v238, s[60:63], s24 offen offset:1024 lds
    buffer_load_dwordx4 v238, s[60:63], s24 offen offset:2048 lds
    buffer_load_dwordx4 v238, s[60:63], s24 offen offset:3072 lds
    s_add_u32 s24, s31, 133120
    s_add_u32 m0, s22, 114688
    s_nop 0
    buffer_load_dwordx4 v238, s[60:63], s24 offen offset:0 lds
    buffer_load_dwordx4 v238, s[60:63], s24 offen offset:1024 lds
    buffer_load_dwordx4 v238, s[60:63], s24 offen offset:2048 lds
    buffer_load_dwordx4 v238, s[60:63], s24 offen offset:3072 lds
    s_add_u32 s24, s31, 137216
    s_add_u32 m0, s22, 118784
    s_nop 0
    buffer_load_dwordx4 v238, s[60:63], s24 offen offset:0 lds
    s_waitcnt vmcnt(9)
    s_barrier
    s_add_u32 s24, s31, 147456
    s_add_u32 m0, s22, 0
    s_nop 0
    buffer_load_dwordx4 v238, s[60:63], s24 offen offset:0 lds
    buffer_load_dwordx4 v238, s[60:63], s24 offen offset:1024 lds
    buffer_load_dwordx4 v238, s[60:63], s24 offen offset:2048 lds
    buffer_load_dwordx4 v238, s[60:63], s24 offen offset:3072 lds
    s_add_u32 s24, s31, 151552
    s_add_u32 m0, s22, 4096
    s_nop 0
    buffer_load_dwordx4 v238, s[60:63], s24 offen offset:0 lds
    buffer_load_dwordx4 v238, s[60:63], s24 offen offset:1024 lds
    buffer_load_dwordx4 v238, s[60:63], s24 offen offset:2048 lds
    buffer_load_dwordx4 v238, s[60:63], s24 offen offset:3072 lds
    s_add_u32 s24, s31, 155648
    s_add_u32 m0, s22, 8192
    s_nop 0
    buffer_load_dwordx4 v238, s[60:63], s24 offen offset:0 lds
    s_waitcnt vmcnt(9)
    s_cmp_eq_u32 s3, 7
    s_cbranch_scc0 POLL3_9778_R
    v_mbcnt_lo_u32_b32 v0, -1, 0
    v_mbcnt_hi_u32_b32 v0, -1, v0
    s_lshr_b32 s27, s21, 4
    s_lshl_b32 s27, s27, 4
    v_add_u32 v1, s27, v0
    v_max_i32 v1, 0, v1
    v_lshlrev_b32 v1, 4, v1
    v_cmp_gt_u32 vcc, 16, v0
    s_nop 0
    s_mov_b64 exec, vcc
    s_mov_b32 s26, 0
POLL3_9778_F:
    buffer_load_dwordx4 v[4:7], v1, s[56:59], 0 offen offset:0 sc1
    s_add_u32 s26, s26, 1
    s_waitcnt vmcnt(0)
    s_add_u32 s27, s76, 500
    v_xor_b32 v2, v4, v5
    v_xor_b32 v3, v6, v7
    v_xor_b32 v2, 0x5bd1e995, v2
    v_xor_b32 v3, 0x5bd1e995, v3
    v_or_b32 v2, v2, v3
    v_subrev_u32 v5, s27, v4
    v_subrev_u32 v7, s27, v6
    v_max_u32 v3, v5, v7
    v_lshrrev_b32 v3, 22, v3
    v_or_b32 v2, v2, v3
    v_cmp_ne_u32 vcc, 0, v2
    s_nop 4
    s_cbranch_vccz POLL3_9778_D
    s_mov_b64 exec, vcc
    s_sleep 3
    s_cmp_lt_u32 s26, 0x8000
    s_cbranch_scc1 POLL3_9778_F
POLL3_9778_D:
    s_mov_b64 exec, -1
POLL3_9778_R:
    s_barrier
    s_add_u32 s24, s67, 0
    s_add_u32 m0, s22, 36864
    s_nop 0
    buffer_load_dwordx4 v238, s[60:63], s24 offen offset:0 lds
    buffer_load_dwordx4 v238, s[60:63], s24 offen offset:1024 lds
    buffer_load_dwordx4 v238, s[60:63], s24 offen offset:2048 lds
    buffer_load_dwordx4 v238, s[60:63], s24 offen offset:3072 lds
    s_add_u32 s24, s67, 4096
    s_add_u32 m0, s22, 40960
    s_nop 0
    buffer_load_dwordx4 v238, s[60:63], s24 offen offset:0 lds
    buffer_load_dwordx4 v238, s[60:63], s24 offen offset:1024 lds
    buffer_load_dwordx4 v238, s[60:63], s24 offen offset:2048 lds
    buffer_load_dwordx4 v238, s[60:63], s24 offen offset:3072 lds
    s_add_u32 s24, s67, 8192
    s_add_u32 m0, s22, 45056
    s_nop 0
    buffer_load_dwordx4 v238, s[60:63], s24 offen offset:0 lds
    s_waitcnt vmcnt(9)
    s_barrier
    s_add_u32 s24, s67, 36864
    s_add_u32 m0, s22, 73728
    s_nop 0
    buffer_load_dwordx4 v238, s[60:63], s24 offen offset:0 lds
    buffer_load_dwordx4 v238, s[60:63], s24 offen offset:1024 lds
    buffer_load_dwordx4 v238, s[60:63], s24 offen offset:2048 lds
    buffer_load_dwordx4 v238, s[60:63], s24 offen offset:3072 lds
    s_add_u32 s24, s67, 40960
    s_add_u32 m0, s22, 77824
    s_nop 0
    buffer_load_dwordx4 v238, s[60:63], s24 offen offset:0 lds
    buffer_load_dwordx4 v238, s[60:63], s24 offen offset:1024 lds
    buffer_load_dwordx4 v238, s[60:63], s24 offen offset:2048 lds
    buffer_load_dwordx4 v238, s[60:63], s24 offen offset:3072 lds
    s_add_u32 s24, s67, 45056
    s_add_u32 m0, s22, 81920
    s_nop 0
    buffer_load_dwordx4 v238, s[60:63], s24 offen offset:0 lds
    s_waitcnt vmcnt(9)
    s_barrier
    s_add_u32 s24, s67, 73728
    s_add_u32 m0, s22, 110592
    s_cmp_eq_u32 s3, 4
    s_cbranch_scc0 K2_SKIP11
    buffer_load_dwordx4 v238, s[60:63], s24 offen offset:0 lds
    buffer_load_dwordx4 v238, s[60:63], s24 offen offset:1024 lds
    buffer_load_dwordx4 v238, s[60:63], s24 offen offset:2048 lds
    buffer_load_dwordx4 v238, s[60:63], s24 offen offset:3072 lds
    s_add_u32 s24, s67, 77824
    s_add_u32 m0, s22, 114688
    s_nop 0
    buffer_load_dwordx4 v238, s[60:63], s24 offen offset:0 lds
    buffer_load_dwordx4 v238, s[60:63], s24 offen offset:1024 lds
    buffer_load_dwordx4 v238, s[60:63], s24 offen offset:2048 lds
    buffer_load_dwordx4 v238, s[60:63], s24 offen offset:3072 lds
    s_add_u32 s24, s67, 81920
    s_add_u32 m0, s22, 118784
    s_nop 0
    buffer_load_dwordx4 v238, s[60:63], s24 offen offset:0 lds
K2_SKIP11:
    s_waitcnt vmcnt(0)
    s_barrier
    s_waitcnt vmcnt(0)
    s_barrier
    s_cmp_eq_u32 s3, 7
    s_cbranch_scc0 POLL4_9872_R
    v_mbcnt_lo_u32_b32 v0, -1, 0
    v_mbcnt_hi_u32_b32 v0, -1, v0
    s_lshl_b32 s27, s2, 3
    v_add_u32 v1, s27, v0
    v_max_i32 v1, 0, v1
    v_lshlrev_b32 v1, 4, v1
    v_cmp_gt_u32 vcc, 6, v0
    s_nop 0
    s_mov_b64 exec, vcc
    s_mov_b32 s26, 0
POLL4_9872_F:
    buffer_load_dwordx4 v[4:7], v1, s[56:59], 0 offen offset:2048 sc1
    s_add_u32 s26, s26, 1
    s_waitcnt vmcnt(0)
    s_add_u32 s27, s76, 500
    v_xor_b32 v2, v4, v5
    v_xor_b32 v3, v6, v7
    v_xor_b32 v2, 0x5bd1e995, v2
    v_xor_b32 v3, 0x5bd1e995, v3
    v_or_b32 v2, v2, v3
    v_subrev_u32 v5, s27, v4
    v_subrev_u32 v7, s27, v6
    v_max_u32 v3, v5, v7
    v_lshrrev_b32 v3, 22, v3
    v_or_b32 v2, v2, v3
    v_cmp_ne_u32 vcc, 0, v2
    s_nop 4
    s_cbranch_vccz POLL4_9872_D
    s_mov_b64 exec, vcc
    s_sleep 3
    s_cmp_lt_u32 s26, 0x8000
    s_cbranch_scc1 POLL4_9872_F
POLL4_9872_D:
    s_mov_b64 exec, -1
POLL4_9872_R:
    s_barrier
K_END:
    s_endpgm
.section .rodata,"a"
.p2align 6
.amdhsa_kernel recurrent_scan__sliding_local_dilated__swiglu_ffn__prompt_kernel
  .amdhsa_next_free_vgpr 256
  .amdhsa_next_free_sgpr 102
  .amdhsa_accum_offset 256
  .amdhsa_group_segment_fixed_size 0
  .amdhsa_kernarg_size 80
  .amdhsa_user_sgpr_count 2
  .amdhsa_user_sgpr_kernarg_segment_ptr 1
  .amdhsa_system_sgpr_workgroup_id_x 1
.end_amdhsa_kernel
```
